```python
import torch

def _softmax(x, axis=-1):
    return torch.softmax(x, dim=axis)
def _gelu(x):
    return torch.nn.functional.gelu(x, approximate="tanh")
def _silu(x):
    return torch.nn.functional.silu(x)
def _sigmoid(x):
    return torch.sigmoid(x)
def _layernorm(x, axis=-1, eps=1e-5):
    m = x.mean(dim=axis, keepdim=True)
    v = x.var(dim=axis, keepdim=True, unbiased=False)
    return (x - m) / torch.sqrt(v + eps)
def _scatter_add(tgt, idx, src, axis=0):
    return tgt.clone().index_add_(axis, idx, src)
def _segment_sum(src, seg, n):
    out = torch.zeros((n,) + src.shape[1:], dtype=src.dtype)
    return out.index_add_(0, seg, src)
def _pad(x, pw):
    flat = tuple(v for pair in reversed(pw) for v in pair)
    return torch.nn.functional.pad(x, flat)

kernel_name = 'gated_mix__ssm_conv_s4__swiglu_ffn__prompt'

def setup_inputs():

    _w = (lambda a: (lambda t: t.to(torch.bfloat16) if t.is_floating_point() else t)(torch.as_tensor(a)))
    def _A_setup():
        B, L, D, N = 1, 2048, 512, 128
        A_re = -(lambda _x: torch.exp(torch.as_tensor(_x)))((lambda *s: torch.randn(*s, dtype=torch.bfloat16) * 3.2)(D, N))
        A_im = torch.pi * (lambda *s: torch.randn(*s, dtype=torch.bfloat16) * 0.05)(D, N)
        B_re = (lambda *s: torch.randn(*s, dtype=torch.bfloat16) * 0.1)(D, N)
        B_im = (lambda *s: torch.randn(*s, dtype=torch.bfloat16) * 0.1)(D, N)
        C_re = (lambda *s: torch.randn(*s, dtype=torch.bfloat16) * 0.1)(D, N)
        C_im = (lambda *s: torch.randn(*s, dtype=torch.bfloat16) * 0.1)(D, N)
        log_dt = (lambda *s: torch.randn(*s, dtype=torch.bfloat16) * 0.05)(D) * 0.5 - 4.0
        Dskip = (lambda *s: torch.randn(*s, dtype=torch.bfloat16) * 0.05)(D)
        return {
            "u": _w((lambda *s: torch.randn(*s, dtype=torch.bfloat16) * 0.05)(B, L, D)),
            "A_re": _w(A_re),
            "A_im": _w(A_im),
            "B_re": _w(B_re),
            "B_im": _w(B_im),
            "C_re": _w(C_re),
            "C_im": _w(C_im),
            "log_dt": _w(log_dt),
            "Dskip": _w(Dskip),
        }
    _A_in = _A_setup()

    def _B_setup():
        B, S, D, F = 1, 2048, 512, 1792
        return {
            "x": _w((lambda *s: torch.randn(*s, dtype=torch.bfloat16) * 0.05)(B, S, D)),
            "w_gate": _w((lambda *s: torch.randn(*s, dtype=torch.bfloat16) * 0.05)(D, F)),
            "w_up": _w((lambda *s: torch.randn(*s, dtype=torch.bfloat16) * 0.05)(D, F)),
            "w_down": _w((lambda *s: torch.randn(*s, dtype=torch.bfloat16) * 0.05)(F, D)),
        }
    _B_in = _B_setup()

    return {
        "A_u": _A_in["u"],
        "A_A_re": _A_in["A_re"],
        "A_A_im": _A_in["A_im"],
        "A_B_re": _A_in["B_re"],
        "A_B_im": _A_in["B_im"],
        "A_C_re": _A_in["C_re"],
        "A_C_im": _A_in["C_im"],
        "A_log_dt": _A_in["log_dt"],
        "A_Dskip": _A_in["Dskip"],
        "B_x": _B_in["x"],
        "B_w_gate": _B_in["w_gate"],
        "B_w_up": _B_in["w_up"],
        "B_w_down": _B_in["w_down"],
        "gate_w": _w((lambda *s: torch.randn(*s, dtype=torch.bfloat16) * 0.05)(512) * 16.0),
    }

def reference(A_u, A_A_re, A_A_im, A_B_re, A_B_im, A_C_re, A_C_im, A_log_dt, A_Dskip, B_x, B_w_gate, B_w_up, B_w_down, gate_w):
    def _A_ref(u, A_re, A_im, B_re, B_im, C_re, C_im, log_dt, Dskip):
        Bsz, L, D = u.shape
        dt = torch.exp(log_dt)[:, None]
        A = A_re + 1j * A_im
        Bc = B_re + 1j * B_im
        Cc = C_re + 1j * C_im
        logdA = dt * A
        dB = dt * Bc
        l = (lambda x, dt: x.to(dt))(torch.arange(L), A_re.dtype)
        P = torch.exp(logdA[:, :, None] * l[None, None, :])
        K = torch.einsum("dn,dnl,dn->dl", Cc, P, dB).real
        L2 = 2 * L
        Kp = _pad(K, ((0, 0), (0, L)))
        up = (lambda x, *d: x.permute(*d))(u, 0, 2, 1)
        up = _pad(up, ((0, 0), (0, 0), (0, L)))
        Kf = (lambda x, axes=(-2,-1): torch.fft.rfft2(x.float(), dim=axes))(Kp[:, None, :], axes=(-2, -1))
        Uf = (lambda x, axes=(-2,-1): torch.fft.rfft2(x.float(), dim=axes))(up[:, :, None, :], axes=(-2, -1))
        Yf = Uf * Kf[None, :, :, :]
        y = (lambda x, s, axes=(-2,-1): torch.fft.irfft2(x, s=s, dim=axes).to(torch.bfloat16))(Yf, (1, L2), axes=(-2, -1))[:, :, 0, :L]
        y = (lambda x, *d: x.permute(*d))(y, 0, 2, 1) + u * Dskip[None, None, :]
        return y

    def _B_ref(x, w_gate, w_up, w_down):
        g = _silu(x @ w_gate)
        u = x @ w_up
        return (g * u) @ w_down

    x = A_u
    g = _sigmoid((x * gate_w).sum(-1, keepdims=True))
    a = _A_ref(x, A_A_re, A_A_im, A_B_re, A_B_im, A_C_re, A_C_im, A_log_dt, A_Dskip)
    b = _B_ref(x, B_w_gate, B_w_up, B_w_down)
    return g * a + (1 - g) * b
```

```asm
; @launch grid=(256,1,1) block=(512,1,1) lds=163840
.amdgcn_target "amdgcn-amd-amdhsa--gfx950"
.text
.globl gated_mix__ssm_conv_s4__swiglu_ffn__prompt_kernel
.p2align 8
.type gated_mix__ssm_conv_s4__swiglu_ffn__prompt_kernel,@function
gated_mix__ssm_conv_s4__swiglu_ffn__prompt_kernel:
    s_cmp_ge_u32 s2, 256
    s_cbranch_scc1 L_end
    s_load_dwordx16 s[16:31], s[0:1], 0
    s_load_dwordx16 s[32:47], s[0:1], 64
    s_load_dwordx2 s[48:49], s[0:1], 128
    s_getpc_b64 s[60:61]
L_pc:
    s_and_b32 s61, s61, 0xffff
    s_mov_b32 s62, L_end - L_pc
    s_mov_b32 s63, 0x00020000
    v_lshrrev_b32 v3, 6, v0
    v_lshlrev_b32 v2, 7, v0
    v_lshl_add_u32 v2, v3, 24, v2
    s_bfe_u32 s4, s2, 0x30003
    s_lshl_b32 s4, s4, 13
    buffer_load_dword v255, v2, s[60:63], s4 offen
    s_memrealtime s[52:53]
    v_lshrrev_b32 v1, 6, v0
    v_and_b32 v0, 63, v0
    v_readfirstlane_b32 s3, v1
    v_mov_b32 v1, 0
    s_and_b32 s4, s2, 7
    s_lshr_b32 s5, s2, 3
    s_and_b32 s6, s4, 1
    s_lshr_b32 s7, s4, 1
    s_and_b32 s8, s5, 7
    s_lshl_b32 s6, s6, 3
    s_add_u32 s8, s8, s6
    s_lshr_b32 s9, s5, 3
    s_lshl_b32 s7, s7, 2
    s_add_u32 s9, s9, s7
    s_and_b32 s4, s2, 7
    s_lshr_b32 s5, s2, 3
    s_lshl_b32 s4, s4, 6
    s_lshl_b32 s5, s5, 1
    s_add_u32 s50, s4, s5
    s_and_b32 s14, s9, 3
    s_lshl_b32 s14, s14, 1
    s_add_u32 s14, s14, s8
    s_lshr_b32 s4, s9, 3
    s_add_u32 s14, s14, s4
    s_and_b32 s14, s14, 7
    s_and_b32 s12, s9, 3
    s_mul_i32 s13, s12, 7
    s_add_u32 s13, s13, 1
    s_lshr_b32 s13, s13, 2
    s_lshr_b32 s4, s9, 2
    s_mul_i32 s4, s4, 7
    s_add_u32 s13, s13, s4
    s_and_b32 s51, s3, 1
    s_lshr_b32 s4, s3, 1
    s_cmp_eq_u32 s4, 2
    s_cbranch_scc1 L_load0
    s_waitcnt lgkmcnt(0)
    s_and_b32 s51, s3, 1
    s_add_u32 s4, s50, s51
    s_lshl_b32 s4, s4, 8
    v_lshl_add_u32 v2, v0, 2, s4
    s_lshl_b32 s5, s50, 1
    s_load_dword s90, s[30:31], s5
    s_load_dword s91, s[32:33], s5
    global_load_dword v16, v2, s[18:19]
    global_load_dword v17, v2, s[20:21]
    global_load_dword v18, v2, s[22:23]
    global_load_dword v19, v2, s[24:25]
    global_load_dword v20, v2, s[26:27]
    global_load_dword v21, v2, s[28:29]
    s_cmp_lt_u32 s3, 4
    s_cbranch_scc1 L_cons0
    s_branch L_ssm0
L_load0:
    v_lshrrev_b32 v3, 3, v0
    v_and_b32 v4, 7, v0
    v_lshrrev_b32 v5, 1, v3
    v_xor_b32 v6, v4, v5
    v_lshlrev_b32 v6, 4, v6
    v_lshl_add_u32 v224, v3, 10, v6
    v_xor_b32 v225, 64, v224
    v_lshrrev_b32 v3, 4, v0
    v_and_b32 v4, 15, v0
    v_lshlrev_b32 v5, 2, v3
    v_xor_b32 v4, v4, v5
    v_mul_u32_u24 v3, 3584, v3
    v_lshl_add_u32 v226, v4, 4, v3
    v_xor_b32 v4, 2, v4
    v_lshl_add_u32 v227, v4, 4, v3
    s_lshl_b32 s72, s8, 17
    s_lshl_b32 s11, s51, 15
    s_add_u32 s72, s72, s11
    s_lshl_b32 s73, s13, 7
    s_lshl_b32 s74, s51, 12
    s_mul_i32 s75, s51, 16384
    s_waitcnt lgkmcnt(0)
    s_mov_b32 s64, s16
    s_and_b32 s65, s17, 0xffff
    s_mov_b32 s66, 2097152
    s_mov_b32 s67, 0x00020000
    s_cmp_eq_u32 s51, 0
    s_cselect_b32 s68, s36, s38
    s_cselect_b32 s69, s37, s39
    s_and_b32 s69, s69, 0xffff
    s_mov_b32 s70, 1835008
    s_mov_b32 s71, 0x00020000
    s_add_u32 s77, s14, 0
    s_and_b32 s77, s77, 7
    s_lshl_b32 s78, s77, 7
    s_add_u32 s78, s78, s72
    s_add_u32 m0, s74, 32768
    s_add_u32 s76, s78, 0
    buffer_load_dwordx4 v224, s[64:67], s76 offen lds
    s_add_u32 m0, s74, 33792
    s_add_u32 s76, s78, 8192
    buffer_load_dwordx4 v225, s[64:67], s76 offen lds
    s_add_u32 m0, s74, 34816
    s_add_u32 s76, s78, 16384
    buffer_load_dwordx4 v224, s[64:67], s76 offen lds
    s_add_u32 m0, s74, 35840
    s_add_u32 s76, s78, 24576
    buffer_load_dwordx4 v225, s[64:67], s76 offen lds
    s_add_u32 m0, s74, 40960
    s_add_u32 s76, s78, 65536
    buffer_load_dwordx4 v224, s[64:67], s76 offen lds
    s_add_u32 m0, s74, 41984
    s_add_u32 s76, s78, 73728
    buffer_load_dwordx4 v225, s[64:67], s76 offen lds
    s_add_u32 m0, s74, 43008
    s_add_u32 s76, s78, 81920
    buffer_load_dwordx4 v224, s[64:67], s76 offen lds
    s_add_u32 m0, s74, 44032
    s_add_u32 s76, s78, 90112
    buffer_load_dwordx4 v225, s[64:67], s76 offen lds
    s_mul_i32 s76, s77, 229376
    s_add_u32 s76, s76, s73
    s_add_u32 m0, s75, 0
    s_nop 0
    buffer_load_dwordx4 v226, s[68:71], s76 offen lds
    s_add_u32 m0, s75, 1024
    s_add_u32 s76, s76, 14336
    buffer_load_dwordx4 v226, s[68:71], s76 offen lds
    s_add_u32 m0, s75, 2048
    s_add_u32 s76, s76, 14336
    buffer_load_dwordx4 v227, s[68:71], s76 offen lds
    s_add_u32 m0, s75, 3072
    s_add_u32 s76, s76, 14336
    buffer_load_dwordx4 v227, s[68:71], s76 offen lds
    s_add_u32 m0, s75, 4096
    s_add_u32 s76, s76, 14336
    buffer_load_dwordx4 v226, s[68:71], s76 offen lds
    s_add_u32 m0, s75, 5120
    s_add_u32 s76, s76, 14336
    buffer_load_dwordx4 v226, s[68:71], s76 offen lds
    s_add_u32 m0, s75, 6144
    s_add_u32 s76, s76, 14336
    buffer_load_dwordx4 v227, s[68:71], s76 offen lds
    s_add_u32 m0, s75, 7168
    s_add_u32 s76, s76, 14336
    buffer_load_dwordx4 v227, s[68:71], s76 offen lds
    s_add_u32 m0, s75, 8192
    s_add_u32 s76, s76, 14336
    buffer_load_dwordx4 v226, s[68:71], s76 offen lds
    s_add_u32 m0, s75, 9216
    s_add_u32 s76, s76, 14336
    buffer_load_dwordx4 v226, s[68:71], s76 offen lds
    s_add_u32 m0, s75, 10240
    s_add_u32 s76, s76, 14336
    buffer_load_dwordx4 v227, s[68:71], s76 offen lds
    s_add_u32 m0, s75, 11264
    s_add_u32 s76, s76, 14336
    buffer_load_dwordx4 v227, s[68:71], s76 offen lds
    s_add_u32 m0, s75, 12288
    s_add_u32 s76, s76, 14336
    buffer_load_dwordx4 v226, s[68:71], s76 offen lds
    s_add_u32 m0, s75, 13312
    s_add_u32 s76, s76, 14336
    buffer_load_dwordx4 v226, s[68:71], s76 offen lds
    s_add_u32 m0, s75, 14336
    s_add_u32 s76, s76, 14336
    buffer_load_dwordx4 v227, s[68:71], s76 offen lds
    s_add_u32 m0, s75, 15360
    s_add_u32 s76, s76, 14336
    buffer_load_dwordx4 v227, s[68:71], s76 offen lds
    s_mov_b32 s56, s46
    s_and_b32 s57, s47, 0xffff
    s_mov_b32 s58, 256
    s_mov_b32 s59, 0x00020000
    v_mov_b32 v231, 0
    s_bfe_u32 s4, s3, 0x10001
    s_lshl_b32 s4, s4, 5
    s_add_u32 s4, s4, 16
    v_and_b32 v2, 15, v0
    v_lshrrev_b32 v3, 4, v0
    v_lshlrev_b32 v3, 3, v3
    v_sub_u32 v2, v2, v3
    v_add_u32 v2, s4, v2
    v_mov_b32 v3, 0xffff
    v_cmp_le_i32 vcc, 0, v2
    s_nop 1
    v_cndmask_b32 v236, 0, v3, vcc
    v_cmp_lt_i32 vcc, 0, v2
    s_nop 1
    v_cndmask_b32 v236, v236, -1, vcc
    v_cmp_le_i32 vcc, 2, v2
    s_nop 1
    v_cndmask_b32 v237, 0, v3, vcc
    v_cmp_lt_i32 vcc, 2, v2
    s_nop 1
    v_cndmask_b32 v237, v237, -1, vcc
    v_cmp_le_i32 vcc, 4, v2
    s_nop 1
    v_cndmask_b32 v238, 0, v3, vcc
    v_cmp_lt_i32 vcc, 4, v2
    s_nop 1
    v_cndmask_b32 v238, v238, -1, vcc
    v_cmp_le_i32 vcc, 6, v2
    s_nop 1
    v_cndmask_b32 v239, 0, v3, vcc
    v_cmp_lt_i32 vcc, 6, v2
    s_nop 1
    v_cndmask_b32 v239, v239, -1, vcc
    s_bfe_u32 s94, s3, 0x10001
    v_and_b32 v2, 15, v0
    v_lshrrev_b32 v3, 4, v0
    v_and_b32 v4, 1, v0
    v_lshlrev_b32 v5, 3, v3
    v_sub_u32 v5, v5, v2
    v_add_u32 v5, v5, v4
    v_lshlrev_b32 v5, 1, v5
    v_xor_b32 v4, 1, v4
    v_mul_u32_u24 v4, 4160, v4
    v_add_u32 v5, v5, v4
    s_mul_i32 s4, s51, 8320
    s_lshl_b32 s5, s94, 6
    s_sub_u32 s4, s4, s5
    s_add_u32 s5, s4, 101468
    v_add_u32 v56, s5, v5
    s_add_u32 s5, s4, 100444
    v_add_u32 v57, s5, v5
    s_add_u32 s5, s4, 99420
    v_add_u32 v58, s5, v5
    s_add_u32 s5, s4, 98396
    v_add_u32 v59, s5, v5
    s_and_b32 s4, s2, 7
    s_lshr_b32 s5, s2, 3
    s_and_b32 s80, s5, 3
    s_mul_i32 s82, s80, 7
    s_lshl_b32 s4, s4, 2
    s_add_u32 s80, s80, s4
    s_lshr_b32 s81, s5, 2
    s_mul_i32 s4, s81, 7
    s_lshr_b32 s4, s4, 1
    s_add_u32 s82, s82, s4
    s_sub_u32 s4, s82, 28
    s_cmp_ge_u32 s82, 28
    s_cselect_b32 s82, s4, s82
    s_lshr_b32 s82, s80, 2
    s_mul_i32 s82, s82, 7
    s_lshr_b32 s82, s82, 2
    s_and_b32 s4, s80, 1
    s_mul_i32 s4, s4, 14
    s_add_u32 s82, s82, s4
    s_and_b32 s83, s3, 1
    s_bfe_u32 s84, s3, 0x10001
    s_lshr_b32 s85, s3, 2
    s_lshl_b32 s85, s85, 1
    s_add_u32 s85, s85, s83
    v_lshrrev_b32 v3, 3, v0
    v_and_b32 v4, 7, v0
    v_bfe_u32 v5, v0, 4, 1
    v_lshlrev_b32 v5, 2, v5
    v_xor_b32 v4, v4, v5
    v_lshlrev_b32 v4, 4, v4
    v_lshl_add_u32 v240, v3, 10, v4
    v_lshl_add_u32 v253, v3, 12, v4
    v_lshrrev_b32 v3, 5, v0
    v_bfe_u32 v4, v0, 4, 1
    v_bfe_u32 v5, v0, 2, 2
    v_and_b32 v6, 3, v0
    v_lshlrev_b32 v6, 3, v6
    v_lshl_add_u32 v6, v4, 5, v6
    v_bfe_u32 v7, v0, 3, 1
    v_lshlrev_b32 v7, 6, v7
    v_xor_b32 v6, v6, v7
    v_lshl_add_u32 v7, v3, 2, v5
    v_lshl_add_u32 v7, v7, 7, v6
    s_lshl_b32 s4, s83, 12
    v_add_u32 v241, s4, v7
    s_lshl_b32 s4, s85, 5
    v_xor_b32 v241, s4, v241
    v_xor_b32 v242, 64, v241
    v_add_u32 v244, 114944, v241
    v_add_u32 v245, 114944, v242
    v_lshl_add_u32 v7, v3, 2, v5
    s_lshl_b32 s4, s84, 6
    v_xor_b32 v6, s4, v6
    v_lshl_add_u32 v7, v7, 7, v6
    s_lshl_b32 s4, s85, 11
    s_add_u32 s4, s4, 0
    v_add_u32 v243, s4, v7
    s_lshl_b32 s4, s80, 6
    s_lshl_b32 s5, s84, 5
    s_add_u32 s4, s4, s5
    v_and_b32 v2, 31, v0
    v_add_u32 v246, s4, v2
    v_lshlrev_b32 v247, 4, v0
    v_mov_b32 v248, 0
    v_lshlrev_b32 v249, 20, v0
    v_mov_b32 v252, 1
    s_mov_b32 s60, s40
    s_and_b32 s61, s41, 0xffff
    s_mov_b32 s62, 1835008
    s_mov_b32 s63, 0x00020000
    s_lshr_b32 s5, s2, 3
    s_and_b32 s55, s5, 1
    s_mul_i32 s79, s5, 57344
    s_mul_i32 s5, s51, 28672
    s_add_u32 s79, s79, s5
    v_min_u32 v233, 55, v0
    v_lshlrev_b32 v233, 7, v233
    v_and_b32 v234, 31, v0
    v_lshlrev_b32 v235, 2, v234
    s_lshl_b32 s79, s2, 1
    s_add_u32 s79, s79, s51
    s_mul_i32 s79, s79, 3584
    v_min_u32 v233, 27, v0
    v_lshlrev_b32 v233, 7, v233
    s_add_u32 s77, s14, 1
    s_and_b32 s77, s77, 7
    s_lshl_b32 s78, s77, 7
    s_add_u32 s78, s78, s72
    s_add_u32 m0, s74, 81920
    s_add_u32 s76, s78, 0
    buffer_load_dwordx4 v224, s[64:67], s76 offen lds
    s_add_u32 m0, s74, 82944
    s_add_u32 s76, s78, 8192
    buffer_load_dwordx4 v225, s[64:67], s76 offen lds
    s_add_u32 m0, s74, 83968
    s_add_u32 s76, s78, 16384
    buffer_load_dwordx4 v224, s[64:67], s76 offen lds
    s_add_u32 m0, s74, 84992
    s_add_u32 s76, s78, 24576
    buffer_load_dwordx4 v225, s[64:67], s76 offen lds
    s_add_u32 m0, s74, 90112
    s_add_u32 s76, s78, 65536
    buffer_load_dwordx4 v224, s[64:67], s76 offen lds
    s_add_u32 m0, s74, 91136
    s_add_u32 s76, s78, 73728
    buffer_load_dwordx4 v225, s[64:67], s76 offen lds
    s_add_u32 m0, s74, 92160
    s_add_u32 s76, s78, 81920
    buffer_load_dwordx4 v224, s[64:67], s76 offen lds
    s_add_u32 m0, s74, 93184
    s_add_u32 s76, s78, 90112
    buffer_load_dwordx4 v225, s[64:67], s76 offen lds
    s_barrier
    s_mul_i32 s76, s77, 229376
    s_add_u32 s76, s76, s73
    s_add_u32 m0, s75, 49152
    s_nop 0
    buffer_load_dwordx4 v226, s[68:71], s76 offen lds
    s_add_u32 m0, s75, 50176
    s_add_u32 s76, s76, 14336
    buffer_load_dwordx4 v226, s[68:71], s76 offen lds
    s_add_u32 m0, s75, 51200
    s_add_u32 s76, s76, 14336
    buffer_load_dwordx4 v227, s[68:71], s76 offen lds
    s_add_u32 m0, s75, 52224
    s_add_u32 s76, s76, 14336
    buffer_load_dwordx4 v227, s[68:71], s76 offen lds
    s_add_u32 m0, s75, 53248
    s_add_u32 s76, s76, 14336
    buffer_load_dwordx4 v226, s[68:71], s76 offen lds
    s_add_u32 m0, s75, 54272
    s_add_u32 s76, s76, 14336
    buffer_load_dwordx4 v226, s[68:71], s76 offen lds
    s_add_u32 m0, s75, 55296
    s_add_u32 s76, s76, 14336
    buffer_load_dwordx4 v227, s[68:71], s76 offen lds
    s_add_u32 m0, s75, 56320
    s_add_u32 s76, s76, 14336
    buffer_load_dwordx4 v227, s[68:71], s76 offen lds
    s_add_u32 m0, s75, 57344
    s_add_u32 s76, s76, 14336
    buffer_load_dwordx4 v226, s[68:71], s76 offen lds
    s_add_u32 m0, s75, 58368
    s_add_u32 s76, s76, 14336
    buffer_load_dwordx4 v226, s[68:71], s76 offen lds
    s_add_u32 m0, s75, 59392
    s_add_u32 s76, s76, 14336
    buffer_load_dwordx4 v227, s[68:71], s76 offen lds
    s_add_u32 m0, s75, 60416
    s_add_u32 s76, s76, 14336
    buffer_load_dwordx4 v227, s[68:71], s76 offen lds
    s_add_u32 m0, s75, 61440
    s_add_u32 s76, s76, 14336
    buffer_load_dwordx4 v226, s[68:71], s76 offen lds
    s_add_u32 m0, s75, 62464
    s_add_u32 s76, s76, 14336
    buffer_load_dwordx4 v226, s[68:71], s76 offen lds
    s_add_u32 m0, s75, 63488
    s_add_u32 s76, s76, 14336
    buffer_load_dwordx4 v227, s[68:71], s76 offen lds
    s_add_u32 m0, s75, 64512
    s_add_u32 s76, s76, 14336
    buffer_load_dwordx4 v227, s[68:71], s76 offen lds
    buffer_load_dword v230, v231, s[56:59], 0 offen sc1
    s_waitcnt vmcnt(25)
    s_barrier
    s_add_u32 s77, s14, 2
    s_and_b32 s77, s77, 7
    s_lshl_b32 s78, s77, 7
    s_add_u32 s78, s78, s72
    s_add_u32 m0, s74, 131072
    s_add_u32 s76, s78, 0
    buffer_load_dwordx4 v224, s[64:67], s76 offen lds
    s_add_u32 m0, s74, 132096
    s_add_u32 s76, s78, 8192
    buffer_load_dwordx4 v225, s[64:67], s76 offen lds
    s_add_u32 m0, s74, 133120
    s_add_u32 s76, s78, 16384
    buffer_load_dwordx4 v224, s[64:67], s76 offen lds
    s_add_u32 m0, s74, 134144
    s_add_u32 s76, s78, 24576
    buffer_load_dwordx4 v225, s[64:67], s76 offen lds
    s_add_u32 m0, s74, 139264
    s_add_u32 s76, s78, 65536
    buffer_load_dwordx4 v224, s[64:67], s76 offen lds
    s_add_u32 m0, s74, 140288
    s_add_u32 s76, s78, 73728
    buffer_load_dwordx4 v225, s[64:67], s76 offen lds
    s_add_u32 m0, s74, 141312
    s_add_u32 s76, s78, 81920
    buffer_load_dwordx4 v224, s[64:67], s76 offen lds
    s_add_u32 m0, s74, 142336
    s_add_u32 s76, s78, 90112
    buffer_load_dwordx4 v225, s[64:67], s76 offen lds
    s_mul_i32 s76, s77, 229376
    s_add_u32 s76, s76, s73
    s_add_u32 m0, s75, 98304
    s_nop 0
    buffer_load_dwordx4 v226, s[68:71], s76 offen lds
    s_add_u32 m0, s75, 99328
    s_add_u32 s76, s76, 14336
    buffer_load_dwordx4 v226, s[68:71], s76 offen lds
    s_add_u32 m0, s75, 100352
    s_add_u32 s76, s76, 14336
    buffer_load_dwordx4 v227, s[68:71], s76 offen lds
    s_add_u32 m0, s75, 101376
    s_add_u32 s76, s76, 14336
    buffer_load_dwordx4 v227, s[68:71], s76 offen lds
    s_add_u32 m0, s75, 102400
    s_add_u32 s76, s76, 14336
    buffer_load_dwordx4 v226, s[68:71], s76 offen lds
    s_add_u32 m0, s75, 103424
    s_add_u32 s76, s76, 14336
    buffer_load_dwordx4 v226, s[68:71], s76 offen lds
    s_add_u32 m0, s75, 104448
    s_add_u32 s76, s76, 14336
    buffer_load_dwordx4 v227, s[68:71], s76 offen lds
    s_add_u32 m0, s75, 105472
    s_add_u32 s76, s76, 14336
    buffer_load_dwordx4 v227, s[68:71], s76 offen lds
    s_add_u32 m0, s75, 106496
    s_add_u32 s76, s76, 14336
    buffer_load_dwordx4 v226, s[68:71], s76 offen lds
    s_add_u32 m0, s75, 107520
    s_add_u32 s76, s76, 14336
    buffer_load_dwordx4 v226, s[68:71], s76 offen lds
    s_add_u32 m0, s75, 108544
    s_add_u32 s76, s76, 14336
    buffer_load_dwordx4 v227, s[68:71], s76 offen lds
    s_add_u32 m0, s75, 109568
    s_add_u32 s76, s76, 14336
    buffer_load_dwordx4 v227, s[68:71], s76 offen lds
    s_add_u32 m0, s75, 110592
    s_add_u32 s76, s76, 14336
    buffer_load_dwordx4 v226, s[68:71], s76 offen lds
    s_add_u32 m0, s75, 111616
    s_add_u32 s76, s76, 14336
    buffer_load_dwordx4 v226, s[68:71], s76 offen lds
    s_add_u32 m0, s75, 112640
    s_add_u32 s76, s76, 14336
    buffer_load_dwordx4 v227, s[68:71], s76 offen lds
    s_add_u32 m0, s75, 113664
    s_add_u32 s76, s76, 14336
    buffer_load_dwordx4 v227, s[68:71], s76 offen lds
    s_waitcnt vmcnt(24)
    v_readfirstlane_b32 s15, v230
    s_mov_b32 s5, 0
    s_cmp_lg_u32 s15, 0
    s_cbranch_scc1 L_epok
L_eppoll:
    buffer_load_dword v230, v231, s[56:59], 0 offen sc1
    s_add_u32 s5, s5, 1
    s_cmp_gt_u32 s5, 400000
    s_cbranch_scc1 L_epok
    s_waitcnt vmcnt(0)
    v_readfirstlane_b32 s15, v230
    s_cmp_eq_u32 s15, 0
    s_cbranch_scc1 L_eppoll
L_epok:
    v_mov_b32 v250, v230
    s_add_u32 s56, s48, 14745600
    s_addc_u32 s57, s49, 0
    s_and_b32 s57, s57, 0xffff
    s_mov_b32 s58, 131072
    s_mov_b32 s59, 0x00020000
    s_lshr_b32 s54, s50, 5
    s_lshl_b32 s54, s54, 8
    s_add_u32 s54, s54, 98304
    s_waitcnt lgkmcnt(0)
    s_barrier
    s_add_u32 s77, s14, 3
    s_and_b32 s77, s77, 7
    s_lshl_b32 s78, s77, 7
    s_add_u32 s78, s78, s72
    s_add_u32 m0, s74, 32768
    s_add_u32 s76, s78, 0
    buffer_load_dwordx4 v224, s[64:67], s76 offen lds
    s_add_u32 m0, s74, 33792
    s_add_u32 s76, s78, 8192
    buffer_load_dwordx4 v225, s[64:67], s76 offen lds
    s_add_u32 m0, s74, 34816
    s_add_u32 s76, s78, 16384
    buffer_load_dwordx4 v224, s[64:67], s76 offen lds
    s_add_u32 m0, s74, 35840
    s_add_u32 s76, s78, 24576
    buffer_load_dwordx4 v225, s[64:67], s76 offen lds
    s_add_u32 m0, s74, 40960
    s_add_u32 s76, s78, 65536
    buffer_load_dwordx4 v224, s[64:67], s76 offen lds
    s_add_u32 m0, s74, 41984
    s_add_u32 s76, s78, 73728
    buffer_load_dwordx4 v225, s[64:67], s76 offen lds
    s_add_u32 m0, s74, 43008
    s_add_u32 s76, s78, 81920
    buffer_load_dwordx4 v224, s[64:67], s76 offen lds
    s_add_u32 m0, s74, 44032
    s_add_u32 s76, s78, 90112
    buffer_load_dwordx4 v225, s[64:67], s76 offen lds
    s_mul_i32 s76, s77, 229376
    s_add_u32 s76, s76, s73
    s_add_u32 m0, s75, 0
    s_nop 0
    buffer_load_dwordx4 v226, s[68:71], s76 offen lds
    s_add_u32 m0, s75, 1024
    s_add_u32 s76, s76, 14336
    buffer_load_dwordx4 v226, s[68:71], s76 offen lds
    s_add_u32 m0, s75, 2048
    s_add_u32 s76, s76, 14336
    buffer_load_dwordx4 v227, s[68:71], s76 offen lds
    s_add_u32 m0, s75, 3072
    s_add_u32 s76, s76, 14336
    buffer_load_dwordx4 v227, s[68:71], s76 offen lds
    s_add_u32 m0, s75, 4096
    s_add_u32 s76, s76, 14336
    buffer_load_dwordx4 v226, s[68:71], s76 offen lds
    s_add_u32 m0, s75, 5120
    s_add_u32 s76, s76, 14336
    buffer_load_dwordx4 v226, s[68:71], s76 offen lds
    s_add_u32 m0, s75, 6144
    s_add_u32 s76, s76, 14336
    buffer_load_dwordx4 v227, s[68:71], s76 offen lds
    s_add_u32 m0, s75, 7168
    s_add_u32 s76, s76, 14336
    buffer_load_dwordx4 v227, s[68:71], s76 offen lds
    s_add_u32 m0, s75, 8192
    s_add_u32 s76, s76, 14336
    buffer_load_dwordx4 v226, s[68:71], s76 offen lds
    s_add_u32 m0, s75, 9216
    s_add_u32 s76, s76, 14336
    buffer_load_dwordx4 v226, s[68:71], s76 offen lds
    s_add_u32 m0, s75, 10240
    s_add_u32 s76, s76, 14336
    buffer_load_dwordx4 v227, s[68:71], s76 offen lds
    s_add_u32 m0, s75, 11264
    s_add_u32 s76, s76, 14336
    buffer_load_dwordx4 v227, s[68:71], s76 offen lds
    s_add_u32 m0, s75, 12288
    s_add_u32 s76, s76, 14336
    buffer_load_dwordx4 v226, s[68:71], s76 offen lds
    s_add_u32 m0, s75, 13312
    s_add_u32 s76, s76, 14336
    buffer_load_dwordx4 v226, s[68:71], s76 offen lds
    s_add_u32 m0, s75, 14336
    s_add_u32 s76, s76, 14336
    buffer_load_dwordx4 v227, s[68:71], s76 offen lds
    s_add_u32 m0, s75, 15360
    s_add_u32 s76, s76, 14336
    buffer_load_dwordx4 v227, s[68:71], s76 offen lds
    s_waitcnt vmcnt(24)
    s_barrier
    s_add_u32 s77, s14, 4
    s_and_b32 s77, s77, 7
    s_lshl_b32 s78, s77, 7
    s_add_u32 s78, s78, s72
    s_add_u32 m0, s74, 81920
    s_add_u32 s76, s78, 0
    buffer_load_dwordx4 v224, s[64:67], s76 offen lds
    s_add_u32 m0, s74, 82944
    s_add_u32 s76, s78, 8192
    buffer_load_dwordx4 v225, s[64:67], s76 offen lds
    s_add_u32 m0, s74, 83968
    s_add_u32 s76, s78, 16384
    buffer_load_dwordx4 v224, s[64:67], s76 offen lds
    s_add_u32 m0, s74, 84992
    s_add_u32 s76, s78, 24576
    buffer_load_dwordx4 v225, s[64:67], s76 offen lds
    s_add_u32 m0, s74, 90112
    s_add_u32 s76, s78, 65536
    buffer_load_dwordx4 v224, s[64:67], s76 offen lds
    s_add_u32 m0, s74, 91136
    s_add_u32 s76, s78, 73728
    buffer_load_dwordx4 v225, s[64:67], s76 offen lds
    s_add_u32 m0, s74, 92160
    s_add_u32 s76, s78, 81920
    buffer_load_dwordx4 v224, s[64:67], s76 offen lds
    s_add_u32 m0, s74, 93184
    s_add_u32 s76, s78, 90112
    buffer_load_dwordx4 v225, s[64:67], s76 offen lds
    s_mul_i32 s76, s77, 229376
    s_add_u32 s76, s76, s73
    s_add_u32 m0, s75, 49152
    s_nop 0
    buffer_load_dwordx4 v226, s[68:71], s76 offen lds
    s_add_u32 m0, s75, 50176
    s_add_u32 s76, s76, 14336
    buffer_load_dwordx4 v226, s[68:71], s76 offen lds
    s_add_u32 m0, s75, 51200
    s_add_u32 s76, s76, 14336
    buffer_load_dwordx4 v227, s[68:71], s76 offen lds
    s_add_u32 m0, s75, 52224
    s_add_u32 s76, s76, 14336
    buffer_load_dwordx4 v227, s[68:71], s76 offen lds
    s_add_u32 m0, s75, 53248
    s_add_u32 s76, s76, 14336
    buffer_load_dwordx4 v226, s[68:71], s76 offen lds
    s_add_u32 m0, s75, 54272
    s_add_u32 s76, s76, 14336
    buffer_load_dwordx4 v226, s[68:71], s76 offen lds
    s_add_u32 m0, s75, 55296
    s_add_u32 s76, s76, 14336
    buffer_load_dwordx4 v227, s[68:71], s76 offen lds
    s_add_u32 m0, s75, 56320
    s_add_u32 s76, s76, 14336
    buffer_load_dwordx4 v227, s[68:71], s76 offen lds
    s_add_u32 m0, s75, 57344
    s_add_u32 s76, s76, 14336
    buffer_load_dwordx4 v226, s[68:71], s76 offen lds
    s_add_u32 m0, s75, 58368
    s_add_u32 s76, s76, 14336
    buffer_load_dwordx4 v226, s[68:71], s76 offen lds
    s_add_u32 m0, s75, 59392
    s_add_u32 s76, s76, 14336
    buffer_load_dwordx4 v227, s[68:71], s76 offen lds
    s_add_u32 m0, s75, 60416
    s_add_u32 s76, s76, 14336
    buffer_load_dwordx4 v227, s[68:71], s76 offen lds
    s_add_u32 m0, s75, 61440
    s_add_u32 s76, s76, 14336
    buffer_load_dwordx4 v226, s[68:71], s76 offen lds
    s_add_u32 m0, s75, 62464
    s_add_u32 s76, s76, 14336
    buffer_load_dwordx4 v226, s[68:71], s76 offen lds
    s_add_u32 m0, s75, 63488
    s_add_u32 s76, s76, 14336
    buffer_load_dwordx4 v227, s[68:71], s76 offen lds
    s_add_u32 m0, s75, 64512
    s_add_u32 s76, s76, 14336
    buffer_load_dwordx4 v227, s[68:71], s76 offen lds
    s_waitcnt vmcnt(24)
    s_barrier
    s_add_u32 s77, s14, 5
    s_and_b32 s77, s77, 7
    s_lshl_b32 s78, s77, 7
    s_add_u32 s78, s78, s72
    s_add_u32 m0, s74, 131072
    s_add_u32 s76, s78, 0
    buffer_load_dwordx4 v224, s[64:67], s76 offen lds
    s_add_u32 m0, s74, 132096
    s_add_u32 s76, s78, 8192
    buffer_load_dwordx4 v225, s[64:67], s76 offen lds
    s_add_u32 m0, s74, 133120
    s_add_u32 s76, s78, 16384
    buffer_load_dwordx4 v224, s[64:67], s76 offen lds
    s_add_u32 m0, s74, 134144
    s_add_u32 s76, s78, 24576
    buffer_load_dwordx4 v225, s[64:67], s76 offen lds
    s_add_u32 m0, s74, 139264
    s_add_u32 s76, s78, 65536
    buffer_load_dwordx4 v224, s[64:67], s76 offen lds
    s_add_u32 m0, s74, 140288
    s_add_u32 s76, s78, 73728
    buffer_load_dwordx4 v225, s[64:67], s76 offen lds
    s_add_u32 m0, s74, 141312
    s_add_u32 s76, s78, 81920
    buffer_load_dwordx4 v224, s[64:67], s76 offen lds
    s_add_u32 m0, s74, 142336
    s_add_u32 s76, s78, 90112
    buffer_load_dwordx4 v225, s[64:67], s76 offen lds
    s_mul_i32 s76, s77, 229376
    s_add_u32 s76, s76, s73
    s_add_u32 m0, s75, 98304
    s_nop 0
    buffer_load_dwordx4 v226, s[68:71], s76 offen lds
    s_add_u32 m0, s75, 99328
    s_add_u32 s76, s76, 14336
    buffer_load_dwordx4 v226, s[68:71], s76 offen lds
    s_add_u32 m0, s75, 100352
    s_add_u32 s76, s76, 14336
    buffer_load_dwordx4 v227, s[68:71], s76 offen lds
    s_add_u32 m0, s75, 101376
    s_add_u32 s76, s76, 14336
    buffer_load_dwordx4 v227, s[68:71], s76 offen lds
    s_add_u32 m0, s75, 102400
    s_add_u32 s76, s76, 14336
    buffer_load_dwordx4 v226, s[68:71], s76 offen lds
    s_add_u32 m0, s75, 103424
    s_add_u32 s76, s76, 14336
    buffer_load_dwordx4 v226, s[68:71], s76 offen lds
    s_add_u32 m0, s75, 104448
    s_add_u32 s76, s76, 14336
    buffer_load_dwordx4 v227, s[68:71], s76 offen lds
    s_add_u32 m0, s75, 105472
    s_add_u32 s76, s76, 14336
    buffer_load_dwordx4 v227, s[68:71], s76 offen lds
    s_add_u32 m0, s75, 106496
    s_add_u32 s76, s76, 14336
    buffer_load_dwordx4 v226, s[68:71], s76 offen lds
    s_add_u32 m0, s75, 107520
    s_add_u32 s76, s76, 14336
    buffer_load_dwordx4 v226, s[68:71], s76 offen lds
    s_add_u32 m0, s75, 108544
    s_add_u32 s76, s76, 14336
    buffer_load_dwordx4 v227, s[68:71], s76 offen lds
    s_add_u32 m0, s75, 109568
    s_add_u32 s76, s76, 14336
    buffer_load_dwordx4 v227, s[68:71], s76 offen lds
    s_add_u32 m0, s75, 110592
    s_add_u32 s76, s76, 14336
    buffer_load_dwordx4 v226, s[68:71], s76 offen lds
    s_add_u32 m0, s75, 111616
    s_add_u32 s76, s76, 14336
    buffer_load_dwordx4 v226, s[68:71], s76 offen lds
    s_add_u32 m0, s75, 112640
    s_add_u32 s76, s76, 14336
    buffer_load_dwordx4 v227, s[68:71], s76 offen lds
    s_add_u32 m0, s75, 113664
    s_add_u32 s76, s76, 14336
    buffer_load_dwordx4 v227, s[68:71], s76 offen lds
    buffer_load_dword v255, v233, s[60:63], s79 offen
    s_waitcnt vmcnt(25)
    s_barrier
    s_add_u32 s77, s14, 6
    s_and_b32 s77, s77, 7
    s_lshl_b32 s78, s77, 7
    s_add_u32 s78, s78, s72
    s_add_u32 m0, s74, 32768
    s_add_u32 s76, s78, 0
    buffer_load_dwordx4 v224, s[64:67], s76 offen lds
    s_add_u32 m0, s74, 33792
    s_add_u32 s76, s78, 8192
    buffer_load_dwordx4 v225, s[64:67], s76 offen lds
    s_add_u32 m0, s74, 34816
    s_add_u32 s76, s78, 16384
    buffer_load_dwordx4 v224, s[64:67], s76 offen lds
    s_add_u32 m0, s74, 35840
    s_add_u32 s76, s78, 24576
    buffer_load_dwordx4 v225, s[64:67], s76 offen lds
    s_add_u32 m0, s74, 40960
    s_add_u32 s76, s78, 65536
    buffer_load_dwordx4 v224, s[64:67], s76 offen lds
    s_add_u32 m0, s74, 41984
    s_add_u32 s76, s78, 73728
    buffer_load_dwordx4 v225, s[64:67], s76 offen lds
    s_add_u32 m0, s74, 43008
    s_add_u32 s76, s78, 81920
    buffer_load_dwordx4 v224, s[64:67], s76 offen lds
    s_add_u32 m0, s74, 44032
    s_add_u32 s76, s78, 90112
    buffer_load_dwordx4 v225, s[64:67], s76 offen lds
    s_mul_i32 s76, s77, 229376
    s_add_u32 s76, s76, s73
    s_add_u32 m0, s75, 0
    s_nop 0
    buffer_load_dwordx4 v226, s[68:71], s76 offen lds
    s_add_u32 m0, s75, 1024
    s_add_u32 s76, s76, 14336
    buffer_load_dwordx4 v226, s[68:71], s76 offen lds
    s_add_u32 m0, s75, 2048
    s_add_u32 s76, s76, 14336
    buffer_load_dwordx4 v227, s[68:71], s76 offen lds
    s_add_u32 m0, s75, 3072
    s_add_u32 s76, s76, 14336
    buffer_load_dwordx4 v227, s[68:71], s76 offen lds
    s_add_u32 m0, s75, 4096
    s_add_u32 s76, s76, 14336
    buffer_load_dwordx4 v226, s[68:71], s76 offen lds
    s_add_u32 m0, s75, 5120
    s_add_u32 s76, s76, 14336
    buffer_load_dwordx4 v226, s[68:71], s76 offen lds
    s_add_u32 m0, s75, 6144
    s_add_u32 s76, s76, 14336
    buffer_load_dwordx4 v227, s[68:71], s76 offen lds
    s_add_u32 m0, s75, 7168
    s_add_u32 s76, s76, 14336
    buffer_load_dwordx4 v227, s[68:71], s76 offen lds
    s_add_u32 m0, s75, 8192
    s_add_u32 s76, s76, 14336
    buffer_load_dwordx4 v226, s[68:71], s76 offen lds
    s_add_u32 m0, s75, 9216
    s_add_u32 s76, s76, 14336
    buffer_load_dwordx4 v226, s[68:71], s76 offen lds
    s_add_u32 m0, s75, 10240
    s_add_u32 s76, s76, 14336
    buffer_load_dwordx4 v227, s[68:71], s76 offen lds
    s_add_u32 m0, s75, 11264
    s_add_u32 s76, s76, 14336
    buffer_load_dwordx4 v227, s[68:71], s76 offen lds
    s_add_u32 m0, s75, 12288
    s_add_u32 s76, s76, 14336
    buffer_load_dwordx4 v226, s[68:71], s76 offen lds
    s_add_u32 m0, s75, 13312
    s_add_u32 s76, s76, 14336
    buffer_load_dwordx4 v226, s[68:71], s76 offen lds
    s_add_u32 m0, s75, 14336
    s_add_u32 s76, s76, 14336
    buffer_load_dwordx4 v227, s[68:71], s76 offen lds
    s_add_u32 m0, s75, 15360
    s_add_u32 s76, s76, 14336
    buffer_load_dwordx4 v227, s[68:71], s76 offen lds
    buffer_load_dword v230, v235, s[56:59], s54 offen sc1
    s_waitcnt vmcnt(26)
    s_barrier
    s_add_u32 s77, s14, 7
    s_and_b32 s77, s77, 7
    s_lshl_b32 s78, s77, 7
    s_add_u32 s78, s78, s72
    s_add_u32 m0, s74, 81920
    s_add_u32 s76, s78, 0
    buffer_load_dwordx4 v224, s[64:67], s76 offen lds
    s_add_u32 m0, s74, 82944
    s_add_u32 s76, s78, 8192
    buffer_load_dwordx4 v225, s[64:67], s76 offen lds
    s_add_u32 m0, s74, 83968
    s_add_u32 s76, s78, 16384
    buffer_load_dwordx4 v224, s[64:67], s76 offen lds
    s_add_u32 m0, s74, 84992
    s_add_u32 s76, s78, 24576
    buffer_load_dwordx4 v225, s[64:67], s76 offen lds
    s_add_u32 m0, s74, 90112
    s_add_u32 s76, s78, 65536
    buffer_load_dwordx4 v224, s[64:67], s76 offen lds
    s_add_u32 m0, s74, 91136
    s_add_u32 s76, s78, 73728
    buffer_load_dwordx4 v225, s[64:67], s76 offen lds
    s_add_u32 m0, s74, 92160
    s_add_u32 s76, s78, 81920
    buffer_load_dwordx4 v224, s[64:67], s76 offen lds
    s_add_u32 m0, s74, 93184
    s_add_u32 s76, s78, 90112
    buffer_load_dwordx4 v225, s[64:67], s76 offen lds
    s_mul_i32 s76, s77, 229376
    s_add_u32 s76, s76, s73
    s_add_u32 m0, s75, 49152
    s_nop 0
    buffer_load_dwordx4 v226, s[68:71], s76 offen lds
    s_add_u32 m0, s75, 50176
    s_add_u32 s76, s76, 14336
    buffer_load_dwordx4 v226, s[68:71], s76 offen lds
    s_add_u32 m0, s75, 51200
    s_add_u32 s76, s76, 14336
    buffer_load_dwordx4 v227, s[68:71], s76 offen lds
    s_add_u32 m0, s75, 52224
    s_add_u32 s76, s76, 14336
    buffer_load_dwordx4 v227, s[68:71], s76 offen lds
    s_add_u32 m0, s75, 53248
    s_add_u32 s76, s76, 14336
    buffer_load_dwordx4 v226, s[68:71], s76 offen lds
    s_add_u32 m0, s75, 54272
    s_add_u32 s76, s76, 14336
    buffer_load_dwordx4 v226, s[68:71], s76 offen lds
    s_add_u32 m0, s75, 55296
    s_add_u32 s76, s76, 14336
    buffer_load_dwordx4 v227, s[68:71], s76 offen lds
    s_add_u32 m0, s75, 56320
    s_add_u32 s76, s76, 14336
    buffer_load_dwordx4 v227, s[68:71], s76 offen lds
    s_add_u32 m0, s75, 57344
    s_add_u32 s76, s76, 14336
    buffer_load_dwordx4 v226, s[68:71], s76 offen lds
    s_add_u32 m0, s75, 58368
    s_add_u32 s76, s76, 14336
    buffer_load_dwordx4 v226, s[68:71], s76 offen lds
    s_add_u32 m0, s75, 59392
    s_add_u32 s76, s76, 14336
    buffer_load_dwordx4 v227, s[68:71], s76 offen lds
    s_add_u32 m0, s75, 60416
    s_add_u32 s76, s76, 14336
    buffer_load_dwordx4 v227, s[68:71], s76 offen lds
    s_add_u32 m0, s75, 61440
    s_add_u32 s76, s76, 14336
    buffer_load_dwordx4 v226, s[68:71], s76 offen lds
    s_add_u32 m0, s75, 62464
    s_add_u32 s76, s76, 14336
    buffer_load_dwordx4 v226, s[68:71], s76 offen lds
    s_add_u32 m0, s75, 63488
    s_add_u32 s76, s76, 14336
    buffer_load_dwordx4 v227, s[68:71], s76 offen lds
    s_add_u32 m0, s75, 64512
    s_add_u32 s76, s76, 14336
    buffer_load_dwordx4 v227, s[68:71], s76 offen lds
    s_add_u32 s60, s48, 16777216
    s_addc_u32 s61, s49, 0
    s_and_b32 s61, s61, 0xffff
    s_mov_b32 s62, 2162688
    s_mov_b32 s63, 0x00020000
    s_add_u32 s7, s50, s51
    s_mul_i32 s7, s7, 4224
    s_mul_i32 s6, s51, 8320
    s_waitcnt vmcnt(24)
    s_mov_b32 s68, s40
    s_and_b32 s69, s41, 0xffff
    s_mov_b32 s70, 1835008
    s_mov_b32 s71, 0x00020000
    s_lshl_b32 s72, s81, 7
    s_lshl_b32 s4, s51, 15
    s_add_u32 s72, s72, s4
    s_lshl_b32 s73, s51, 12
    s_barrier
    s_mov_b32 s5, 0
    v_cmp_ne_u32 vcc, s15, v230
    s_cbranch_vccz L_upoll_done
L_upoll:
    buffer_load_dword v230, v235, s[56:59], s54 offen sc1
    s_add_u32 s5, s5, 1
    s_cmp_gt_u32 s5, 400000
    s_cbranch_scc1 L_upoll_done
    s_waitcnt vmcnt(0)
    v_cmp_ne_u32 vcc, s15, v230
    s_cbranch_vccnz L_upoll
L_upoll_done:
    s_add_u32 m0, s6, 98304
    s_add_u32 s76, s7, 0
    buffer_load_dwordx4 v247, s[60:63], s76 offen sc1 lds
    s_add_u32 m0, s6, 99328
    s_add_u32 s76, s7, 1024
    buffer_load_dwordx4 v247, s[60:63], s76 offen sc1 lds
    s_add_u32 m0, s6, 100352
    s_add_u32 s76, s7, 2048
    buffer_load_dwordx4 v247, s[60:63], s76 offen sc1 lds
    s_add_u32 m0, s6, 101376
    s_add_u32 s76, s7, 3072
    buffer_load_dwordx4 v247, s[60:63], s76 offen sc1 lds
    s_add_u32 m0, s6, 102464
    s_add_u32 s76, s7, 2
    buffer_load_dwordx4 v247, s[60:63], s76 offen sc1 lds
    s_add_u32 m0, s6, 103488
    s_add_u32 s76, s7, 1026
    buffer_load_dwordx4 v247, s[60:63], s76 offen sc1 lds
    s_add_u32 m0, s6, 104512
    s_add_u32 s76, s7, 2050
    buffer_load_dwordx4 v247, s[60:63], s76 offen sc1 lds
    s_add_u32 m0, s6, 105536
    s_add_u32 s76, s7, 3074
    buffer_load_dwordx4 v247, s[60:63], s76 offen sc1 lds
    s_add_u32 s77, s82, 0
    s_sub_u32 s4, s77, 28
    s_cmp_ge_u32 s77, 28
    s_cselect_b32 s77, s4, s77
    s_lshl_b32 s77, s77, 16
    s_add_u32 s77, s77, s72
    s_add_u32 m0, s73, 114944
    s_nop 0
    buffer_load_dwordx4 v240, s[68:71], s77 offen lds
    s_add_u32 m0, s73, 115968
    s_add_u32 s77, s77, 8192
    buffer_load_dwordx4 v240, s[68:71], s77 offen lds
    s_add_u32 m0, s73, 116992
    s_add_u32 s77, s77, 8192
    buffer_load_dwordx4 v240, s[68:71], s77 offen lds
    s_add_u32 m0, s73, 118016
    s_add_u32 s77, s77, 8192
    buffer_load_dwordx4 v240, s[68:71], s77 offen lds
    s_add_u32 s77, s82, 1
    s_sub_u32 s4, s77, 28
    s_cmp_ge_u32 s77, 28
    s_cselect_b32 s77, s4, s77
    s_lshl_b32 s77, s77, 16
    s_add_u32 s77, s77, s72
    s_add_u32 m0, s73, 123136
    s_nop 0
    buffer_load_dwordx4 v240, s[68:71], s77 offen lds
    s_add_u32 m0, s73, 124160
    s_add_u32 s77, s77, 8192
    buffer_load_dwordx4 v240, s[68:71], s77 offen lds
    s_add_u32 m0, s73, 125184
    s_add_u32 s77, s77, 8192
    buffer_load_dwordx4 v240, s[68:71], s77 offen lds
    s_add_u32 m0, s73, 126208
    s_add_u32 s77, s77, 8192
    buffer_load_dwordx4 v240, s[68:71], s77 offen lds
    s_add_u32 s77, s82, 2
    s_sub_u32 s4, s77, 28
    s_cmp_ge_u32 s77, 28
    s_cselect_b32 s77, s4, s77
    s_lshl_b32 s77, s77, 16
    s_add_u32 s77, s77, s72
    s_add_u32 m0, s73, 131328
    s_nop 0
    buffer_load_dwordx4 v240, s[68:71], s77 offen lds
    s_add_u32 m0, s73, 132352
    s_add_u32 s77, s77, 8192
    buffer_load_dwordx4 v240, s[68:71], s77 offen lds
    s_add_u32 m0, s73, 133376
    s_add_u32 s77, s77, 8192
    buffer_load_dwordx4 v240, s[68:71], s77 offen lds
    s_add_u32 m0, s73, 134400
    s_add_u32 s77, s77, 8192
    buffer_load_dwordx4 v240, s[68:71], s77 offen lds
    s_add_u32 s77, s82, 3
    s_sub_u32 s4, s77, 28
    s_cmp_ge_u32 s77, 28
    s_cselect_b32 s77, s4, s77
    s_lshl_b32 s77, s77, 16
    s_add_u32 s77, s77, s72
    s_add_u32 m0, s73, 139520
    s_nop 0
    buffer_load_dwordx4 v240, s[68:71], s77 offen lds
    s_add_u32 m0, s73, 140544
    s_add_u32 s77, s77, 8192
    buffer_load_dwordx4 v240, s[68:71], s77 offen lds
    s_add_u32 m0, s73, 141568
    s_add_u32 s77, s77, 8192
    buffer_load_dwordx4 v240, s[68:71], s77 offen lds
    s_add_u32 m0, s73, 142592
    s_add_u32 s77, s77, 8192
    buffer_load_dwordx4 v240, s[68:71], s77 offen lds
    s_sub_u32 s6, s3, 4
    s_mov_b32 s68, s40
    s_and_b32 s69, s41, 0xffff
    s_mov_b32 s70, 1835008
    s_mov_b32 s71, 0x00020000
    s_lshl_b32 s72, s81, 7
    s_lshl_b32 s4, s6, 14
    s_add_u32 s72, s72, s4
    s_lshl_b32 s73, s6, 11
    s_waitcnt vmcnt(24)
    s_barrier
    s_add_u32 s77, s82, 4
    s_sub_u32 s4, s77, 28
    s_cmp_ge_u32 s77, 28
    s_cselect_b32 s77, s4, s77
    s_lshl_b32 s77, s77, 16
    s_add_u32 s77, s77, s72
    s_add_u32 m0, s73, 0
    s_nop 0
    buffer_load_dwordx4 v240, s[68:71], s77 offen lds
    s_add_u32 m0, s73, 1024
    s_add_u32 s77, s77, 8192
    buffer_load_dwordx4 v240, s[68:71], s77 offen lds
    s_add_u32 s77, s82, 5
    s_sub_u32 s4, s77, 28
    s_cmp_ge_u32 s77, 28
    s_cselect_b32 s77, s4, s77
    s_lshl_b32 s77, s77, 16
    s_add_u32 s77, s77, s72
    s_add_u32 m0, s73, 8192
    s_nop 0
    buffer_load_dwordx4 v240, s[68:71], s77 offen lds
    s_add_u32 m0, s73, 9216
    s_add_u32 s77, s77, 8192
    buffer_load_dwordx4 v240, s[68:71], s77 offen lds
    s_add_u32 s77, s82, 6
    s_sub_u32 s4, s77, 28
    s_cmp_ge_u32 s77, 28
    s_cselect_b32 s77, s4, s77
    s_lshl_b32 s77, s77, 16
    s_add_u32 s77, s77, s72
    s_add_u32 m0, s73, 16384
    s_nop 0
    buffer_load_dwordx4 v240, s[68:71], s77 offen lds
    s_add_u32 m0, s73, 17408
    s_add_u32 s77, s77, 8192
    buffer_load_dwordx4 v240, s[68:71], s77 offen lds
    s_add_u32 s77, s82, 7
    s_sub_u32 s4, s77, 28
    s_cmp_ge_u32 s77, 28
    s_cselect_b32 s77, s4, s77
    s_lshl_b32 s77, s77, 16
    s_add_u32 s77, s77, s72
    s_add_u32 m0, s73, 24576
    s_nop 0
    buffer_load_dwordx4 v240, s[68:71], s77 offen lds
    s_add_u32 m0, s73, 25600
    s_add_u32 s77, s77, 8192
    buffer_load_dwordx4 v240, s[68:71], s77 offen lds
    s_add_u32 s77, s82, 8
    s_sub_u32 s4, s77, 28
    s_cmp_ge_u32 s77, 28
    s_cselect_b32 s77, s4, s77
    s_lshl_b32 s77, s77, 16
    s_add_u32 s77, s77, s72
    s_add_u32 m0, s73, 32768
    s_nop 0
    buffer_load_dwordx4 v240, s[68:71], s77 offen lds
    s_add_u32 m0, s73, 33792
    s_add_u32 s77, s77, 8192
    buffer_load_dwordx4 v240, s[68:71], s77 offen lds
    s_add_u32 s77, s82, 9
    s_sub_u32 s4, s77, 28
    s_cmp_ge_u32 s77, 28
    s_cselect_b32 s77, s4, s77
    s_lshl_b32 s77, s77, 16
    s_add_u32 s77, s77, s72
    s_add_u32 m0, s73, 40960
    s_nop 0
    buffer_load_dwordx4 v240, s[68:71], s77 offen lds
    s_add_u32 m0, s73, 41984
    s_add_u32 s77, s77, 8192
    buffer_load_dwordx4 v240, s[68:71], s77 offen lds
    s_waitcnt vmcnt(28)
    s_barrier
L_conv:
    ds_read2_b32 v[64:65], v56 offset0:224 offset1:225
    ds_read2_b32 v[66:67], v56 offset0:226 offset1:227
    ds_read2_b32 v[68:69], v56 offset0:192 offset1:193
    ds_read2_b32 v[70:71], v56 offset0:194 offset1:195
    ds_read2_b32 v[72:73], v56 offset0:160 offset1:161
    ds_read2_b32 v[74:75], v56 offset0:162 offset1:163
    ds_read2_b32 v[76:77], v56 offset0:128 offset1:129
    ds_read2_b32 v[78:79], v56 offset0:130 offset1:131
    ds_read2_b32 v[80:81], v56 offset0:96 offset1:97
    ds_read2_b32 v[82:83], v56 offset0:98 offset1:99
    ds_read2_b32 v[84:85], v56 offset0:64 offset1:65
    ds_read2_b32 v[86:87], v56 offset0:66 offset1:67
    ds_read2_b32 v[88:89], v56 offset0:32 offset1:33
    ds_read2_b32 v[90:91], v56 offset0:34 offset1:35
    ds_read2_b32 v[92:93], v56 offset0:0 offset1:1
    ds_read2_b32 v[94:95], v56 offset0:2 offset1:3
    ds_read2_b32 v[96:97], v57 offset0:224 offset1:225
    ds_read2_b32 v[98:99], v57 offset0:226 offset1:227
    ds_read2_b32 v[100:101], v57 offset0:192 offset1:193
    ds_read2_b32 v[102:103], v57 offset0:194 offset1:195
    ds_read2_b32 v[104:105], v57 offset0:160 offset1:161
    ds_read2_b32 v[106:107], v57 offset0:162 offset1:163
    ds_read2_b32 v[108:109], v57 offset0:128 offset1:129
    ds_read2_b32 v[110:111], v57 offset0:130 offset1:131
    ds_read2_b32 v[112:113], v57 offset0:96 offset1:97
    ds_read2_b32 v[114:115], v57 offset0:98 offset1:99
    ds_read2_b32 v[116:117], v57 offset0:64 offset1:65
    ds_read2_b32 v[118:119], v57 offset0:66 offset1:67
    ds_read2_b32 v[120:121], v57 offset0:32 offset1:33
    ds_read2_b32 v[122:123], v57 offset0:34 offset1:35
    ds_read2_b32 v[124:125], v57 offset0:0 offset1:1
    ds_read2_b32 v[126:127], v57 offset0:2 offset1:3
    ds_read2_b32 v[128:129], v58 offset0:224 offset1:225
    ds_read2_b32 v[130:131], v58 offset0:226 offset1:227
    ds_read2_b32 v[132:133], v58 offset0:192 offset1:193
    ds_read2_b32 v[134:135], v58 offset0:194 offset1:195
    ds_read2_b32 v[136:137], v58 offset0:160 offset1:161
    ds_read2_b32 v[138:139], v58 offset0:162 offset1:163
    ds_read2_b32 v[140:141], v58 offset0:128 offset1:129
    ds_read2_b32 v[142:143], v58 offset0:130 offset1:131
    ds_read2_b32 v[144:145], v58 offset0:96 offset1:97
    ds_read2_b32 v[146:147], v58 offset0:98 offset1:99
    ds_read2_b32 v[148:149], v58 offset0:64 offset1:65
    ds_read2_b32 v[150:151], v58 offset0:66 offset1:67
    ds_read2_b32 v[152:153], v58 offset0:32 offset1:33
    ds_read2_b32 v[154:155], v58 offset0:34 offset1:35
    ds_read2_b32 v[156:157], v58 offset0:0 offset1:1
    ds_read2_b32 v[158:159], v58 offset0:2 offset1:3
    ds_read2_b32 v[160:161], v59 offset0:224 offset1:225
    ds_read2_b32 v[162:163], v59 offset0:226 offset1:227
    ds_read2_b32 v[164:165], v59 offset0:192 offset1:193
    ds_read2_b32 v[166:167], v59 offset0:194 offset1:195
    ds_read2_b32 v[168:169], v59 offset0:160 offset1:161
    ds_read2_b32 v[170:171], v59 offset0:162 offset1:163
    ds_read2_b32 v[172:173], v59 offset0:128 offset1:129
    ds_read2_b32 v[174:175], v59 offset0:130 offset1:131
    ds_read2_b32 v[176:177], v59 offset0:96 offset1:97
    ds_read2_b32 v[178:179], v59 offset0:98 offset1:99
    ds_read2_b32 v[180:181], v59 offset0:64 offset1:65
    ds_read2_b32 v[182:183], v59 offset0:66 offset1:67
    ds_read2_b32 v[184:185], v59 offset0:32 offset1:33
    ds_read2_b32 v[186:187], v59 offset0:34 offset1:35
    ds_read2_b32 v[188:189], v59 offset0:0 offset1:1
    ds_read2_b32 v[190:191], v59 offset0:2 offset1:3
    s_waitcnt vmcnt(0) lgkmcnt(0)
    s_add_u32 s77, s82, 12
    s_sub_u32 s4, s77, 28
    s_cmp_ge_u32 s77, 28
    s_cselect_b32 s77, s4, s77
    s_lshl_b32 s77, s77, 16
    s_add_u32 s77, s77, s72
    s_add_u32 m0, s73, 49152
    s_nop 0
    buffer_load_dwordx4 v240, s[68:71], s77 offen lds
    s_add_u32 m0, s73, 50176
    s_add_u32 s77, s77, 8192
    buffer_load_dwordx4 v240, s[68:71], s77 offen lds
    s_add_u32 s77, s82, 13
    s_sub_u32 s4, s77, 28
    s_cmp_ge_u32 s77, 28
    s_cselect_b32 s77, s4, s77
    s_lshl_b32 s77, s77, 16
    s_add_u32 s77, s77, s72
    s_add_u32 m0, s73, 57344
    s_nop 0
    buffer_load_dwordx4 v240, s[68:71], s77 offen lds
    s_add_u32 m0, s73, 58368
    s_add_u32 s77, s77, 8192
    buffer_load_dwordx4 v240, s[68:71], s77 offen lds
    s_add_u32 s77, s82, 14
    s_sub_u32 s4, s77, 28
    s_cmp_ge_u32 s77, 28
    s_cselect_b32 s77, s4, s77
    s_lshl_b32 s77, s77, 16
    s_add_u32 s77, s77, s72
    s_add_u32 m0, s73, 65536
    s_nop 0
    buffer_load_dwordx4 v240, s[68:71], s77 offen lds
    s_add_u32 m0, s73, 66560
    s_add_u32 s77, s77, 8192
    buffer_load_dwordx4 v240, s[68:71], s77 offen lds
    s_add_u32 s77, s82, 15
    s_sub_u32 s4, s77, 28
    s_cmp_ge_u32 s77, 28
    s_cselect_b32 s77, s4, s77
    s_lshl_b32 s77, s77, 16
    s_add_u32 s77, s77, s72
    s_add_u32 m0, s73, 73728
    s_nop 0
    buffer_load_dwordx4 v240, s[68:71], s77 offen lds
    s_add_u32 m0, s73, 74752
    s_add_u32 s77, s77, 8192
    buffer_load_dwordx4 v240, s[68:71], s77 offen lds
    s_add_u32 s77, s82, 16
    s_sub_u32 s4, s77, 28
    s_cmp_ge_u32 s77, 28
    s_cselect_b32 s77, s4, s77
    s_lshl_b32 s77, s77, 16
    s_add_u32 s77, s77, s72
    s_add_u32 m0, s73, 81920
    s_nop 0
    buffer_load_dwordx4 v240, s[68:71], s77 offen lds
    s_add_u32 m0, s73, 82944
    s_add_u32 s77, s77, 8192
    buffer_load_dwordx4 v240, s[68:71], s77 offen lds
    s_add_u32 s77, s82, 17
    s_sub_u32 s4, s77, 28
    s_cmp_ge_u32 s77, 28
    s_cselect_b32 s77, s4, s77
    s_lshl_b32 s77, s77, 16
    s_add_u32 s77, s77, s72
    s_add_u32 m0, s73, 90112
    s_nop 0
    buffer_load_dwordx4 v240, s[68:71], s77 offen lds
    s_add_u32 m0, s73, 91136
    s_add_u32 s77, s77, 8192
    buffer_load_dwordx4 v240, s[68:71], s77 offen lds
    v_and_b32 v64, v236, v64
    v_and_b32 v65, v237, v65
    v_and_b32 v66, v238, v66
    v_and_b32 v67, v239, v67
    v_and_b32 v2, 15, v0
    v_lshrrev_b32 v3, 4, v0
    v_lshlrev_b32 v4, 5, v2
    v_lshl_add_u32 v4, v3, 4, v4
    s_mul_i32 s4, s51, 4640
    s_lshl_b32 s5, s94, 6
    s_sub_u32 s4, s4, s5
    s_add_u32 s4, s4, 147808
    v_add_u32 v10, s4, v4
    s_add_u32 s60, s48, 8388608
    s_addc_u32 s61, s49, 0
    s_and_b32 s61, s61, 0xffff
    s_mov_b32 s62, 4194304
    s_mov_b32 s63, 0x00020000
    v_lshlrev_b32 v8, 5, v2
    v_lshl_add_u32 v8, v3, 3, v8
    s_add_u32 s6, s50, s51
    s_lshl_b32 s6, s6, 12
    s_lshl_b32 s7, s94, 21
    s_add_u32 s6, s6, s7
    s_waitcnt lgkmcnt(0)
    s_barrier
    ds_read_b128 v[16:19], v10 offset:0
    ds_read_b128 v[20:23], v10 offset:128
    ds_read_b128 v[24:27], v10 offset:256
    ds_read_b128 v[28:31], v10 offset:384
    ds_read_b128 v[32:35], v10 offset:512
    ds_read_b128 v[36:39], v10 offset:640
    ds_read_b128 v[40:43], v10 offset:768
    ds_read_b128 v[44:47], v10 offset:896
    ds_read_b128 v[48:51], v10 offset:1024
    ds_read_b128 v[52:55], v10 offset:1152
    ds_read_b128 v[56:59], v10 offset:1280
    ds_read_b128 v[60:63], v10 offset:1408
    s_waitcnt lgkmcnt(11)
    v_mfma_f32_16x16x32_bf16 v[192:195], v[76:79], v[16:19], 0
    v_mfma_f32_16x16x32_bf16 v[196:199], v[92:95], v[16:19], 0
    v_mfma_f32_16x16x32_bf16 v[200:203], v[108:111], v[16:19], 0
    v_mfma_f32_16x16x32_bf16 v[204:207], v[124:127], v[16:19], 0
    v_mfma_f32_16x16x32_bf16 v[208:211], v[140:143], v[16:19], 0
    v_mfma_f32_16x16x32_bf16 v[212:215], v[156:159], v[16:19], 0
    v_mfma_f32_16x16x32_bf16 v[216:219], v[172:175], v[16:19], 0
    v_mfma_f32_16x16x32_bf16 v[220:223], v[188:191], v[16:19], 0
    ds_read_b128 v[16:19], v10 offset:1536
    s_waitcnt lgkmcnt(11)
    v_mfma_f32_16x16x32_bf16 v[192:195], v[72:75], v[20:23], v[192:195]
    v_mfma_f32_16x16x32_bf16 v[196:199], v[88:91], v[20:23], v[196:199]
    v_mfma_f32_16x16x32_bf16 v[200:203], v[104:107], v[20:23], v[200:203]
    v_mfma_f32_16x16x32_bf16 v[204:207], v[120:123], v[20:23], v[204:207]
    v_mfma_f32_16x16x32_bf16 v[208:211], v[136:139], v[20:23], v[208:211]
    v_mfma_f32_16x16x32_bf16 v[212:215], v[152:155], v[20:23], v[212:215]
    v_mfma_f32_16x16x32_bf16 v[216:219], v[168:171], v[20:23], v[216:219]
    v_mfma_f32_16x16x32_bf16 v[220:223], v[184:187], v[20:23], v[220:223]
    ds_read_b128 v[20:23], v10 offset:1664
    s_waitcnt lgkmcnt(11)
    v_mfma_f32_16x16x32_bf16 v[192:195], v[68:71], v[24:27], v[192:195]
    v_mfma_f32_16x16x32_bf16 v[196:199], v[84:87], v[24:27], v[196:199]
    v_mfma_f32_16x16x32_bf16 v[200:203], v[100:103], v[24:27], v[200:203]
    v_mfma_f32_16x16x32_bf16 v[204:207], v[116:119], v[24:27], v[204:207]
    v_mfma_f32_16x16x32_bf16 v[208:211], v[132:135], v[24:27], v[208:211]
    v_mfma_f32_16x16x32_bf16 v[212:215], v[148:151], v[24:27], v[212:215]
    v_mfma_f32_16x16x32_bf16 v[216:219], v[164:167], v[24:27], v[216:219]
    v_mfma_f32_16x16x32_bf16 v[220:223], v[180:183], v[24:27], v[220:223]
    ds_read_b128 v[24:27], v10 offset:1792
    s_waitcnt lgkmcnt(11)
    v_mfma_f32_16x16x32_bf16 v[192:195], v[64:67], v[28:31], v[192:195]
    v_mfma_f32_16x16x32_bf16 v[196:199], v[80:83], v[28:31], v[196:199]
    v_mfma_f32_16x16x32_bf16 v[200:203], v[96:99], v[28:31], v[200:203]
    v_mfma_f32_16x16x32_bf16 v[204:207], v[112:115], v[28:31], v[204:207]
    v_mfma_f32_16x16x32_bf16 v[208:211], v[128:131], v[28:31], v[208:211]
    v_mfma_f32_16x16x32_bf16 v[212:215], v[144:147], v[28:31], v[212:215]
    v_mfma_f32_16x16x32_bf16 v[216:219], v[160:163], v[28:31], v[216:219]
    v_mfma_f32_16x16x32_bf16 v[220:223], v[176:179], v[28:31], v[220:223]
    ds_read_b128 v[28:31], v10 offset:1920
    s_waitcnt lgkmcnt(11)
    v_mfma_f32_16x16x32_bf16 v[196:199], v[76:79], v[32:35], v[196:199]
    v_mfma_f32_16x16x32_bf16 v[200:203], v[92:95], v[32:35], v[200:203]
    v_mfma_f32_16x16x32_bf16 v[204:207], v[108:111], v[32:35], v[204:207]
    v_mfma_f32_16x16x32_bf16 v[208:211], v[124:127], v[32:35], v[208:211]
    v_mfma_f32_16x16x32_bf16 v[212:215], v[140:143], v[32:35], v[212:215]
    v_mfma_f32_16x16x32_bf16 v[216:219], v[156:159], v[32:35], v[216:219]
    v_mfma_f32_16x16x32_bf16 v[220:223], v[172:175], v[32:35], v[220:223]
    ds_read_b128 v[32:35], v10 offset:2048
    s_waitcnt lgkmcnt(11)
    v_mfma_f32_16x16x32_bf16 v[196:199], v[72:75], v[36:39], v[196:199]
    v_mfma_f32_16x16x32_bf16 v[200:203], v[88:91], v[36:39], v[200:203]
    v_mfma_f32_16x16x32_bf16 v[204:207], v[104:107], v[36:39], v[204:207]
    v_mfma_f32_16x16x32_bf16 v[208:211], v[120:123], v[36:39], v[208:211]
    v_mfma_f32_16x16x32_bf16 v[212:215], v[136:139], v[36:39], v[212:215]
    v_mfma_f32_16x16x32_bf16 v[216:219], v[152:155], v[36:39], v[216:219]
    v_mfma_f32_16x16x32_bf16 v[220:223], v[168:171], v[36:39], v[220:223]
    s_barrier
    ds_read_b128 v[36:39], v10 offset:2176
    s_waitcnt lgkmcnt(11)
    v_mfma_f32_16x16x32_bf16 v[196:199], v[68:71], v[40:43], v[196:199]
    v_mfma_f32_16x16x32_bf16 v[200:203], v[84:87], v[40:43], v[200:203]
    v_mfma_f32_16x16x32_bf16 v[204:207], v[100:103], v[40:43], v[204:207]
    v_mfma_f32_16x16x32_bf16 v[208:211], v[116:119], v[40:43], v[208:211]
    v_mfma_f32_16x16x32_bf16 v[212:215], v[132:135], v[40:43], v[212:215]
    v_mfma_f32_16x16x32_bf16 v[216:219], v[148:151], v[40:43], v[216:219]
    v_mfma_f32_16x16x32_bf16 v[220:223], v[164:167], v[40:43], v[220:223]
    ds_read_b128 v[40:43], v10 offset:2304
    s_waitcnt lgkmcnt(11)
    v_mfma_f32_16x16x32_bf16 v[196:199], v[64:67], v[44:47], v[196:199]
    v_mfma_f32_16x16x32_bf16 v[200:203], v[80:83], v[44:47], v[200:203]
    v_mfma_f32_16x16x32_bf16 v[204:207], v[96:99], v[44:47], v[204:207]
    v_mfma_f32_16x16x32_bf16 v[208:211], v[112:115], v[44:47], v[208:211]
    v_mfma_f32_16x16x32_bf16 v[212:215], v[128:131], v[44:47], v[212:215]
    v_mfma_f32_16x16x32_bf16 v[216:219], v[144:147], v[44:47], v[216:219]
    v_mfma_f32_16x16x32_bf16 v[220:223], v[160:163], v[44:47], v[220:223]
    ds_read_b128 v[44:47], v10 offset:2432
    s_waitcnt lgkmcnt(11)
    v_mfma_f32_16x16x32_bf16 v[200:203], v[76:79], v[48:51], v[200:203]
    v_mfma_f32_16x16x32_bf16 v[204:207], v[92:95], v[48:51], v[204:207]
    v_mfma_f32_16x16x32_bf16 v[208:211], v[108:111], v[48:51], v[208:211]
    v_mfma_f32_16x16x32_bf16 v[212:215], v[124:127], v[48:51], v[212:215]
    v_mfma_f32_16x16x32_bf16 v[216:219], v[140:143], v[48:51], v[216:219]
    v_mfma_f32_16x16x32_bf16 v[220:223], v[156:159], v[48:51], v[220:223]
    ds_read_b128 v[48:51], v10 offset:2560
    s_waitcnt lgkmcnt(11)
    v_mfma_f32_16x16x32_bf16 v[200:203], v[72:75], v[52:55], v[200:203]
    v_mfma_f32_16x16x32_bf16 v[204:207], v[88:91], v[52:55], v[204:207]
    v_mfma_f32_16x16x32_bf16 v[208:211], v[104:107], v[52:55], v[208:211]
    v_mfma_f32_16x16x32_bf16 v[212:215], v[120:123], v[52:55], v[212:215]
    v_mfma_f32_16x16x32_bf16 v[216:219], v[136:139], v[52:55], v[216:219]
    v_mfma_f32_16x16x32_bf16 v[220:223], v[152:155], v[52:55], v[220:223]
    ds_read_b128 v[52:55], v10 offset:2688
    s_waitcnt lgkmcnt(11)
    v_mfma_f32_16x16x32_bf16 v[200:203], v[68:71], v[56:59], v[200:203]
    v_mfma_f32_16x16x32_bf16 v[204:207], v[84:87], v[56:59], v[204:207]
    v_mfma_f32_16x16x32_bf16 v[208:211], v[100:103], v[56:59], v[208:211]
    v_mfma_f32_16x16x32_bf16 v[212:215], v[116:119], v[56:59], v[212:215]
    v_mfma_f32_16x16x32_bf16 v[216:219], v[132:135], v[56:59], v[216:219]
    v_mfma_f32_16x16x32_bf16 v[220:223], v[148:151], v[56:59], v[220:223]
    ds_read_b128 v[56:59], v10 offset:2816
    s_waitcnt lgkmcnt(11)
    v_mfma_f32_16x16x32_bf16 v[200:203], v[64:67], v[60:63], v[200:203]
    v_mfma_f32_16x16x32_bf16 v[204:207], v[80:83], v[60:63], v[204:207]
    v_mfma_f32_16x16x32_bf16 v[208:211], v[96:99], v[60:63], v[208:211]
    v_mfma_f32_16x16x32_bf16 v[212:215], v[112:115], v[60:63], v[212:215]
    v_mfma_f32_16x16x32_bf16 v[216:219], v[128:131], v[60:63], v[216:219]
    v_mfma_f32_16x16x32_bf16 v[220:223], v[144:147], v[60:63], v[220:223]
    ds_read_b128 v[60:63], v10 offset:2944
    s_waitcnt lgkmcnt(11)
    v_mfma_f32_16x16x32_bf16 v[204:207], v[76:79], v[16:19], v[204:207]
    v_mfma_f32_16x16x32_bf16 v[208:211], v[92:95], v[16:19], v[208:211]
    v_mfma_f32_16x16x32_bf16 v[212:215], v[108:111], v[16:19], v[212:215]
    v_mfma_f32_16x16x32_bf16 v[216:219], v[124:127], v[16:19], v[216:219]
    v_mfma_f32_16x16x32_bf16 v[220:223], v[140:143], v[16:19], v[220:223]
    ds_read_b128 v[16:19], v10 offset:3072
    s_waitcnt lgkmcnt(11)
    v_mfma_f32_16x16x32_bf16 v[204:207], v[72:75], v[20:23], v[204:207]
    v_mfma_f32_16x16x32_bf16 v[208:211], v[88:91], v[20:23], v[208:211]
    v_mfma_f32_16x16x32_bf16 v[212:215], v[104:107], v[20:23], v[212:215]
    v_mfma_f32_16x16x32_bf16 v[216:219], v[120:123], v[20:23], v[216:219]
    v_mfma_f32_16x16x32_bf16 v[220:223], v[136:139], v[20:23], v[220:223]
    ds_read_b128 v[20:23], v10 offset:3200
    s_waitcnt lgkmcnt(11)
    v_mfma_f32_16x16x32_bf16 v[204:207], v[68:71], v[24:27], v[204:207]
    v_mfma_f32_16x16x32_bf16 v[208:211], v[84:87], v[24:27], v[208:211]
    v_mfma_f32_16x16x32_bf16 v[212:215], v[100:103], v[24:27], v[212:215]
    v_mfma_f32_16x16x32_bf16 v[216:219], v[116:119], v[24:27], v[216:219]
    v_mfma_f32_16x16x32_bf16 v[220:223], v[132:135], v[24:27], v[220:223]
    ds_read_b128 v[24:27], v10 offset:3328
    s_waitcnt lgkmcnt(11)
    v_mfma_f32_16x16x32_bf16 v[204:207], v[64:67], v[28:31], v[204:207]
    v_mfma_f32_16x16x32_bf16 v[208:211], v[80:83], v[28:31], v[208:211]
    v_mfma_f32_16x16x32_bf16 v[212:215], v[96:99], v[28:31], v[212:215]
    v_mfma_f32_16x16x32_bf16 v[216:219], v[112:115], v[28:31], v[216:219]
    v_mfma_f32_16x16x32_bf16 v[220:223], v[128:131], v[28:31], v[220:223]
    ds_read_b128 v[28:31], v10 offset:3456
    s_waitcnt lgkmcnt(11)
    v_mfma_f32_16x16x32_bf16 v[208:211], v[76:79], v[32:35], v[208:211]
    v_mfma_f32_16x16x32_bf16 v[212:215], v[92:95], v[32:35], v[212:215]
    v_mfma_f32_16x16x32_bf16 v[216:219], v[108:111], v[32:35], v[216:219]
    v_mfma_f32_16x16x32_bf16 v[220:223], v[124:127], v[32:35], v[220:223]
    ds_read_b128 v[32:35], v10 offset:3584
    s_waitcnt lgkmcnt(11)
    v_mfma_f32_16x16x32_bf16 v[208:211], v[72:75], v[36:39], v[208:211]
    v_mfma_f32_16x16x32_bf16 v[212:215], v[88:91], v[36:39], v[212:215]
    v_mfma_f32_16x16x32_bf16 v[216:219], v[104:107], v[36:39], v[216:219]
    v_mfma_f32_16x16x32_bf16 v[220:223], v[120:123], v[36:39], v[220:223]
    ds_read_b128 v[36:39], v10 offset:3712
    s_waitcnt lgkmcnt(11)
    v_mfma_f32_16x16x32_bf16 v[208:211], v[68:71], v[40:43], v[208:211]
    v_mfma_f32_16x16x32_bf16 v[212:215], v[84:87], v[40:43], v[212:215]
    v_mfma_f32_16x16x32_bf16 v[216:219], v[100:103], v[40:43], v[216:219]
    v_mfma_f32_16x16x32_bf16 v[220:223], v[116:119], v[40:43], v[220:223]
    ds_read_b128 v[40:43], v10 offset:3840
    s_waitcnt lgkmcnt(11)
    v_mfma_f32_16x16x32_bf16 v[208:211], v[64:67], v[44:47], v[208:211]
    v_mfma_f32_16x16x32_bf16 v[212:215], v[80:83], v[44:47], v[212:215]
    v_mfma_f32_16x16x32_bf16 v[216:219], v[96:99], v[44:47], v[216:219]
    v_mfma_f32_16x16x32_bf16 v[220:223], v[112:115], v[44:47], v[220:223]
    ds_read_b128 v[44:47], v10 offset:3968
    s_waitcnt lgkmcnt(11)
    v_mfma_f32_16x16x32_bf16 v[212:215], v[76:79], v[48:51], v[212:215]
    v_mfma_f32_16x16x32_bf16 v[216:219], v[92:95], v[48:51], v[216:219]
    v_mfma_f32_16x16x32_bf16 v[220:223], v[108:111], v[48:51], v[220:223]
    s_waitcnt lgkmcnt(10)
    v_mfma_f32_16x16x32_bf16 v[212:215], v[72:75], v[52:55], v[212:215]
    v_mfma_f32_16x16x32_bf16 v[216:219], v[88:91], v[52:55], v[216:219]
    v_mfma_f32_16x16x32_bf16 v[220:223], v[104:107], v[52:55], v[220:223]
    s_waitcnt lgkmcnt(9)
    v_mfma_f32_16x16x32_bf16 v[212:215], v[68:71], v[56:59], v[212:215]
    v_mfma_f32_16x16x32_bf16 v[216:219], v[84:87], v[56:59], v[216:219]
    v_mfma_f32_16x16x32_bf16 v[220:223], v[100:103], v[56:59], v[220:223]
    s_waitcnt lgkmcnt(8)
    v_mfma_f32_16x16x32_bf16 v[212:215], v[64:67], v[60:63], v[212:215]
    v_mfma_f32_16x16x32_bf16 v[216:219], v[80:83], v[60:63], v[216:219]
    v_mfma_f32_16x16x32_bf16 v[220:223], v[96:99], v[60:63], v[220:223]
    s_waitcnt lgkmcnt(7)
    v_mfma_f32_16x16x32_bf16 v[216:219], v[76:79], v[16:19], v[216:219]
    v_mfma_f32_16x16x32_bf16 v[220:223], v[92:95], v[16:19], v[220:223]
    s_waitcnt lgkmcnt(6)
    v_mfma_f32_16x16x32_bf16 v[216:219], v[72:75], v[20:23], v[216:219]
    v_mfma_f32_16x16x32_bf16 v[220:223], v[88:91], v[20:23], v[220:223]
    s_waitcnt lgkmcnt(5)
    v_mfma_f32_16x16x32_bf16 v[216:219], v[68:71], v[24:27], v[216:219]
    v_mfma_f32_16x16x32_bf16 v[220:223], v[84:87], v[24:27], v[220:223]
    s_waitcnt lgkmcnt(4)
    v_mfma_f32_16x16x32_bf16 v[216:219], v[64:67], v[28:31], v[216:219]
    v_mfma_f32_16x16x32_bf16 v[220:223], v[80:83], v[28:31], v[220:223]
    s_waitcnt lgkmcnt(3)
    v_mfma_f32_16x16x32_bf16 v[220:223], v[76:79], v[32:35], v[220:223]
    s_waitcnt lgkmcnt(2)
    v_mfma_f32_16x16x32_bf16 v[220:223], v[72:75], v[36:39], v[220:223]
    s_waitcnt lgkmcnt(1)
    v_mfma_f32_16x16x32_bf16 v[220:223], v[68:71], v[40:43], v[220:223]
    s_waitcnt lgkmcnt(0)
    v_mfma_f32_16x16x32_bf16 v[220:223], v[64:67], v[44:47], v[220:223]
    s_nop 7
    v_and_b32 v9, 1, v3
    v_lshrrev_b32 v11, 1, v3
    v_lshlrev_b32 v8, 5, v2
    v_lshl_add_u32 v8, v11, 4, v8
    v_lshl_add_u32 v8, v9, 9, v8
    v_cvt_pk_bf16_f32 v16, v192, v193
    v_cvt_pk_bf16_f32 v17, v194, v195
    v_cvt_pk_bf16_f32 v18, v196, v197
    v_cvt_pk_bf16_f32 v19, v198, v199
    s_nop 1
    v_permlane16_swap_b32 v16, v18
    v_permlane16_swap_b32 v17, v19
    buffer_store_dwordx4 v[16:19], v8, s[60:63], s6 offen offset:0 sc1
    v_cvt_pk_bf16_f32 v20, v200, v201
    v_cvt_pk_bf16_f32 v21, v202, v203
    v_cvt_pk_bf16_f32 v22, v204, v205
    v_cvt_pk_bf16_f32 v23, v206, v207
    s_nop 1
    v_permlane16_swap_b32 v20, v22
    v_permlane16_swap_b32 v21, v23
    buffer_store_dwordx4 v[20:23], v8, s[60:63], s6 offen offset:1024 sc1
    v_cvt_pk_bf16_f32 v24, v208, v209
    v_cvt_pk_bf16_f32 v25, v210, v211
    v_cvt_pk_bf16_f32 v26, v212, v213
    v_cvt_pk_bf16_f32 v27, v214, v215
    s_nop 1
    v_permlane16_swap_b32 v24, v26
    v_permlane16_swap_b32 v25, v27
    buffer_store_dwordx4 v[24:27], v8, s[60:63], s6 offen offset:2048 sc1
    v_cvt_pk_bf16_f32 v28, v216, v217
    v_cvt_pk_bf16_f32 v29, v218, v219
    v_cvt_pk_bf16_f32 v30, v220, v221
    v_cvt_pk_bf16_f32 v31, v222, v223
    s_nop 1
    v_permlane16_swap_b32 v28, v30
    v_permlane16_swap_b32 v29, v31
    buffer_store_dwordx4 v[28:31], v8, s[60:63], s6 offen offset:3072 sc1
    s_add_u32 s4, s50, s51
    s_lshr_b32 s5, s4, 6
    s_lshl_b32 s5, s5, 1
    s_add_u32 s5, s5, s94
    s_lshl_b32 s5, s5, 8
    s_and_b32 s4, s4, 63
    s_lshl_b32 s4, s4, 2
    s_add_u32 s4, s4, s5
    s_add_u32 s79, s4, 65536
    s_branch L_g2
L_ssm0:
    s_add_u32 s60, s48, 16777216
    s_addc_u32 s61, s49, 0
    s_and_b32 s61, s61, 0xffff
    s_mov_b32 s62, 2162688
    s_mov_b32 s63, 0x00020000
    s_bfe_u32 s55, s9, 0x10002
    s_lshl_b32 s54, s14, 1
    s_add_u32 s54, s54, s55
    v_lshrrev_b32 v2, 4, v0
    v_bfe_u32 v3, v0, 2, 2
    v_and_b32 v4, 3, v0
    v_lshl_add_u32 v5, v2, 3, v3
    s_lshl_b32 s4, s55, 2
    v_lshrrev_b32 v6, 1, v4
    v_or_b32 v6, s4, v6
    v_and_b32 v7, 1, v4
    v_lshlrev_b32 v7, 3, v7
    s_lshl_b32 s5, s51, 13
    s_add_u32 s5, s5, 32768
    v_add_u32 v8, 0, v5
    v_bfe_u32 v9, v8, 1, 3
    v_xor_b32 v9, v9, v6
    v_lshl_add_u32 v9, v9, 4, v7
    v_lshl_add_u32 v9, v8, 7, v9
    v_add_u32 v224, s5, v9
    v_xor_b32 v225, 32, v224
    v_add_u32 v8, 4, v5
    v_bfe_u32 v9, v8, 1, 3
    v_xor_b32 v9, v9, v6
    v_lshl_add_u32 v9, v9, 4, v7
    v_lshl_add_u32 v9, v8, 7, v9
    v_add_u32 v226, s5, v9
    v_xor_b32 v227, 32, v226
    v_and_b32 v3, 15, v0
    v_mul_u32_u24 v3, 4224, v3
    v_lshlrev_b32 v2, 4, v2
    v_sub_u32 v3, v3, v2
    v_add_u32 v228, 48, v3
    s_mul_i32 s4, s54, 135168
    s_lshl_b32 s6, s8, 8
    s_sub_u32 s4, s4, s6
    s_lshl_b32 s6, s51, 7
    s_sub_u32 s4, s4, s6
    s_add_u32 s72, s4, 4032
    s_add_u32 s56, s48, 14745600
    s_addc_u32 s57, s49, 0
    s_and_b32 s57, s57, 0xffff
    s_mov_b32 s58, 131072
    s_mov_b32 s59, 0x00020000
    s_lshl_b32 s79, s54, 8
    s_lshl_b32 s5, s8, 3
    s_add_u32 s79, s79, s5
    s_lshl_b32 s5, s51, 2
    s_add_u32 s79, s79, s5
    s_add_u32 s79, s79, 98304
    v_mov_b32 v232, 0
    v_mov_b32 v233, 0
    v_mov_b32 v234, 0
    v_mov_b32 v235, 0
    s_bfe_u32 s4, s3, 0x10001
    s_lshl_b32 s4, s4, 5
    s_add_u32 s4, s4, 16
    v_and_b32 v2, 15, v0
    v_lshrrev_b32 v3, 4, v0
    v_lshlrev_b32 v3, 3, v3
    v_sub_u32 v2, v2, v3
    v_add_u32 v2, s4, v2
    v_mov_b32 v3, 0xffff
    v_cmp_le_i32 vcc, 0, v2
    s_nop 1
    v_cndmask_b32 v236, 0, v3, vcc
    v_cmp_lt_i32 vcc, 0, v2
    s_nop 1
    v_cndmask_b32 v236, v236, -1, vcc
    v_cmp_le_i32 vcc, 2, v2
    s_nop 1
    v_cndmask_b32 v237, 0, v3, vcc
    v_cmp_lt_i32 vcc, 2, v2
    s_nop 1
    v_cndmask_b32 v237, v237, -1, vcc
    v_cmp_le_i32 vcc, 4, v2
    s_nop 1
    v_cndmask_b32 v238, 0, v3, vcc
    v_cmp_lt_i32 vcc, 4, v2
    s_nop 1
    v_cndmask_b32 v238, v238, -1, vcc
    v_cmp_le_i32 vcc, 6, v2
    s_nop 1
    v_cndmask_b32 v239, 0, v3, vcc
    v_cmp_lt_i32 vcc, 6, v2
    s_nop 1
    v_cndmask_b32 v239, v239, -1, vcc
    s_bfe_u32 s94, s3, 0x10001
    v_and_b32 v2, 15, v0
    v_lshrrev_b32 v3, 4, v0
    v_and_b32 v4, 1, v0
    v_lshlrev_b32 v5, 3, v3
    v_sub_u32 v5, v5, v2
    v_add_u32 v5, v5, v4
    v_lshlrev_b32 v5, 1, v5
    v_xor_b32 v4, 1, v4
    v_mul_u32_u24 v4, 4160, v4
    v_add_u32 v5, v5, v4
    s_mul_i32 s4, s51, 8320
    s_lshl_b32 s5, s94, 6
    s_sub_u32 s4, s4, s5
    s_add_u32 s5, s4, 101468
    v_add_u32 v56, s5, v5
    s_add_u32 s5, s4, 100444
    v_add_u32 v57, s5, v5
    s_add_u32 s5, s4, 99420
    v_add_u32 v58, s5, v5
    s_add_u32 s5, s4, 98396
    v_add_u32 v59, s5, v5
    s_and_b32 s4, s2, 7
    s_lshr_b32 s5, s2, 3
    s_and_b32 s80, s5, 3
    s_mul_i32 s82, s80, 7
    s_lshl_b32 s4, s4, 2
    s_add_u32 s80, s80, s4
    s_lshr_b32 s81, s5, 2
    s_mul_i32 s4, s81, 7
    s_lshr_b32 s4, s4, 1
    s_add_u32 s82, s82, s4
    s_sub_u32 s4, s82, 28
    s_cmp_ge_u32 s82, 28
    s_cselect_b32 s82, s4, s82
    s_lshr_b32 s82, s80, 2
    s_mul_i32 s82, s82, 7
    s_lshr_b32 s82, s82, 2
    s_and_b32 s4, s80, 1
    s_mul_i32 s4, s4, 14
    s_add_u32 s82, s82, s4
    s_and_b32 s83, s3, 1
    s_bfe_u32 s84, s3, 0x10001
    s_lshr_b32 s85, s3, 2
    s_lshl_b32 s85, s85, 1
    s_add_u32 s85, s85, s83
    v_lshrrev_b32 v3, 3, v0
    v_and_b32 v4, 7, v0
    v_bfe_u32 v5, v0, 4, 1
    v_lshlrev_b32 v5, 2, v5
    v_xor_b32 v4, v4, v5
    v_lshlrev_b32 v4, 4, v4
    v_lshl_add_u32 v240, v3, 10, v4
    v_lshl_add_u32 v253, v3, 12, v4
    v_lshrrev_b32 v3, 5, v0
    v_bfe_u32 v4, v0, 4, 1
    v_bfe_u32 v5, v0, 2, 2
    v_and_b32 v6, 3, v0
    v_lshlrev_b32 v6, 3, v6
    v_lshl_add_u32 v6, v4, 5, v6
    v_bfe_u32 v7, v0, 3, 1
    v_lshlrev_b32 v7, 6, v7
    v_xor_b32 v6, v6, v7
    v_lshl_add_u32 v7, v3, 2, v5
    v_lshl_add_u32 v7, v7, 7, v6
    s_lshl_b32 s4, s83, 12
    v_add_u32 v241, s4, v7
    s_lshl_b32 s4, s85, 5
    v_xor_b32 v241, s4, v241
    v_xor_b32 v242, 64, v241
    v_add_u32 v244, 114944, v241
    v_add_u32 v245, 114944, v242
    v_lshl_add_u32 v7, v3, 2, v5
    s_lshl_b32 s4, s84, 6
    v_xor_b32 v6, s4, v6
    v_lshl_add_u32 v7, v7, 7, v6
    s_lshl_b32 s4, s85, 11
    s_add_u32 s4, s4, 0
    v_add_u32 v243, s4, v7
    s_lshl_b32 s4, s80, 6
    s_lshl_b32 s5, s84, 5
    s_add_u32 s4, s4, s5
    v_and_b32 v2, 31, v0
    v_add_u32 v246, s4, v2
    v_lshlrev_b32 v247, 4, v0
    v_mov_b32 v248, 0
    v_lshlrev_b32 v249, 20, v0
    v_mov_b32 v252, 1
    s_waitcnt vmcnt(0)
    s_waitcnt lgkmcnt(0)
    s_lshl_b32 s4, s90, 16
    s_and_b32 s5, s90, 0xffff0000
    s_lshl_b32 s6, s91, 16
    s_and_b32 s7, s91, 0xffff0000
    s_cmp_eq_u32 s51, 0
    s_cselect_b32 s90, s4, s5
    s_cselect_b32 s91, s6, s7
    v_mov_b32 v68, s90
    s_mov_b32 s4, 0x3fb8aa3b
    v_mul_f32 v69, s4, v68
    v_fma_f32 v70, v68, s4, -v69
    v_fmac_f32 v70, 0x32a57060, v68
    v_exp_f32 v69, v69
    v_mul_f32 v70, 0x3f317218, v70
    v_fma_f32 v69, v69, v70, v69
    v_cvt_pk_bf16_f32 v72, v69, v69
    v_lshlrev_b32 v72, 16, v72
    s_mul_i32 s4, s51, 28512
    s_cmp_lt_u32 s3, 4
    s_cselect_b32 s5, 11616, 0
    s_add_u32 s4, s4, s5
    s_add_u32 s4, s4, 98304
    v_lshl_add_u32 v73, v0, 3, s4
    v_lshlrev_b32 v64, 16, v16
    v_and_b32 v65, 0xffff0000, v16
    v_lshlrev_b32 v66, 16, v17
    v_and_b32 v67, 0xffff0000, v17
    v_mul_f32 v64, v72, v64
    v_mul_f32 v66, v72, v66
    v_mul_f32 v65, v72, v65
    v_mul_f32 v67, v72, v67
    v_mul_f32 v64, 0x3fb8aa3b, v64
    v_mul_f32 v66, 0.15915494, v66
    v_mul_f32 v65, 0x3fb8aa3b, v65
    v_mul_f32 v67, 0.15915494, v67
    v_max_f32 v106, v64, v65
    v_lshlrev_b32 v86, 16, v18
    v_and_b32 v87, 0xffff0000, v18
    v_lshlrev_b32 v88, 16, v19
    v_and_b32 v89, 0xffff0000, v19
    v_lshlrev_b32 v90, 16, v20
    v_and_b32 v91, 0xffff0000, v20
    v_lshlrev_b32 v92, 16, v21
    v_and_b32 v93, 0xffff0000, v21
    v_mul_f32 v86, v72, v86
    v_mul_f32 v87, v72, v87
    v_mul_f32 v88, v72, v88
    v_mul_f32 v89, v72, v89
    v_pk_mul_f32 v[102:103], v[90:91], v[86:87]
    v_pk_mul_f32 v[104:105], v[90:91], v[88:89]
    v_pk_fma_f32 v[102:103], v[92:93], v[88:89], v[102:103] neg_lo:[1,0,0] neg_hi:[1,0,0]
    v_pk_fma_f32 v[104:105], v[92:93], v[86:87], v[104:105]
    v_max3_f32 v107, abs(v102), abs(v103), abs(v104)
    v_max_f32 v107, v107, abs(v105)
    s_nop 1
    v_max_f32_dpp v106, v106, v106 row_ror:8
    v_max_f32_dpp v107, v107, v107 row_ror:8
    s_nop 1
    v_max_f32_dpp v106, v106, v106 row_ror:4
    v_max_f32_dpp v107, v107, v107 row_ror:4
    s_nop 1
    v_max_f32_dpp v106, v106, v106 row_ror:2
    v_max_f32_dpp v107, v107, v107 row_ror:2
    s_nop 1
    v_max_f32_dpp v106, v106, v106 row_ror:1
    v_max_f32_dpp v107, v107, v107 row_ror:1
    s_nop 1
    v_max_f32_dpp v106, v106, v106 row_bcast:15 row_mask:0xa
    v_max_f32_dpp v107, v107, v107 row_bcast:15 row_mask:0xa
    s_nop 1
    v_max_f32_dpp v106, v106, v106 row_bcast:31 row_mask:0xc
    v_max_f32_dpp v107, v107, v107 row_bcast:31 row_mask:0xc
    s_nop 1
    v_readlane_b32 s92, v106, 63
    v_readlane_b32 s93, v107, 63
    s_nop 1
    v_subrev_f32 v64, s92, v64
    v_subrev_f32 v65, s92, v65
    s_and_b32 s93, s93, 0x7f800000
    s_max_u32 s93, s93, 0x00800000
    s_min_u32 s93, s93, 0x7e800000
    s_sub_u32 s4, 0x7f000000, s93
    v_mul_f32 v102, s4, v102
    v_mul_f32 v103, s4, v103
    v_mul_f32 v104, s4, v104
    v_mul_f32 v105, s4, v105
    s_lshr_b32 s93, s93, 23
    s_sub_u32 s93, s93, 127
    v_mul_f32 v68, 0x3f800000, v64
    v_mul_f32 v70, 0x3f800000, v66
    v_mul_f32 v69, 0x3f800000, v65
    v_mul_f32 v71, 0x3f800000, v67
    v_exp_f32 v68, v68
    v_fract_f32 v70, v70
    v_exp_f32 v69, v69
    v_fract_f32 v71, v71
    v_cos_f32 v74, v70
    v_sin_f32 v76, v70
    v_cos_f32 v75, v71
    v_sin_f32 v77, v71
    s_nop 0
    v_pk_mul_f32 v[74:75], v[74:75], v[68:69]
    v_pk_mul_f32 v[76:77], v[76:77], v[68:69]
    v_mul_f32 v68, 0x43800000, v64
    v_mul_f32 v70, 0x43800000, v66
    v_mul_f32 v69, 0x43800000, v65
    v_mul_f32 v71, 0x43800000, v67
    v_exp_f32 v68, v68
    v_fract_f32 v70, v70
    v_exp_f32 v69, v69
    v_fract_f32 v71, v71
    v_cos_f32 v78, v70
    v_sin_f32 v80, v70
    v_cos_f32 v79, v71
    v_sin_f32 v81, v71
    s_nop 0
    v_pk_mul_f32 v[78:79], v[78:79], v[68:69]
    v_pk_mul_f32 v[80:81], v[80:81], v[68:69]
    v_pk_mul_f32 v[82:83], v[74:75], v[74:75]
    v_pk_mul_f32 v[84:85], v[74:75], v[76:77]
    v_pk_fma_f32 v[82:83], v[76:77], v[76:77], v[82:83] neg_lo:[1,0,0] neg_hi:[1,0,0]
    v_pk_fma_f32 v[84:85], v[76:77], v[74:75], v[84:85]
    v_cvt_pk_f16_f32 v98, v102, -v104
    v_cvt_pk_f16_f32 v99, v103, -v105
    ds_write_b64 v73, v[98:99] offset:0
    v_pk_mul_f32 v[86:87], v[102:103], v[74:75]
    v_pk_mul_f32 v[88:89], v[102:103], v[76:77]
    v_pk_fma_f32 v[86:87], v[104:105], v[76:77], v[86:87] neg_lo:[1,0,0] neg_hi:[1,0,0]
    v_pk_fma_f32 v[88:89], v[104:105], v[74:75], v[88:89]
    v_cvt_pk_f16_f32 v100, v86, -v88
    v_cvt_pk_f16_f32 v101, v87, -v89
    ds_write_b64 v73, v[100:101] offset:528
    v_pk_mul_f32 v[90:91], v[86:87], v[74:75]
    v_pk_mul_f32 v[92:93], v[86:87], v[76:77]
    v_pk_fma_f32 v[90:91], v[88:89], v[76:77], v[90:91] neg_lo:[1,0,0] neg_hi:[1,0,0]
    v_pk_fma_f32 v[92:93], v[88:89], v[74:75], v[92:93]
    v_cvt_pk_f16_f32 v98, v90, -v92
    v_cvt_pk_f16_f32 v99, v91, -v93
    ds_write_b64 v73, v[98:99] offset:1056
    v_pk_mul_f32 v[86:87], v[90:91], v[74:75]
    v_pk_mul_f32 v[88:89], v[90:91], v[76:77]
    v_pk_fma_f32 v[86:87], v[92:93], v[76:77], v[86:87] neg_lo:[1,0,0] neg_hi:[1,0,0]
    v_pk_fma_f32 v[88:89], v[92:93], v[74:75], v[88:89]
    v_cvt_pk_f16_f32 v100, v86, -v88
    v_cvt_pk_f16_f32 v101, v87, -v89
    ds_write_b64 v73, v[100:101] offset:1584
    v_pk_mul_f32 v[90:91], v[86:87], v[74:75]
    v_pk_mul_f32 v[92:93], v[86:87], v[76:77]
    v_pk_fma_f32 v[90:91], v[88:89], v[76:77], v[90:91] neg_lo:[1,0,0] neg_hi:[1,0,0]
    v_pk_fma_f32 v[92:93], v[88:89], v[74:75], v[92:93]
    v_cvt_pk_f16_f32 v98, v90, -v92
    v_cvt_pk_f16_f32 v99, v91, -v93
    ds_write_b64 v73, v[98:99] offset:2112
    v_pk_mul_f32 v[86:87], v[90:91], v[74:75]
    v_pk_mul_f32 v[88:89], v[90:91], v[76:77]
    v_pk_fma_f32 v[86:87], v[92:93], v[76:77], v[86:87] neg_lo:[1,0,0] neg_hi:[1,0,0]
    v_pk_fma_f32 v[88:89], v[92:93], v[74:75], v[88:89]
    v_cvt_pk_f16_f32 v100, v86, -v88
    v_cvt_pk_f16_f32 v101, v87, -v89
    ds_write_b64 v73, v[100:101] offset:2640
    v_pk_mul_f32 v[90:91], v[86:87], v[74:75]
    v_pk_mul_f32 v[92:93], v[86:87], v[76:77]
    v_pk_fma_f32 v[90:91], v[88:89], v[76:77], v[90:91] neg_lo:[1,0,0] neg_hi:[1,0,0]
    v_pk_fma_f32 v[92:93], v[88:89], v[74:75], v[92:93]
    v_cvt_pk_f16_f32 v98, v90, -v92
    v_cvt_pk_f16_f32 v99, v91, -v93
    ds_write_b64 v73, v[98:99] offset:3168
    v_pk_mul_f32 v[86:87], v[90:91], v[74:75]
    v_pk_mul_f32 v[88:89], v[90:91], v[76:77]
    v_pk_fma_f32 v[86:87], v[92:93], v[76:77], v[86:87] neg_lo:[1,0,0] neg_hi:[1,0,0]
    v_pk_fma_f32 v[88:89], v[92:93], v[74:75], v[88:89]
    v_cvt_pk_f16_f32 v100, v86, -v88
    v_cvt_pk_f16_f32 v101, v87, -v89
    ds_write_b64 v73, v[100:101] offset:3696
    v_pk_mul_f32 v[94:95], v[102:103], v[78:79]
    v_pk_mul_f32 v[96:97], v[102:103], v[80:81]
    v_pk_fma_f32 v[94:95], v[104:105], v[80:81], v[94:95] neg_lo:[1,0,0] neg_hi:[1,0,0]
    v_pk_fma_f32 v[96:97], v[104:105], v[78:79], v[96:97]
    v_cvt_pk_f16_f32 v98, v94, -v96
    v_cvt_pk_f16_f32 v99, v95, -v97
    ds_write_b64 v73, v[98:99] offset:4224
    v_pk_mul_f32 v[86:87], v[94:95], v[82:83]
    v_pk_mul_f32 v[88:89], v[94:95], v[84:85]
    v_pk_fma_f32 v[86:87], v[96:97], v[84:85], v[86:87] neg_lo:[1,0,0] neg_hi:[1,0,0]
    v_pk_fma_f32 v[88:89], v[96:97], v[82:83], v[88:89]
    v_cvt_pk_f16_f32 v100, v86, -v88
    v_cvt_pk_f16_f32 v101, v87, -v89
    ds_write_b64 v73, v[100:101] offset:4752
    v_pk_mul_f32 v[90:91], v[86:87], v[82:83]
    v_pk_mul_f32 v[92:93], v[86:87], v[84:85]
    v_pk_fma_f32 v[90:91], v[88:89], v[84:85], v[90:91] neg_lo:[1,0,0] neg_hi:[1,0,0]
    v_pk_fma_f32 v[92:93], v[88:89], v[82:83], v[92:93]
    v_cvt_pk_f16_f32 v98, v90, -v92
    v_cvt_pk_f16_f32 v99, v91, -v93
    ds_write_b64 v73, v[98:99] offset:6336
    v_pk_mul_f32 v[86:87], v[90:91], v[82:83]
    v_pk_mul_f32 v[88:89], v[90:91], v[84:85]
    v_pk_fma_f32 v[86:87], v[92:93], v[84:85], v[86:87] neg_lo:[1,0,0] neg_hi:[1,0,0]
    v_pk_fma_f32 v[88:89], v[92:93], v[82:83], v[88:89]
    v_cvt_pk_f16_f32 v100, v86, -v88
    v_cvt_pk_f16_f32 v101, v87, -v89
    ds_write_b64 v73, v[100:101] offset:6864
    s_waitcnt lgkmcnt(0)
    v_and_b32 v2, 31, v0
    v_lshrrev_b32 v3, 5, v0
    v_mul_u32_u24 v4, 528, v2
    v_lshl_add_u32 v4, v3, 4, v4
    s_mul_i32 s4, s51, 28512
    s_add_u32 s4, s4, 98304
    v_add_u32 v4, s4, v4
    v_mov_b32 v208, s92
    v_cvt_f32_i32 v209, s93
    v_lshlrev_b32 v5, 3, v2
    v_lshl_add_u32 v6, v3, 2, v5
    v_lshl_add_u32 v7, v3, 9, v5
    v_cvt_f32_u32 v210, v6
    v_cvt_f32_u32 v211, v7
    v_fma_f32 v210, v210, v208, v209
    v_fma_f32 v211, v211, v208, v209
    v_fmamk_f32 v212, v208, 0x00000000, v210
    v_fmamk_f32 v213, v208, 0x3f800000, v210
    v_fmamk_f32 v214, v208, 0x40000000, v210
    v_fmamk_f32 v215, v208, 0x40400000, v210
    v_fmamk_f32 v216, v208, 0x43800000, v210
    v_fmamk_f32 v217, v208, 0x43810000, v210
    v_fmamk_f32 v218, v208, 0x44000000, v210
    v_fmamk_f32 v219, v208, 0x44400000, v210
    v_fmamk_f32 v220, v208, 0x44800000, v211
    v_fmamk_f32 v221, v208, 0x44a00000, v211
    v_fmamk_f32 v222, v208, 0x45000000, v211
    v_exp_f32 v212, v212
    v_exp_f32 v213, v213
    v_exp_f32 v214, v214
    v_exp_f32 v215, v215
    v_exp_f32 v216, v216
    v_exp_f32 v217, v217
    v_exp_f32 v218, v218
    v_exp_f32 v219, v219
    v_exp_f32 v220, v220
    v_exp_f32 v221, v221
    v_exp_f32 v222, v222
    v_cmp_eq_u32 vcc, 0, v0
    v_mov_b32 v8, s91
    s_mul_i32 s4, s51, 4224
    s_add_u32 s4, s4, 155328
    v_cndmask_b32 v8, 0, v8, vcc
    v_lshl_add_u32 v6, v6, 1, s4
    v_lshl_add_u32 v7, v7, 1, s4
    v_lshlrev_b32 v12, 5, v0
    v_and_b32 v13, 0x3ff, v12
    v_and_b32 v14, 0x1ff, v12
    s_mul_i32 s6, s51, 4224
    s_add_u32 s6, s6, 154816
    v_add_u32 v9, s6, v12
    v_add_u32 v10, s6, v13
    v_add_u32 v11, s6, v14
    s_mul_i32 s6, s51, 4640
    s_add_u32 s6, s6, 147712
    v_add_u32 v12, s6, v12
    v_add_u32 v13, s6, v13
    v_add_u32 v14, s6, v14
    s_barrier
    ds_read_b128 v[64:67], v4 offset:0
    ds_read_b128 v[68:71], v4 offset:11616
    ds_read_b128 v[72:75], v4 offset:32
    ds_read_b128 v[76:79], v4 offset:11648
    ds_read_b128 v[80:83], v4 offset:64
    ds_read_b128 v[84:87], v4 offset:11680
    ds_read_b128 v[88:91], v4 offset:96
    ds_read_b128 v[92:95], v4 offset:11712
    ds_read_b128 v[96:99], v4 offset:128
    ds_read_b128 v[100:103], v4 offset:11744
    s_waitcnt lgkmcnt(8)
    v_mfma_f32_32x32x16_f16 v[192:207], v[64:67], v[68:71], 0
    ds_read_b128 v[104:107], v4 offset:160
    ds_read_b128 v[108:111], v4 offset:11776
    s_waitcnt lgkmcnt(8)
    v_mfma_f32_32x32x16_f16 v[192:207], v[72:75], v[76:79], v[192:207]
    ds_read_b128 v[112:115], v4 offset:192
    ds_read_b128 v[116:119], v4 offset:11808
    s_waitcnt lgkmcnt(8)
    v_mfma_f32_32x32x16_f16 v[192:207], v[80:83], v[84:87], v[192:207]
    ds_read_b128 v[120:123], v4 offset:224
    ds_read_b128 v[124:127], v4 offset:11840
    s_waitcnt lgkmcnt(8)
    v_mfma_f32_32x32x16_f16 v[192:207], v[88:91], v[92:95], v[192:207]
    ds_read_b128 v[128:131], v4 offset:256
    ds_read_b128 v[132:135], v4 offset:11872
    s_waitcnt lgkmcnt(8)
    v_mfma_f32_32x32x16_f16 v[192:207], v[96:99], v[100:103], v[192:207]
    ds_read_b128 v[136:139], v4 offset:288
    ds_read_b128 v[140:143], v4 offset:11904
    s_waitcnt lgkmcnt(8)
    v_mfma_f32_32x32x16_f16 v[192:207], v[104:107], v[108:111], v[192:207]
    ds_read_b128 v[144:147], v4 offset:320
    ds_read_b128 v[148:151], v4 offset:11936
    s_waitcnt lgkmcnt(8)
    v_mfma_f32_32x32x16_f16 v[192:207], v[112:115], v[116:119], v[192:207]
    ds_read_b128 v[152:155], v4 offset:352
    ds_read_b128 v[156:159], v4 offset:11968
    s_waitcnt lgkmcnt(8)
    v_mfma_f32_32x32x16_f16 v[192:207], v[120:123], v[124:127], v[192:207]
    ds_read_b128 v[160:163], v4 offset:384
    ds_read_b128 v[164:167], v4 offset:12000
    s_waitcnt lgkmcnt(8)
    v_mfma_f32_32x32x16_f16 v[192:207], v[128:131], v[132:135], v[192:207]
    ds_read_b128 v[168:171], v4 offset:416
    ds_read_b128 v[172:175], v4 offset:12032
    s_waitcnt lgkmcnt(8)
    v_mfma_f32_32x32x16_f16 v[192:207], v[136:139], v[140:143], v[192:207]
    ds_read_b128 v[176:179], v4 offset:448
    ds_read_b128 v[180:183], v4 offset:12064
    s_waitcnt lgkmcnt(8)
    v_mfma_f32_32x32x16_f16 v[192:207], v[144:147], v[148:151], v[192:207]
    ds_read_b128 v[184:187], v4 offset:480
    ds_read_b128 v[188:191], v4 offset:12096
    s_waitcnt lgkmcnt(8)
    v_mfma_f32_32x32x16_f16 v[192:207], v[152:155], v[156:159], v[192:207]
    s_waitcnt lgkmcnt(6)
    v_mfma_f32_32x32x16_f16 v[192:207], v[160:163], v[164:167], v[192:207]
    s_waitcnt lgkmcnt(4)
    v_mfma_f32_32x32x16_f16 v[192:207], v[168:171], v[172:175], v[192:207]
    s_waitcnt lgkmcnt(2)
    v_mfma_f32_32x32x16_f16 v[192:207], v[176:179], v[180:183], v[192:207]
    s_waitcnt lgkmcnt(0)
    v_mfma_f32_32x32x16_f16 v[192:207], v[184:187], v[188:191], v[192:207]
    s_nop 7
    s_nop 4
    v_fma_f32 v192, v192, v212, v8
    v_mul_f32 v193, v193, v213
    v_mul_f32 v194, v194, v214
    v_mul_f32 v195, v195, v215
    v_mul_f32 v196, v196, v216
    v_mul_f32 v197, v197, v217
    v_mul_f32 v198, v198, v218
    v_mul_f32 v199, v199, v219
    v_mul_f32 v200, v200, v220
    v_mul_f32 v201, v201, v221
    v_mul_f32 v202, v202, v222
    v_cvt_pk_bf16_f32 v212, v192, v193
    v_cvt_pk_bf16_f32 v213, v194, v195
    v_cvt_pk_bf16_f32 v214, v196, v197
    v_cvt_pk_bf16_f32 v215, v198, v199
    v_cvt_pk_bf16_f32 v216, v200, v201
    v_cvt_pk_bf16_f32 v217, v202, v203
    ds_write_b64 v6, v[212:213]
    ds_write_b16 v6, v214 offset:512
    ds_write_b16_d16_hi v6, v214 offset:516
    ds_write_b16 v6, v215 offset:1024
    ds_write_b16_d16_hi v6, v215 offset:1536
    ds_write_b16 v7, v216 offset:2048
    ds_write_b16_d16_hi v7, v216 offset:2560
    s_mov_b64 exec, 1
    ds_write_b16 v7, v217 offset:4096
    s_mov_b64 exec, -1
    s_waitcnt lgkmcnt(0)
    s_mov_b32 s64, s46
    s_and_b32 s65, s47, 0xffff
    s_mov_b32 s66, 256
    s_mov_b32 s67, 0x00020000
    buffer_load_dword v250, v232, s[64:67], 0 offen sc1
    s_barrier
    ds_read_b64_tr_b16 v[64:65], v224 offset:0
    ds_read_b64_tr_b16 v[66:67], v226 offset:0
    ds_read_b64_tr_b16 v[72:73], v225 offset:0
    ds_read_b64_tr_b16 v[74:75], v227 offset:0
    ds_read_b64_tr_b16 v[80:81], v224 offset:4096
    ds_read_b64_tr_b16 v[82:83], v226 offset:4096
    ds_read_b64_tr_b16 v[88:89], v225 offset:4096
    ds_read_b64_tr_b16 v[90:91], v227 offset:4096
    s_waitcnt lgkmcnt(0)
    s_barrier
    v_alignbit_b32 v68, v67, v67, 16
    v_alignbit_b32 v69, v66, v66, 16
    v_alignbit_b32 v70, v65, v65, 16
    v_alignbit_b32 v71, v64, v64, 16
    s_add_u32 s6, s72, 0
    buffer_store_dwordx4 v[68:71], v228, s[60:63], s6 offen sc1
    v_alignbit_b32 v76, v75, v75, 16
    v_alignbit_b32 v77, v74, v74, 16
    v_alignbit_b32 v78, v73, v73, 16
    v_alignbit_b32 v79, v72, v72, 16
    s_add_u32 s6, s72, 67584
    buffer_store_dwordx4 v[76:79], v228, s[60:63], s6 offen sc1
    v_alignbit_b32 v84, v83, v83, 16
    v_alignbit_b32 v85, v82, v82, 16
    v_alignbit_b32 v86, v81, v81, 16
    v_alignbit_b32 v87, v80, v80, 16
    s_add_u32 s6, s72, 0
    s_sub_u32 s6, s6, 64
    buffer_store_dwordx4 v[84:87], v228, s[60:63], s6 offen sc1
    v_alignbit_b32 v92, v91, v91, 16
    v_alignbit_b32 v93, v90, v90, 16
    v_alignbit_b32 v94, v89, v89, 16
    v_alignbit_b32 v95, v88, v88, 16
    s_add_u32 s6, s72, 67584
    s_sub_u32 s6, s6, 64
    buffer_store_dwordx4 v[92:95], v228, s[60:63], s6 offen sc1
    s_barrier
    s_waitcnt vmcnt(0)
    v_readfirstlane_b32 s15, v250
    s_mov_b32 s5, 0
    s_cmp_lg_u32 s15, 0
    s_cbranch_scc1 L_epok2
L_eppoll2:
    buffer_load_dword v250, v232, s[64:67], 0 offen sc1
    s_add_u32 s5, s5, 1
    s_cmp_gt_u32 s5, 400000
    s_cbranch_scc1 L_epok2
    s_waitcnt vmcnt(0)
    v_readfirstlane_b32 s15, v250
    s_cmp_eq_u32 s15, 0
    s_cbranch_scc1 L_eppoll2
L_epok2:
    buffer_store_dword v250, v249, s[56:59], s79 offen sc1
    ds_read_b128 v[128:131], v9 offset:2560
    ds_read_b128 v[132:135], v9 offset:2576
    ds_read_b32 v136, v9 offset:2592
    ds_read_b128 v[140:143], v10 offset:1536
    ds_read_b128 v[144:147], v10 offset:1552
    ds_read_b32 v148, v10 offset:1568
    ds_read_b128 v[152:155], v11 offset:1024
    ds_read_b128 v[156:159], v11 offset:1040
    ds_read_b32 v160, v11 offset:1056
    ds_read_b128 v[216:219], v11 offset:512
    ds_read_b128 v[220:223], v11 offset:528
    s_barrier
    s_waitcnt lgkmcnt(0)
    s_mov_b32 s4, 0x01000100
    s_mov_b32 s5, 0x05040100
    v_perm_b32 v192, v128, v128, s4
    v_perm_b32 v193, v128, v128, s4
    v_perm_b32 v194, v132, v128, s5
    v_perm_b32 v195, v132, v132, s4
    v_perm_b32 v196, v132, v132, s4
    v_perm_b32 v197, v132, v132, s4
    v_perm_b32 v198, v136, v136, s4
    v_perm_b32 v199, v136, v136, s4
    s_barrier
    s_mov_b32 s4, 0x01000100
    s_mov_b32 s5, 0x05040100
    v_perm_b32 v200, v140, v140, s4
    v_perm_b32 v201, v142, v140, s5
    v_perm_b32 v202, v142, v142, s4
    v_perm_b32 v203, v144, v144, s4
    v_perm_b32 v204, v144, v144, s4
    v_perm_b32 v205, v146, v144, s5
    v_perm_b32 v206, v146, v146, s4
    v_perm_b32 v207, v148, v148, s4
    s_barrier
    s_mov_b32 s4, 0x01000100
    s_mov_b32 s5, 0x05040100
    v_perm_b32 v208, v152, v152, s4
    v_perm_b32 v209, v154, v153, s5
    v_perm_b32 v210, v154, v154, s4
    v_perm_b32 v211, v156, v155, s5
    v_perm_b32 v212, v156, v156, s4
    v_perm_b32 v213, v158, v157, s5
    v_perm_b32 v214, v158, v158, s4
    v_perm_b32 v215, v160, v159, s5
    s_sub_u32 s6, s3, 4
    s_mov_b32 s68, s40
    s_and_b32 s69, s41, 0xffff
    s_mov_b32 s70, 1835008
    s_mov_b32 s71, 0x00020000
    s_lshl_b32 s72, s81, 7
    s_lshl_b32 s4, s6, 14
    s_add_u32 s72, s72, s4
    s_lshl_b32 s73, s6, 11
    s_barrier
    s_barrier
    s_add_u32 s77, s82, 4
    s_sub_u32 s4, s77, 28
    s_cmp_ge_u32 s77, 28
    s_cselect_b32 s77, s4, s77
    s_lshl_b32 s77, s77, 16
    s_add_u32 s77, s77, s72
    s_add_u32 m0, s73, 0
    s_nop 0
    buffer_load_dwordx4 v240, s[68:71], s77 offen lds
    s_add_u32 m0, s73, 1024
    s_add_u32 s77, s77, 8192
    buffer_load_dwordx4 v240, s[68:71], s77 offen lds
    s_add_u32 s77, s82, 5
    s_sub_u32 s4, s77, 28
    s_cmp_ge_u32 s77, 28
    s_cselect_b32 s77, s4, s77
    s_lshl_b32 s77, s77, 16
    s_add_u32 s77, s77, s72
    s_add_u32 m0, s73, 8192
    s_nop 0
    buffer_load_dwordx4 v240, s[68:71], s77 offen lds
    s_add_u32 m0, s73, 9216
    s_add_u32 s77, s77, 8192
    buffer_load_dwordx4 v240, s[68:71], s77 offen lds
    s_add_u32 s77, s82, 6
    s_sub_u32 s4, s77, 28
    s_cmp_ge_u32 s77, 28
    s_cselect_b32 s77, s4, s77
    s_lshl_b32 s77, s77, 16
    s_add_u32 s77, s77, s72
    s_add_u32 m0, s73, 16384
    s_nop 0
    buffer_load_dwordx4 v240, s[68:71], s77 offen lds
    s_add_u32 m0, s73, 17408
    s_add_u32 s77, s77, 8192
    buffer_load_dwordx4 v240, s[68:71], s77 offen lds
    s_add_u32 s77, s82, 7
    s_sub_u32 s4, s77, 28
    s_cmp_ge_u32 s77, 28
    s_cselect_b32 s77, s4, s77
    s_lshl_b32 s77, s77, 16
    s_add_u32 s77, s77, s72
    s_add_u32 m0, s73, 24576
    s_nop 0
    buffer_load_dwordx4 v240, s[68:71], s77 offen lds
    s_add_u32 m0, s73, 25600
    s_add_u32 s77, s77, 8192
    buffer_load_dwordx4 v240, s[68:71], s77 offen lds
    s_add_u32 s77, s82, 8
    s_sub_u32 s4, s77, 28
    s_cmp_ge_u32 s77, 28
    s_cselect_b32 s77, s4, s77
    s_lshl_b32 s77, s77, 16
    s_add_u32 s77, s77, s72
    s_add_u32 m0, s73, 32768
    s_nop 0
    buffer_load_dwordx4 v240, s[68:71], s77 offen lds
    s_add_u32 m0, s73, 33792
    s_add_u32 s77, s77, 8192
    buffer_load_dwordx4 v240, s[68:71], s77 offen lds
    s_add_u32 s77, s82, 9
    s_sub_u32 s4, s77, 28
    s_cmp_ge_u32 s77, 28
    s_cselect_b32 s77, s4, s77
    s_lshl_b32 s77, s77, 16
    s_add_u32 s77, s77, s72
    s_add_u32 m0, s73, 40960
    s_nop 0
    buffer_load_dwordx4 v240, s[68:71], s77 offen lds
    s_add_u32 m0, s73, 41984
    s_add_u32 s77, s77, 8192
    buffer_load_dwordx4 v240, s[68:71], s77 offen lds
    s_barrier
    ds_write_b128 v12, v[192:195] offset:2560
    ds_write_b128 v12, v[196:199] offset:2576
    ds_write_b128 v13, v[200:203] offset:1536
    ds_write_b128 v13, v[204:207] offset:1552
    ds_write_b128 v14, v[208:211] offset:1024
    ds_write_b128 v14, v[212:215] offset:1040
    ds_write_b128 v14, v[216:219] offset:512
    ds_write_b128 v14, v[220:223] offset:528
    ds_write_b128 v14, v[232:235]
    ds_write_b128 v14, v[232:235] offset:16
    s_branch L_conv
L_cons0:
    s_or_b32 s4, s2, s3
    s_cmp_lg_u32 s4, 0
    s_cbranch_scc1 L_noep
    s_mov_b32 s56, s46
    s_and_b32 s57, s47, 0xffff
    s_mov_b32 s58, 256
    s_mov_b32 s59, 0x00020000
    s_or_b32 s4, s52, 1
    v_mov_b32 v2, s4
    v_lshlrev_b32 v3, 8, v0
    buffer_store_dword v2, v3, s[56:59], 0 offen sc1
L_noep:
    s_lshl_b32 s4, s8, 7
    s_lshl_b32 s5, s9, 3
    s_add_u32 s4, s4, s5
    s_lshl_b32 s5, s3, 1
    s_add_u32 s95, s4, s5
    s_lshl_b32 s5, s95, 10
    v_lshlrev_b32 v2, 4, v0
    v_add_u32 v3, s5, v2
    v_mov_b32 v22, v2
    v_mov_b32 v23, v3
    s_add_u32 s4, s12, 1
    s_and_b32 s4, s4, 2
    s_cmp_eq_u32 s4, 0
    s_cselect_b32 s89, 1, 0
    s_and_b32 s5, s3, 1
    s_lshr_b32 s6, s3, 1
    s_cselect_b32 s10, s5, s6
    s_cmp_eq_u32 s89, 1
    s_cselect_b32 s10, s5, s6
    s_cselect_b32 s11, s6, s5
    s_lshl_b32 s4, s5, 1
    s_cselect_b32 s55, s4, s3
    s_cmp_eq_u32 s89, 1
    s_cselect_b32 s55, s4, s3
    s_lshl_b32 s4, s6, 2
    s_cmp_eq_u32 s89, 1
    s_cselect_b32 s54, s4, 0
    s_cmp_eq_u32 s12, 2
    s_cselect_b32 s4, 2, 0
    s_add_u32 s54, s54, s4
    v_and_b32 v2, 15, v0
    v_lshrrev_b32 v3, 4, v0
    v_lshrrev_b32 v4, 1, v2
    v_xor_b32 v4, v4, v3
    v_lshlrev_b32 v4, 4, v4
    v_lshl_add_u32 v4, v2, 7, v4
    s_lshl_b32 s4, s55, 12
    s_add_u32 s4, s4, 32768
    v_add_u32 v40, s4, v4
    v_xor_b32 v41, 64, v40
    v_lshlrev_b32 v4, 4, v2
    v_lshl_add_u32 v254, v3, 9, v4
    v_bfe_u32 v5, v0, 2, 2
    v_and_b32 v6, 1, v3
    v_lshl_add_u32 v7, v5, 1, v6
    v_lshl_add_u32 v5, v3, 3, v5
    v_lshlrev_b32 v5, 8, v5
    v_and_b32 v6, 3, v0
    v_lshl_add_u32 v5, v6, 3, v5
    s_add_u32 s4, s54, 0
    s_and_b32 s4, s4, 7
    v_xor_b32 v6, s4, v7
    v_lshl_add_u32 v42, v6, 5, v5
    s_add_u32 s4, s54, 1
    s_and_b32 s4, s4, 7
    v_xor_b32 v6, s4, v7
    v_lshl_add_u32 v43, v6, 5, v5
    s_add_u32 s4, s54, 2
    s_and_b32 s4, s4, 7
    v_xor_b32 v6, s4, v7
    v_lshl_add_u32 v44, v6, 5, v5
    s_add_u32 s4, s54, 3
    s_and_b32 s4, s4, 7
    v_xor_b32 v6, s4, v7
    v_lshl_add_u32 v45, v6, 5, v5
    s_add_u32 s4, s54, 4
    s_and_b32 s4, s4, 7
    v_xor_b32 v6, s4, v7
    v_lshl_add_u32 v46, v6, 5, v5
    s_add_u32 s4, s54, 5
    s_and_b32 s4, s4, 7
    v_xor_b32 v6, s4, v7
    v_lshl_add_u32 v47, v6, 5, v5
    s_and_b32 s4, s2, 7
    s_lshr_b32 s5, s2, 3
    s_and_b32 s80, s5, 3
    s_mul_i32 s82, s80, 7
    s_lshl_b32 s4, s4, 2
    s_add_u32 s80, s80, s4
    s_lshr_b32 s81, s5, 2
    s_mul_i32 s4, s81, 7
    s_lshr_b32 s4, s4, 1
    s_add_u32 s82, s82, s4
    s_sub_u32 s4, s82, 28
    s_cmp_ge_u32 s82, 28
    s_cselect_b32 s82, s4, s82
    s_lshr_b32 s82, s80, 2
    s_mul_i32 s82, s82, 7
    s_lshr_b32 s82, s82, 2
    s_and_b32 s4, s80, 1
    s_mul_i32 s4, s4, 14
    s_add_u32 s82, s82, s4
    s_and_b32 s83, s3, 1
    s_bfe_u32 s84, s3, 0x10001
    s_lshr_b32 s85, s3, 2
    s_lshl_b32 s85, s85, 1
    s_add_u32 s85, s85, s83
    v_lshrrev_b32 v3, 3, v0
    v_and_b32 v4, 7, v0
    v_bfe_u32 v5, v0, 4, 1
    v_lshlrev_b32 v5, 2, v5
    v_xor_b32 v4, v4, v5
    v_lshlrev_b32 v4, 4, v4
    v_lshl_add_u32 v240, v3, 10, v4
    v_lshl_add_u32 v253, v3, 12, v4
    v_lshrrev_b32 v3, 5, v0
    v_bfe_u32 v4, v0, 4, 1
    v_bfe_u32 v5, v0, 2, 2
    v_and_b32 v6, 3, v0
    v_lshlrev_b32 v6, 3, v6
    v_lshl_add_u32 v6, v4, 5, v6
    v_bfe_u32 v7, v0, 3, 1
    v_lshlrev_b32 v7, 6, v7
    v_xor_b32 v6, v6, v7
    v_lshl_add_u32 v7, v3, 2, v5
    v_lshl_add_u32 v7, v7, 7, v6
    s_lshl_b32 s4, s83, 12
    v_add_u32 v241, s4, v7
    s_lshl_b32 s4, s85, 5
    v_xor_b32 v241, s4, v241
    v_xor_b32 v242, 64, v241
    v_add_u32 v244, 114944, v241
    v_add_u32 v245, 114944, v242
    v_lshl_add_u32 v7, v3, 2, v5
    s_lshl_b32 s4, s84, 6
    v_xor_b32 v6, s4, v6
    v_lshl_add_u32 v7, v7, 7, v6
    s_lshl_b32 s4, s85, 11
    s_add_u32 s4, s4, 0
    v_add_u32 v243, s4, v7
    s_lshl_b32 s4, s80, 6
    s_lshl_b32 s5, s84, 5
    s_add_u32 s4, s4, s5
    v_and_b32 v2, 31, v0
    v_add_u32 v246, s4, v2
    v_lshlrev_b32 v247, 4, v0
    v_mov_b32 v248, 0
    v_lshlrev_b32 v249, 20, v0
    v_mov_b32 v252, 1
    s_mov_b32 s64, s48
    s_and_b32 s65, s49, 0xffff
    s_mov_b32 s66, 7340032
    s_mov_b32 s67, 0x00020000
    s_lshl_b32 s4, s8, 2
    s_add_u32 s4, s4, s55
    s_mul_i32 s4, s4, 112
    s_lshl_b32 s5, s13, 2
    s_add_u32 s4, s4, s5
    s_add_u32 s4, s4, s54
    s_lshl_b32 s86, s4, 10
    s_add_u32 s87, s86, 114688
    s_add_u32 s88, s86, 4096
    s_mov_b32 s75, 0xbfb8aa3b
    s_mov_b32 s74, 0xbfb8aa3b
    s_add_u32 s56, s48, 14745600
    s_addc_u32 s57, s49, 0
    s_and_b32 s57, s57, 0xffff
    s_mov_b32 s58, 131072
    s_mov_b32 s59, 0x00020000
    s_lshl_b32 s4, s8, 1
    s_add_u32 s4, s4, s10
    s_lshl_b32 s4, s4, 8
    s_lshl_b32 s5, s9, 1
    s_add_u32 s5, s5, s11
    s_lshl_b32 s5, s5, 2
    s_add_u32 s79, s4, s5
    s_mov_b32 s68, s40
    s_and_b32 s69, s41, 0xffff
    s_mov_b32 s70, 1835008
    s_mov_b32 s71, 0x00020000
    s_lshl_b32 s72, s81, 7
    s_lshl_b32 s4, s3, 14
    s_add_u32 s72, s72, s4
    s_lshl_b32 s73, s3, 11
    s_waitcnt vmcnt(0)
    global_load_dwordx4 v[224:227], v23, s[16:17] offset:0
    global_load_dwordx4 v[228:231], v23, s[16:17] offset:1024
    global_load_dwordx4 v[232:235], v22, s[42:43]
    s_cmp_ge_u32 s3, 2
    s_cbranch_scc1 L_y1
    s_waitcnt lgkmcnt(0)
    s_lshl_b32 s4, s90, 16
    s_and_b32 s5, s90, 0xffff0000
    s_lshl_b32 s6, s91, 16
    s_and_b32 s7, s91, 0xffff0000
    s_cmp_eq_u32 s51, 0
    s_cselect_b32 s90, s4, s5
    s_cselect_b32 s91, s6, s7
    v_mov_b32 v68, s90
    s_mov_b32 s4, 0x3fb8aa3b
    v_mul_f32 v69, s4, v68
    v_fma_f32 v70, v68, s4, -v69
    v_fmac_f32 v70, 0x32a57060, v68
    v_exp_f32 v69, v69
    v_mul_f32 v70, 0x3f317218, v70
    v_fma_f32 v69, v69, v70, v69
    v_cvt_pk_bf16_f32 v72, v69, v69
    v_lshlrev_b32 v72, 16, v72
    s_mul_i32 s4, s51, 28512
    s_cmp_lt_u32 s3, 4
    s_cselect_b32 s5, 11616, 0
    s_add_u32 s4, s4, s5
    s_add_u32 s4, s4, 98304
    v_lshl_add_u32 v73, v0, 3, s4
    v_lshlrev_b32 v64, 16, v16
    v_and_b32 v65, 0xffff0000, v16
    v_lshlrev_b32 v66, 16, v17
    v_and_b32 v67, 0xffff0000, v17
    v_mul_f32 v64, v72, v64
    v_mul_f32 v66, v72, v66
    v_mul_f32 v65, v72, v65
    v_mul_f32 v67, v72, v67
    v_mul_f32 v64, 0x3fb8aa3b, v64
    v_mul_f32 v66, 0.15915494, v66
    v_mul_f32 v65, 0x3fb8aa3b, v65
    v_mul_f32 v67, 0.15915494, v67
    v_max_f32 v106, v64, v65
    v_lshlrev_b32 v86, 16, v18
    v_and_b32 v87, 0xffff0000, v18
    v_lshlrev_b32 v88, 16, v19
    v_and_b32 v89, 0xffff0000, v19
    v_lshlrev_b32 v90, 16, v20
    v_and_b32 v91, 0xffff0000, v20
    v_lshlrev_b32 v92, 16, v21
    v_and_b32 v93, 0xffff0000, v21
    v_mul_f32 v86, v72, v86
    v_mul_f32 v87, v72, v87
    v_mul_f32 v88, v72, v88
    v_mul_f32 v89, v72, v89
    v_pk_mul_f32 v[102:103], v[90:91], v[86:87]
    v_pk_mul_f32 v[104:105], v[90:91], v[88:89]
    v_pk_fma_f32 v[102:103], v[92:93], v[88:89], v[102:103] neg_lo:[1,0,0] neg_hi:[1,0,0]
    v_pk_fma_f32 v[104:105], v[92:93], v[86:87], v[104:105]
    v_max3_f32 v107, abs(v102), abs(v103), abs(v104)
    v_max_f32 v107, v107, abs(v105)
    s_nop 1
    v_max_f32_dpp v106, v106, v106 row_ror:8
    v_max_f32_dpp v107, v107, v107 row_ror:8
    s_nop 1
    v_max_f32_dpp v106, v106, v106 row_ror:4
    v_max_f32_dpp v107, v107, v107 row_ror:4
    s_nop 1
    v_max_f32_dpp v106, v106, v106 row_ror:2
    v_max_f32_dpp v107, v107, v107 row_ror:2
    s_nop 1
    v_max_f32_dpp v106, v106, v106 row_ror:1
    v_max_f32_dpp v107, v107, v107 row_ror:1
    s_nop 1
    v_max_f32_dpp v106, v106, v106 row_bcast:15 row_mask:0xa
    v_max_f32_dpp v107, v107, v107 row_bcast:15 row_mask:0xa
    s_nop 1
    v_max_f32_dpp v106, v106, v106 row_bcast:31 row_mask:0xc
    v_max_f32_dpp v107, v107, v107 row_bcast:31 row_mask:0xc
    s_nop 1
    v_readlane_b32 s92, v106, 63
    v_readlane_b32 s93, v107, 63
    s_nop 1
    v_subrev_f32 v64, s92, v64
    v_subrev_f32 v65, s92, v65
    s_and_b32 s93, s93, 0x7f800000
    s_max_u32 s93, s93, 0x00800000
    s_min_u32 s93, s93, 0x7e800000
    s_sub_u32 s4, 0x7f000000, s93
    v_mul_f32 v102, s4, v102
    v_mul_f32 v103, s4, v103
    v_mul_f32 v104, s4, v104
    v_mul_f32 v105, s4, v105
    s_lshr_b32 s93, s93, 23
    s_sub_u32 s93, s93, 127
    v_subrev_u32 v73, 11616, v73
    v_mul_f32 v68, 0x43800000, v64
    v_mul_f32 v70, 0x43800000, v66
    v_mul_f32 v69, 0x43800000, v65
    v_mul_f32 v71, 0x43800000, v67
    v_exp_f32 v68, v68
    v_fract_f32 v70, v70
    v_exp_f32 v69, v69
    v_fract_f32 v71, v71
    v_cos_f32 v78, v70
    v_sin_f32 v80, v70
    v_cos_f32 v79, v71
    v_sin_f32 v81, v71
    s_nop 0
    v_pk_mul_f32 v[78:79], v[78:79], v[68:69]
    v_pk_mul_f32 v[80:81], v[80:81], v[68:69]
    v_mul_f32 v68, 0x40800000, v64
    v_mul_f32 v70, 0x40800000, v66
    v_mul_f32 v69, 0x40800000, v65
    v_mul_f32 v71, 0x40800000, v67
    v_exp_f32 v68, v68
    v_fract_f32 v70, v70
    v_exp_f32 v69, v69
    v_fract_f32 v71, v71
    v_cos_f32 v82, v70
    v_sin_f32 v84, v70
    v_cos_f32 v83, v71
    v_sin_f32 v85, v71
    s_nop 0
    v_pk_mul_f32 v[82:83], v[82:83], v[68:69]
    v_pk_mul_f32 v[84:85], v[84:85], v[68:69]
    v_pk_mul_f32 v[94:95], v[102:103], v[78:79]
    v_pk_mul_f32 v[96:97], v[102:103], v[80:81]
    v_pk_fma_f32 v[94:95], v[104:105], v[80:81], v[94:95] neg_lo:[1,0,0] neg_hi:[1,0,0]
    v_pk_fma_f32 v[96:97], v[104:105], v[78:79], v[96:97]
    v_pk_mul_f32 v[86:87], v[94:95], v[78:79]
    v_pk_mul_f32 v[88:89], v[94:95], v[80:81]
    v_pk_fma_f32 v[86:87], v[96:97], v[80:81], v[86:87] neg_lo:[1,0,0] neg_hi:[1,0,0]
    v_pk_fma_f32 v[88:89], v[96:97], v[78:79], v[88:89]
    v_cvt_pk_f16_f32 v98, v86, -v88
    v_cvt_pk_f16_f32 v99, v87, -v89
    ds_write_b64 v73, v[98:99] offset:5280
    v_pk_mul_f32 v[94:95], v[86:87], v[82:83]
    v_pk_mul_f32 v[96:97], v[86:87], v[84:85]
    v_pk_fma_f32 v[94:95], v[88:89], v[84:85], v[94:95] neg_lo:[1,0,0] neg_hi:[1,0,0]
    v_pk_fma_f32 v[96:97], v[88:89], v[82:83], v[96:97]
    v_cvt_pk_f16_f32 v100, v94, -v96
    v_cvt_pk_f16_f32 v101, v95, -v97
    ds_write_b64 v73, v[100:101] offset:7392
    v_pk_mul_f32 v[90:91], v[86:87], v[78:79]
    v_pk_mul_f32 v[92:93], v[86:87], v[80:81]
    v_pk_fma_f32 v[90:91], v[88:89], v[80:81], v[90:91] neg_lo:[1,0,0] neg_hi:[1,0,0]
    v_pk_fma_f32 v[92:93], v[88:89], v[78:79], v[92:93]
    v_cvt_pk_f16_f32 v98, v90, -v92
    v_cvt_pk_f16_f32 v99, v91, -v93
    ds_write_b64 v73, v[98:99] offset:5808
    v_pk_mul_f32 v[94:95], v[90:91], v[82:83]
    v_pk_mul_f32 v[96:97], v[90:91], v[84:85]
    v_pk_fma_f32 v[94:95], v[92:93], v[84:85], v[94:95] neg_lo:[1,0,0] neg_hi:[1,0,0]
    v_pk_fma_f32 v[96:97], v[92:93], v[82:83], v[96:97]
    v_cvt_pk_f16_f32 v100, v94, -v96
    v_cvt_pk_f16_f32 v101, v95, -v97
    ds_write_b64 v73, v[100:101] offset:7920
    v_pk_mul_f32 v[86:87], v[90:91], v[78:79]
    v_pk_mul_f32 v[88:89], v[90:91], v[80:81]
    v_pk_fma_f32 v[86:87], v[92:93], v[80:81], v[86:87] neg_lo:[1,0,0] neg_hi:[1,0,0]
    v_pk_fma_f32 v[88:89], v[92:93], v[78:79], v[88:89]
    v_cvt_pk_f16_f32 v98, v86, -v88
    v_cvt_pk_f16_f32 v99, v87, -v89
    ds_write_b64 v73, v[98:99] offset:8448
    v_pk_mul_f32 v[90:91], v[86:87], v[78:79]
    v_pk_mul_f32 v[92:93], v[86:87], v[80:81]
    v_pk_fma_f32 v[90:91], v[88:89], v[80:81], v[90:91] neg_lo:[1,0,0] neg_hi:[1,0,0]
    v_pk_fma_f32 v[92:93], v[88:89], v[78:79], v[92:93]
    v_cvt_pk_f16_f32 v100, v90, -v92
    v_cvt_pk_f16_f32 v101, v91, -v93
    ds_write_b64 v73, v[100:101] offset:8976
    v_pk_mul_f32 v[86:87], v[90:91], v[78:79]
    v_pk_mul_f32 v[88:89], v[90:91], v[80:81]
    v_pk_fma_f32 v[86:87], v[92:93], v[80:81], v[86:87] neg_lo:[1,0,0] neg_hi:[1,0,0]
    v_pk_fma_f32 v[88:89], v[92:93], v[78:79], v[88:89]
    v_cvt_pk_f16_f32 v98, v86, -v88
    v_cvt_pk_f16_f32 v99, v87, -v89
    ds_write_b64 v73, v[98:99] offset:10560
    v_pk_mul_f32 v[90:91], v[86:87], v[78:79]
    v_pk_mul_f32 v[92:93], v[86:87], v[80:81]
    v_pk_fma_f32 v[90:91], v[88:89], v[80:81], v[90:91] neg_lo:[1,0,0] neg_hi:[1,0,0]
    v_pk_fma_f32 v[92:93], v[88:89], v[78:79], v[92:93]
    v_cvt_pk_f16_f32 v100, v90, -v92
    v_cvt_pk_f16_f32 v101, v91, -v93
    ds_write_b64 v73, v[100:101] offset:11088
    v_pk_mul_f32 v[86:87], v[90:91], v[78:79]
    v_pk_mul_f32 v[88:89], v[90:91], v[80:81]
    v_pk_fma_f32 v[86:87], v[92:93], v[80:81], v[86:87] neg_lo:[1,0,0] neg_hi:[1,0,0]
    v_pk_fma_f32 v[88:89], v[92:93], v[78:79], v[88:89]
    v_cvt_pk_f16_f32 v98, v86, -v88
    v_cvt_pk_f16_f32 v99, v87, -v89
    ds_write_b64 v73, v[98:99] offset:9504
    v_add_u32 v73, 11616, v73
    v_pk_mul_f32 v[74:75], v[82:83], v[82:83]
    v_pk_mul_f32 v[76:77], v[82:83], v[84:85]
    v_pk_fma_f32 v[74:75], v[84:85], v[84:85], v[74:75] neg_lo:[1,0,0] neg_hi:[1,0,0]
    v_pk_fma_f32 v[76:77], v[84:85], v[82:83], v[76:77]
    v_mov_b32 v100, 0x3c00
    v_mov_b32 v101, 0x3c00
    ds_write_b64 v73, v[100:101]
    v_cvt_pk_f16_f32 v98, v74, v76
    v_cvt_pk_f16_f32 v99, v75, v77
    ds_write_b64 v73, v[98:99] offset:528
    v_pk_mul_f32 v[90:91], v[74:75], v[74:75]
    v_pk_mul_f32 v[92:93], v[74:75], v[76:77]
    v_pk_fma_f32 v[90:91], v[76:77], v[76:77], v[90:91] neg_lo:[1,0,0] neg_hi:[1,0,0]
    v_pk_fma_f32 v[92:93], v[76:77], v[74:75], v[92:93]
    v_cvt_pk_f16_f32 v100, v90, v92
    v_cvt_pk_f16_f32 v101, v91, v93
    ds_write_b64 v73, v[100:101] offset:1056
    v_pk_mul_f32 v[86:87], v[90:91], v[74:75]
    v_pk_mul_f32 v[88:89], v[90:91], v[76:77]
    v_pk_fma_f32 v[86:87], v[92:93], v[76:77], v[86:87] neg_lo:[1,0,0] neg_hi:[1,0,0]
    v_pk_fma_f32 v[88:89], v[92:93], v[74:75], v[88:89]
    v_cvt_pk_f16_f32 v98, v86, v88
    v_cvt_pk_f16_f32 v99, v87, v89
    ds_write_b64 v73, v[98:99] offset:1584
    v_pk_mul_f32 v[90:91], v[86:87], v[74:75]
    v_pk_mul_f32 v[92:93], v[86:87], v[76:77]
    v_pk_fma_f32 v[90:91], v[88:89], v[76:77], v[90:91] neg_lo:[1,0,0] neg_hi:[1,0,0]
    v_pk_fma_f32 v[92:93], v[88:89], v[74:75], v[92:93]
    v_cvt_pk_f16_f32 v100, v90, v92
    v_cvt_pk_f16_f32 v101, v91, v93
    ds_write_b64 v73, v[100:101] offset:2112
    v_pk_mul_f32 v[86:87], v[90:91], v[74:75]
    v_pk_mul_f32 v[88:89], v[90:91], v[76:77]
    v_pk_fma_f32 v[86:87], v[92:93], v[76:77], v[86:87] neg_lo:[1,0,0] neg_hi:[1,0,0]
    v_pk_fma_f32 v[88:89], v[92:93], v[74:75], v[88:89]
    v_cvt_pk_f16_f32 v98, v86, v88
    v_cvt_pk_f16_f32 v99, v87, v89
    ds_write_b64 v73, v[98:99] offset:2640
    v_pk_mul_f32 v[90:91], v[86:87], v[74:75]
    v_pk_mul_f32 v[92:93], v[86:87], v[76:77]
    v_pk_fma_f32 v[90:91], v[88:89], v[76:77], v[90:91] neg_lo:[1,0,0] neg_hi:[1,0,0]
    v_pk_fma_f32 v[92:93], v[88:89], v[74:75], v[92:93]
    v_cvt_pk_f16_f32 v100, v90, v92
    v_cvt_pk_f16_f32 v101, v91, v93
    ds_write_b64 v73, v[100:101] offset:3168
    v_pk_mul_f32 v[86:87], v[90:91], v[74:75]
    v_pk_mul_f32 v[88:89], v[90:91], v[76:77]
    v_pk_fma_f32 v[86:87], v[92:93], v[76:77], v[86:87] neg_lo:[1,0,0] neg_hi:[1,0,0]
    v_pk_fma_f32 v[88:89], v[92:93], v[74:75], v[88:89]
    v_cvt_pk_f16_f32 v98, v86, v88
    v_cvt_pk_f16_f32 v99, v87, v89
    ds_write_b64 v73, v[98:99] offset:3696
    v_pk_mul_f32 v[90:91], v[86:87], v[74:75]
    v_pk_mul_f32 v[92:93], v[86:87], v[76:77]
    v_pk_fma_f32 v[90:91], v[88:89], v[76:77], v[90:91] neg_lo:[1,0,0] neg_hi:[1,0,0]
    v_pk_fma_f32 v[92:93], v[88:89], v[74:75], v[92:93]
    v_cvt_pk_f16_f32 v100, v90, v92
    v_cvt_pk_f16_f32 v101, v91, v93
    ds_write_b64 v73, v[100:101] offset:4224
    v_pk_mul_f32 v[86:87], v[90:91], v[74:75]
    v_pk_mul_f32 v[88:89], v[90:91], v[76:77]
    v_pk_fma_f32 v[86:87], v[92:93], v[76:77], v[86:87] neg_lo:[1,0,0] neg_hi:[1,0,0]
    v_pk_fma_f32 v[88:89], v[92:93], v[74:75], v[88:89]
    v_cvt_pk_f16_f32 v98, v86, v88
    v_cvt_pk_f16_f32 v99, v87, v89
    ds_write_b64 v73, v[98:99] offset:4752
    v_pk_mul_f32 v[90:91], v[86:87], v[74:75]
    v_pk_mul_f32 v[92:93], v[86:87], v[76:77]
    v_pk_fma_f32 v[90:91], v[88:89], v[76:77], v[90:91] neg_lo:[1,0,0] neg_hi:[1,0,0]
    v_pk_fma_f32 v[92:93], v[88:89], v[74:75], v[92:93]
    v_cvt_pk_f16_f32 v100, v90, v92
    v_cvt_pk_f16_f32 v101, v91, v93
    ds_write_b64 v73, v[100:101] offset:5280
    v_pk_mul_f32 v[86:87], v[90:91], v[74:75]
    v_pk_mul_f32 v[88:89], v[90:91], v[76:77]
    v_pk_fma_f32 v[86:87], v[92:93], v[76:77], v[86:87] neg_lo:[1,0,0] neg_hi:[1,0,0]
    v_pk_fma_f32 v[88:89], v[92:93], v[74:75], v[88:89]
    v_cvt_pk_f16_f32 v98, v86, v88
    v_cvt_pk_f16_f32 v99, v87, v89
    ds_write_b64 v73, v[98:99] offset:5808
    v_pk_mul_f32 v[90:91], v[86:87], v[74:75]
    v_pk_mul_f32 v[92:93], v[86:87], v[76:77]
    v_pk_fma_f32 v[90:91], v[88:89], v[76:77], v[90:91] neg_lo:[1,0,0] neg_hi:[1,0,0]
    v_pk_fma_f32 v[92:93], v[88:89], v[74:75], v[92:93]
    v_cvt_pk_f16_f32 v100, v90, v92
    v_cvt_pk_f16_f32 v101, v91, v93
    ds_write_b64 v73, v[100:101] offset:6336
    v_pk_mul_f32 v[86:87], v[90:91], v[74:75]
    v_pk_mul_f32 v[88:89], v[90:91], v[76:77]
    v_pk_fma_f32 v[86:87], v[92:93], v[76:77], v[86:87] neg_lo:[1,0,0] neg_hi:[1,0,0]
    v_pk_fma_f32 v[88:89], v[92:93], v[74:75], v[88:89]
    v_cvt_pk_f16_f32 v98, v86, v88
    v_cvt_pk_f16_f32 v99, v87, v89
    ds_write_b64 v73, v[98:99] offset:6864
    v_pk_mul_f32 v[90:91], v[86:87], v[74:75]
    v_pk_mul_f32 v[92:93], v[86:87], v[76:77]
    v_pk_fma_f32 v[90:91], v[88:89], v[76:77], v[90:91] neg_lo:[1,0,0] neg_hi:[1,0,0]
    v_pk_fma_f32 v[92:93], v[88:89], v[74:75], v[92:93]
    v_cvt_pk_f16_f32 v100, v90, v92
    v_cvt_pk_f16_f32 v101, v91, v93
    ds_write_b64 v73, v[100:101] offset:7392
    v_pk_mul_f32 v[86:87], v[90:91], v[74:75]
    v_pk_mul_f32 v[88:89], v[90:91], v[76:77]
    v_pk_fma_f32 v[86:87], v[92:93], v[76:77], v[86:87] neg_lo:[1,0,0] neg_hi:[1,0,0]
    v_pk_fma_f32 v[88:89], v[92:93], v[74:75], v[88:89]
    v_cvt_pk_f16_f32 v98, v86, v88
    v_cvt_pk_f16_f32 v99, v87, v89
    ds_write_b64 v73, v[98:99] offset:7920
    s_waitcnt lgkmcnt(0)
    s_branch L_ydone
L_y1:
    s_waitcnt lgkmcnt(0)
    s_lshl_b32 s4, s90, 16
    s_and_b32 s5, s90, 0xffff0000
    s_lshl_b32 s6, s91, 16
    s_and_b32 s7, s91, 0xffff0000
    s_cmp_eq_u32 s51, 0
    s_cselect_b32 s90, s4, s5
    s_cselect_b32 s91, s6, s7
    v_mov_b32 v68, s90
    s_mov_b32 s4, 0x3fb8aa3b
    v_mul_f32 v69, s4, v68
    v_fma_f32 v70, v68, s4, -v69
    v_fmac_f32 v70, 0x32a57060, v68
    v_exp_f32 v69, v69
    v_mul_f32 v70, 0x3f317218, v70
    v_fma_f32 v69, v69, v70, v69
    v_cvt_pk_bf16_f32 v72, v69, v69
    v_lshlrev_b32 v72, 16, v72
    s_mul_i32 s4, s51, 28512
    s_cmp_lt_u32 s3, 4
    s_cselect_b32 s5, 11616, 0
    s_add_u32 s4, s4, s5
    s_add_u32 s4, s4, 98304
    v_lshl_add_u32 v73, v0, 3, s4
    v_lshlrev_b32 v64, 16, v16
    v_and_b32 v65, 0xffff0000, v16
    v_lshlrev_b32 v66, 16, v17
    v_and_b32 v67, 0xffff0000, v17
    v_mul_f32 v64, v72, v64
    v_mul_f32 v66, v72, v66
    v_mul_f32 v65, v72, v65
    v_mul_f32 v67, v72, v67
    v_mul_f32 v64, 0x3fb8aa3b, v64
    v_mul_f32 v66, 0.15915494, v66
    v_mul_f32 v65, 0x3fb8aa3b, v65
    v_mul_f32 v67, 0.15915494, v67
    v_max_f32 v106, v64, v65
    s_nop 1
    v_max_f32_dpp v106, v106, v106 row_ror:8
    s_nop 1
    v_max_f32_dpp v106, v106, v106 row_ror:4
    s_nop 1
    v_max_f32_dpp v106, v106, v106 row_ror:2
    s_nop 1
    v_max_f32_dpp v106, v106, v106 row_ror:1
    s_nop 1
    v_max_f32_dpp v106, v106, v106 row_bcast:15 row_mask:0xa
    s_nop 1
    v_max_f32_dpp v106, v106, v106 row_bcast:31 row_mask:0xc
    s_nop 1
    v_readlane_b32 s92, v106, 63
    s_nop 1
    v_subrev_f32 v64, s92, v64
    v_subrev_f32 v65, s92, v65
    v_mul_f32 v68, 0x41000000, v64
    v_mul_f32 v70, 0x41000000, v66
    v_mul_f32 v69, 0x41000000, v65
    v_mul_f32 v71, 0x41000000, v67
    v_exp_f32 v68, v68
    v_fract_f32 v70, v70
    v_exp_f32 v69, v69
    v_fract_f32 v71, v71
    v_cos_f32 v74, v70
    v_sin_f32 v76, v70
    v_cos_f32 v75, v71
    v_sin_f32 v77, v71
    s_nop 0
    v_pk_mul_f32 v[74:75], v[74:75], v[68:69]
    v_pk_mul_f32 v[76:77], v[76:77], v[68:69]
    v_mul_f32 v68, 0x43000000, v64
    v_mul_f32 v70, 0x43000000, v66
    v_mul_f32 v69, 0x43000000, v65
    v_mul_f32 v71, 0x43000000, v67
    v_exp_f32 v68, v68
    v_fract_f32 v70, v70
    v_exp_f32 v69, v69
    v_fract_f32 v71, v71
    v_cos_f32 v90, v70
    v_sin_f32 v92, v70
    v_cos_f32 v91, v71
    v_sin_f32 v93, v71
    s_nop 0
    v_pk_mul_f32 v[90:91], v[90:91], v[68:69]
    v_pk_mul_f32 v[92:93], v[92:93], v[68:69]
    v_cvt_pk_f16_f32 v98, v90, v92
    v_cvt_pk_f16_f32 v99, v91, v93
    ds_write_b64 v73, v[98:99] offset:8448
    v_pk_mul_f32 v[86:87], v[90:91], v[74:75]
    v_pk_mul_f32 v[88:89], v[90:91], v[76:77]
    v_pk_fma_f32 v[86:87], v[92:93], v[76:77], v[86:87] neg_lo:[1,0,0] neg_hi:[1,0,0]
    v_pk_fma_f32 v[88:89], v[92:93], v[74:75], v[88:89]
    v_cvt_pk_f16_f32 v100, v86, v88
    v_cvt_pk_f16_f32 v101, v87, v89
    ds_write_b64 v73, v[100:101] offset:8976
    v_pk_mul_f32 v[90:91], v[86:87], v[74:75]
    v_pk_mul_f32 v[92:93], v[86:87], v[76:77]
    v_pk_fma_f32 v[90:91], v[88:89], v[76:77], v[90:91] neg_lo:[1,0,0] neg_hi:[1,0,0]
    v_pk_fma_f32 v[92:93], v[88:89], v[74:75], v[92:93]
    v_cvt_pk_f16_f32 v98, v90, v92
    v_cvt_pk_f16_f32 v99, v91, v93
    ds_write_b64 v73, v[98:99] offset:9504
    v_pk_mul_f32 v[86:87], v[90:91], v[74:75]
    v_pk_mul_f32 v[88:89], v[90:91], v[76:77]
    v_pk_fma_f32 v[86:87], v[92:93], v[76:77], v[86:87] neg_lo:[1,0,0] neg_hi:[1,0,0]
    v_pk_fma_f32 v[88:89], v[92:93], v[74:75], v[88:89]
    v_cvt_pk_f16_f32 v100, v86, v88
    v_cvt_pk_f16_f32 v101, v87, v89
    ds_write_b64 v73, v[100:101] offset:10032
    v_pk_mul_f32 v[90:91], v[86:87], v[74:75]
    v_pk_mul_f32 v[92:93], v[86:87], v[76:77]
    v_pk_fma_f32 v[90:91], v[88:89], v[76:77], v[90:91] neg_lo:[1,0,0] neg_hi:[1,0,0]
    v_pk_fma_f32 v[92:93], v[88:89], v[74:75], v[92:93]
    v_cvt_pk_f16_f32 v98, v90, v92
    v_cvt_pk_f16_f32 v99, v91, v93
    ds_write_b64 v73, v[98:99] offset:10560
    v_pk_mul_f32 v[86:87], v[90:91], v[74:75]
    v_pk_mul_f32 v[88:89], v[90:91], v[76:77]
    v_pk_fma_f32 v[86:87], v[92:93], v[76:77], v[86:87] neg_lo:[1,0,0] neg_hi:[1,0,0]
    v_pk_fma_f32 v[88:89], v[92:93], v[74:75], v[88:89]
    v_cvt_pk_f16_f32 v100, v86, v88
    v_cvt_pk_f16_f32 v101, v87, v89
    ds_write_b64 v73, v[100:101] offset:11088
    v_pk_mul_f32 v[90:91], v[86:87], v[74:75]
    v_pk_mul_f32 v[92:93], v[86:87], v[76:77]
    v_pk_fma_f32 v[90:91], v[88:89], v[76:77], v[90:91] neg_lo:[1,0,0] neg_hi:[1,0,0]
    v_pk_fma_f32 v[92:93], v[88:89], v[74:75], v[92:93]
    v_cvt_pk_f16_f32 v98, v90, v92
    v_cvt_pk_f16_f32 v99, v91, v93
    ds_write_b64 v73, v[98:99] offset:11616
    v_pk_mul_f32 v[86:87], v[90:91], v[74:75]
    v_pk_mul_f32 v[88:89], v[90:91], v[76:77]
    v_pk_fma_f32 v[86:87], v[92:93], v[76:77], v[86:87] neg_lo:[1,0,0] neg_hi:[1,0,0]
    v_pk_fma_f32 v[88:89], v[92:93], v[74:75], v[88:89]
    v_cvt_pk_f16_f32 v100, v86, v88
    v_cvt_pk_f16_f32 v101, v87, v89
    ds_write_b64 v73, v[100:101] offset:12144
    v_pk_mul_f32 v[90:91], v[86:87], v[74:75]
    v_pk_mul_f32 v[92:93], v[86:87], v[76:77]
    v_pk_fma_f32 v[90:91], v[88:89], v[76:77], v[90:91] neg_lo:[1,0,0] neg_hi:[1,0,0]
    v_pk_fma_f32 v[92:93], v[88:89], v[74:75], v[92:93]
    v_cvt_pk_f16_f32 v98, v90, v92
    v_cvt_pk_f16_f32 v99, v91, v93
    ds_write_b64 v73, v[98:99] offset:12672
    v_pk_mul_f32 v[86:87], v[90:91], v[74:75]
    v_pk_mul_f32 v[88:89], v[90:91], v[76:77]
    v_pk_fma_f32 v[86:87], v[92:93], v[76:77], v[86:87] neg_lo:[1,0,0] neg_hi:[1,0,0]
    v_pk_fma_f32 v[88:89], v[92:93], v[74:75], v[88:89]
    v_cvt_pk_f16_f32 v100, v86, v88
    v_cvt_pk_f16_f32 v101, v87, v89
    ds_write_b64 v73, v[100:101] offset:13200
    v_pk_mul_f32 v[90:91], v[86:87], v[74:75]
    v_pk_mul_f32 v[92:93], v[86:87], v[76:77]
    v_pk_fma_f32 v[90:91], v[88:89], v[76:77], v[90:91] neg_lo:[1,0,0] neg_hi:[1,0,0]
    v_pk_fma_f32 v[92:93], v[88:89], v[74:75], v[92:93]
    v_cvt_pk_f16_f32 v98, v90, v92
    v_cvt_pk_f16_f32 v99, v91, v93
    ds_write_b64 v73, v[98:99] offset:13728
    v_pk_mul_f32 v[86:87], v[90:91], v[74:75]
    v_pk_mul_f32 v[88:89], v[90:91], v[76:77]
    v_pk_fma_f32 v[86:87], v[92:93], v[76:77], v[86:87] neg_lo:[1,0,0] neg_hi:[1,0,0]
    v_pk_fma_f32 v[88:89], v[92:93], v[74:75], v[88:89]
    v_cvt_pk_f16_f32 v100, v86, v88
    v_cvt_pk_f16_f32 v101, v87, v89
    ds_write_b64 v73, v[100:101] offset:14256
    v_pk_mul_f32 v[90:91], v[86:87], v[74:75]
    v_pk_mul_f32 v[92:93], v[86:87], v[76:77]
    v_pk_fma_f32 v[90:91], v[88:89], v[76:77], v[90:91] neg_lo:[1,0,0] neg_hi:[1,0,0]
    v_pk_fma_f32 v[92:93], v[88:89], v[74:75], v[92:93]
    v_cvt_pk_f16_f32 v98, v90, v92
    v_cvt_pk_f16_f32 v99, v91, v93
    ds_write_b64 v73, v[98:99] offset:14784
    v_pk_mul_f32 v[86:87], v[90:91], v[74:75]
    v_pk_mul_f32 v[88:89], v[90:91], v[76:77]
    v_pk_fma_f32 v[86:87], v[92:93], v[76:77], v[86:87] neg_lo:[1,0,0] neg_hi:[1,0,0]
    v_pk_fma_f32 v[88:89], v[92:93], v[74:75], v[88:89]
    v_cvt_pk_f16_f32 v100, v86, v88
    v_cvt_pk_f16_f32 v101, v87, v89
    ds_write_b64 v73, v[100:101] offset:15312
    v_pk_mul_f32 v[90:91], v[86:87], v[74:75]
    v_pk_mul_f32 v[92:93], v[86:87], v[76:77]
    v_pk_fma_f32 v[90:91], v[88:89], v[76:77], v[90:91] neg_lo:[1,0,0] neg_hi:[1,0,0]
    v_pk_fma_f32 v[92:93], v[88:89], v[74:75], v[92:93]
    v_cvt_pk_f16_f32 v98, v90, v92
    v_cvt_pk_f16_f32 v99, v91, v93
    ds_write_b64 v73, v[98:99] offset:15840
    v_pk_mul_f32 v[86:87], v[90:91], v[74:75]
    v_pk_mul_f32 v[88:89], v[90:91], v[76:77]
    v_pk_fma_f32 v[86:87], v[92:93], v[76:77], v[86:87] neg_lo:[1,0,0] neg_hi:[1,0,0]
    v_pk_fma_f32 v[88:89], v[92:93], v[74:75], v[88:89]
    v_cvt_pk_f16_f32 v100, v86, v88
    v_cvt_pk_f16_f32 v101, v87, v89
    ds_write_b64 v73, v[100:101] offset:16368
    s_waitcnt lgkmcnt(0)
L_ydone:
    s_barrier
    s_waitcnt vmcnt(0)
    v_mov_b32 v16, 0
    v_mov_b32 v17, 0
    v_dot2_f32_bf16 v16, v224, v232, v16
    v_dot2_f32_bf16 v17, v228, v232, v17
    v_dot2_f32_bf16 v16, v225, v233, v16
    v_dot2_f32_bf16 v17, v229, v233, v17
    v_dot2_f32_bf16 v16, v226, v234, v16
    v_dot2_f32_bf16 v17, v230, v234, v17
    v_dot2_f32_bf16 v16, v227, v235, v16
    v_dot2_f32_bf16 v17, v231, v235, v17
    s_nop 2
    s_nop 0
    v_add_f32_dpp v16, v16, v16 row_ror:8
    v_add_f32_dpp v17, v17, v17 row_ror:8
    s_nop 0
    v_add_f32_dpp v16, v16, v16 row_ror:4
    v_add_f32_dpp v17, v17, v17 row_ror:4
    s_nop 0
    v_add_f32_dpp v16, v16, v16 row_ror:2
    v_add_f32_dpp v17, v17, v17 row_ror:2
    s_nop 0
    v_add_f32_dpp v16, v16, v16 row_ror:1
    v_add_f32_dpp v17, v17, v17 row_ror:1
    s_nop 0
    v_add_f32_dpp v16, v16, v16 row_bcast:15 row_mask:0xa
    v_add_f32_dpp v17, v17, v17 row_bcast:15 row_mask:0xa
    s_nop 0
    v_add_f32_dpp v16, v16, v16 row_bcast:31 row_mask:0xc
    v_add_f32_dpp v17, v17, v17 row_bcast:31 row_mask:0xc
    v_cvt_pk_bf16_f32 v18, v16, v17
    v_lshlrev_b32 v16, 16, v18
    v_and_b32 v17, 0xffff0000, v18
    v_mul_f32 v16, 0xbfb8aa3b, v16
    v_mul_f32 v17, 0xbfb8aa3b, v17
    v_exp_f32 v16, v16
    v_exp_f32 v17, v17
    s_nop 0
    v_add_f32 v16, 1.0, v16
    v_add_f32 v17, 1.0, v17
    v_rcp_f32 v16, v16
    v_rcp_f32 v17, v17
    s_nop 0
    v_cvt_pk_bf16_f32 v18, v16, v17
    v_lshlrev_b32 v16, 16, v18
    v_and_b32 v17, 0xffff0000, v18
    s_add_u32 s60, s48, 14680064
    s_addc_u32 s61, s49, 0
    s_and_b32 s61, s61, 0xffff
    s_mov_b32 s62, 8192
    s_mov_b32 s63, 0x00020000
    s_lshl_b32 s4, s95, 2
    v_cmp_eq_u32 vcc, 63, v0
    v_mov_b32 v19, 0x100000
    s_nop 0
    v_cndmask_b32 v19, v19, 0, vcc
    buffer_store_dwordx2 v[16:17], v19, s[60:63], s4 offen sc1
    s_mov_b32 s60, s46
    s_and_b32 s61, s47, 0xffff
    s_mov_b32 s62, 256
    s_mov_b32 s63, 0x00020000
    v_mov_b32 v248, 0
    buffer_load_dword v250, v248, s[60:63], 0 offen sc1
    s_setprio 3
    s_cmp_eq_u32 s89, 0
    s_cbranch_scc1 L_g1b
    s_barrier
    ds_read_b128 v[80:83], v40 offset:0
    ds_read_b64_tr_b16 v[48:49], v42 offset:0
    ds_read_b64_tr_b16 v[50:51], v42 offset:1024
    ds_read_b128 v[84:87], v40 offset:2048
    ds_read_b128 v[88:91], v40 offset:4096
    ds_read_b128 v[92:95], v40 offset:6144
    ds_read_b64_tr_b16 v[52:53], v42 offset:16384
    ds_read_b64_tr_b16 v[54:55], v42 offset:17408
    ds_read_b64_tr_b16 v[56:57], v43 offset:0
    ds_read_b64_tr_b16 v[58:59], v43 offset:1024
    ds_read_b64_tr_b16 v[60:61], v43 offset:16384
    ds_read_b64_tr_b16 v[62:63], v43 offset:17408
    ds_read_b128 v[96:99], v41 offset:0
    ds_read_b128 v[100:103], v41 offset:2048
    s_waitcnt lgkmcnt(11)
    v_mfma_f32_16x16x32_bf16 v[112:115], v[48:51], v[80:83], 0
    ds_read_b128 v[104:107], v41 offset:4096
    s_waitcnt lgkmcnt(11)
    v_mfma_f32_16x16x32_bf16 v[128:131], v[48:51], v[84:87], 0
    ds_read_b128 v[108:111], v41 offset:6144
    s_waitcnt lgkmcnt(11)
    v_mfma_f32_16x16x32_bf16 v[144:147], v[48:51], v[88:91], 0
    ds_read_b64_tr_b16 v[64:65], v44 offset:0
    s_waitcnt lgkmcnt(11)
    v_mfma_f32_16x16x32_bf16 v[160:163], v[48:51], v[92:95], 0
    ds_read_b64_tr_b16 v[66:67], v44 offset:1024
    s_waitcnt lgkmcnt(10)
    v_mfma_f32_16x16x32_bf16 v[120:123], v[52:55], v[80:83], 0
    ds_read_b64_tr_b16 v[68:69], v44 offset:16384
    v_mfma_f32_16x16x32_bf16 v[136:139], v[52:55], v[84:87], 0
    ds_read_b64_tr_b16 v[70:71], v44 offset:17408
    v_mfma_f32_16x16x32_bf16 v[152:155], v[52:55], v[88:91], 0
    ds_read_b64_tr_b16 v[72:73], v45 offset:0
    v_mfma_f32_16x16x32_bf16 v[168:171], v[52:55], v[92:95], 0
    ds_read_b64_tr_b16 v[74:75], v45 offset:1024
    s_waitcnt lgkmcnt(12)
    v_mfma_f32_16x16x32_bf16 v[116:119], v[56:59], v[80:83], 0
    ds_read_b64_tr_b16 v[76:77], v45 offset:16384
    v_mfma_f32_16x16x32_bf16 v[132:135], v[56:59], v[84:87], 0
    ds_read_b64_tr_b16 v[78:79], v45 offset:17408
    v_mfma_f32_16x16x32_bf16 v[148:151], v[56:59], v[88:91], 0
    v_mfma_f32_16x16x32_bf16 v[164:167], v[56:59], v[92:95], 0
    s_waitcnt lgkmcnt(12)
    v_mfma_f32_16x16x32_bf16 v[124:127], v[60:63], v[80:83], 0
    ds_read_b64_tr_b16 v[48:49], v42 offset:8192
    v_mfma_f32_16x16x32_bf16 v[140:143], v[60:63], v[84:87], 0
    ds_read_b64_tr_b16 v[50:51], v42 offset:9216
    v_mfma_f32_16x16x32_bf16 v[156:159], v[60:63], v[88:91], 0
    v_mfma_f32_16x16x32_bf16 v[172:175], v[60:63], v[92:95], 0
    s_waitcnt lgkmcnt(8)
    v_mfma_f32_16x16x32_bf16 v[176:179], v[64:67], v[80:83], 0
    ds_read_b64_tr_b16 v[52:53], v42 offset:24576
    v_mfma_f32_16x16x32_bf16 v[192:195], v[64:67], v[84:87], 0
    ds_read_b64_tr_b16 v[54:55], v42 offset:25600
    v_mfma_f32_16x16x32_bf16 v[208:211], v[64:67], v[88:91], 0
    ds_read_b64_tr_b16 v[56:57], v43 offset:8192
    v_mfma_f32_16x16x32_bf16 v[224:227], v[64:67], v[92:95], 0
    ds_read_b64_tr_b16 v[58:59], v43 offset:9216
    s_waitcnt lgkmcnt(10)
    v_mfma_f32_16x16x32_bf16 v[184:187], v[68:71], v[80:83], 0
    ds_read_b64_tr_b16 v[60:61], v43 offset:24576
    v_mfma_f32_16x16x32_bf16 v[200:203], v[68:71], v[84:87], 0
    ds_read_b64_tr_b16 v[62:63], v43 offset:25600
    v_mfma_f32_16x16x32_bf16 v[216:219], v[68:71], v[88:91], 0
    ds_read_b64_tr_b16 v[64:65], v44 offset:8192
    v_mfma_f32_16x16x32_bf16 v[232:235], v[68:71], v[92:95], 0
    ds_read_b64_tr_b16 v[66:67], v44 offset:9216
    s_waitcnt lgkmcnt(12)
    v_mfma_f32_16x16x32_bf16 v[180:183], v[72:75], v[80:83], 0
    ds_read_b64_tr_b16 v[68:69], v44 offset:24576
    v_mfma_f32_16x16x32_bf16 v[196:199], v[72:75], v[84:87], 0
    ds_read_b64_tr_b16 v[70:71], v44 offset:25600
    v_mfma_f32_16x16x32_bf16 v[212:215], v[72:75], v[88:91], 0
    v_mfma_f32_16x16x32_bf16 v[228:231], v[72:75], v[92:95], 0
    s_waitcnt lgkmcnt(12)
    v_mfma_f32_16x16x32_bf16 v[188:191], v[76:79], v[80:83], 0
    ds_read_b64_tr_b16 v[72:73], v45 offset:8192
    v_mfma_f32_16x16x32_bf16 v[204:207], v[76:79], v[84:87], 0
    ds_read_b64_tr_b16 v[74:75], v45 offset:9216
    v_mfma_f32_16x16x32_bf16 v[220:223], v[76:79], v[88:91], 0
    v_mfma_f32_16x16x32_bf16 v[236:239], v[76:79], v[92:95], 0
    s_waitcnt lgkmcnt(12)
    v_mfma_f32_16x16x32_bf16 v[112:115], v[48:51], v[96:99], v[112:115]
    ds_read_b64_tr_b16 v[76:77], v45 offset:24576
    v_mfma_f32_16x16x32_bf16 v[128:131], v[48:51], v[100:103], v[128:131]
    ds_read_b64_tr_b16 v[78:79], v45 offset:25600
    v_mfma_f32_16x16x32_bf16 v[144:147], v[48:51], v[104:107], v[144:147]
    v_mfma_f32_16x16x32_bf16 v[160:163], v[48:51], v[108:111], v[160:163]
    s_waitcnt lgkmcnt(12)
    v_mfma_f32_16x16x32_bf16 v[120:123], v[52:55], v[96:99], v[120:123]
    v_mfma_f32_16x16x32_bf16 v[136:139], v[52:55], v[100:103], v[136:139]
    v_mfma_f32_16x16x32_bf16 v[152:155], v[52:55], v[104:107], v[152:155]
    v_mfma_f32_16x16x32_bf16 v[168:171], v[52:55], v[108:111], v[168:171]
    s_waitcnt lgkmcnt(10)
    v_mfma_f32_16x16x32_bf16 v[116:119], v[56:59], v[96:99], v[116:119]
    v_mfma_f32_16x16x32_bf16 v[132:135], v[56:59], v[100:103], v[132:135]
    v_mfma_f32_16x16x32_bf16 v[148:151], v[56:59], v[104:107], v[148:151]
    v_mfma_f32_16x16x32_bf16 v[164:167], v[56:59], v[108:111], v[164:167]
    s_waitcnt lgkmcnt(0)
    s_barrier
    v_mfma_f32_16x16x32_bf16 v[124:127], v[60:63], v[96:99], v[124:127]
    v_add_u32 v40, 0xc000, v40
    ds_read_b128 v[80:83], v40 offset:0
    v_mfma_f32_16x16x32_bf16 v[140:143], v[60:63], v[100:103], v[140:143]
    v_add_u32 v42, 0xc000, v42
    ds_read_b64_tr_b16 v[48:49], v42 offset:0
    v_mfma_f32_16x16x32_bf16 v[156:159], v[60:63], v[104:107], v[156:159]
    ds_read_b64_tr_b16 v[50:51], v42 offset:1024
    v_mfma_f32_16x16x32_bf16 v[172:175], v[60:63], v[108:111], v[172:175]
    ds_read_b128 v[84:87], v40 offset:2048
    v_mfma_f32_16x16x32_bf16 v[176:179], v[64:67], v[96:99], v[176:179]
    ds_read_b128 v[88:91], v40 offset:4096
    v_mfma_f32_16x16x32_bf16 v[192:195], v[64:67], v[100:103], v[192:195]
    ds_read_b128 v[92:95], v40 offset:6144
    v_mfma_f32_16x16x32_bf16 v[208:211], v[64:67], v[104:107], v[208:211]
    ds_read_b64_tr_b16 v[52:53], v42 offset:16384
    v_mfma_f32_16x16x32_bf16 v[224:227], v[64:67], v[108:111], v[224:227]
    ds_read_b64_tr_b16 v[54:55], v42 offset:17408
    v_mfma_f32_16x16x32_bf16 v[184:187], v[68:71], v[96:99], v[184:187]
    v_add_u32 v43, 0xc000, v43
    ds_read_b64_tr_b16 v[56:57], v43 offset:0
    v_mfma_f32_16x16x32_bf16 v[200:203], v[68:71], v[100:103], v[200:203]
    ds_read_b64_tr_b16 v[58:59], v43 offset:1024
    v_mfma_f32_16x16x32_bf16 v[216:219], v[68:71], v[104:107], v[216:219]
    ds_read_b64_tr_b16 v[60:61], v43 offset:16384
    v_mfma_f32_16x16x32_bf16 v[232:235], v[68:71], v[108:111], v[232:235]
    ds_read_b64_tr_b16 v[62:63], v43 offset:17408
    v_mfma_f32_16x16x32_bf16 v[180:183], v[72:75], v[96:99], v[180:183]
    v_mfma_f32_16x16x32_bf16 v[196:199], v[72:75], v[100:103], v[196:199]
    v_mfma_f32_16x16x32_bf16 v[212:215], v[72:75], v[104:107], v[212:215]
    v_mfma_f32_16x16x32_bf16 v[228:231], v[72:75], v[108:111], v[228:231]
    v_mfma_f32_16x16x32_bf16 v[188:191], v[76:79], v[96:99], v[188:191]
    v_mfma_f32_16x16x32_bf16 v[204:207], v[76:79], v[100:103], v[204:207]
    v_mfma_f32_16x16x32_bf16 v[220:223], v[76:79], v[104:107], v[220:223]
    v_mfma_f32_16x16x32_bf16 v[236:239], v[76:79], v[108:111], v[236:239]
    s_waitcnt lgkmcnt(9)
    v_mfma_f32_16x16x32_bf16 v[112:115], v[48:51], v[80:83], v[112:115]
    v_add_u32 v41, 0xc000, v41
    ds_read_b128 v[96:99], v41 offset:0
    s_waitcnt lgkmcnt(9)
    v_mfma_f32_16x16x32_bf16 v[128:131], v[48:51], v[84:87], v[128:131]
    ds_read_b128 v[100:103], v41 offset:2048
    s_waitcnt lgkmcnt(9)
    v_mfma_f32_16x16x32_bf16 v[144:147], v[48:51], v[88:91], v[144:147]
    ds_read_b128 v[104:107], v41 offset:4096
    s_waitcnt lgkmcnt(9)
    v_mfma_f32_16x16x32_bf16 v[160:163], v[48:51], v[92:95], v[160:163]
    ds_read_b128 v[108:111], v41 offset:6144
    s_waitcnt lgkmcnt(8)
    v_mfma_f32_16x16x32_bf16 v[120:123], v[52:55], v[80:83], v[120:123]
    v_add_u32 v44, 0xc000, v44
    ds_read_b64_tr_b16 v[64:65], v44 offset:0
    v_mfma_f32_16x16x32_bf16 v[136:139], v[52:55], v[84:87], v[136:139]
    ds_read_b64_tr_b16 v[66:67], v44 offset:1024
    v_mfma_f32_16x16x32_bf16 v[152:155], v[52:55], v[88:91], v[152:155]
    ds_read_b64_tr_b16 v[68:69], v44 offset:16384
    v_mfma_f32_16x16x32_bf16 v[168:171], v[52:55], v[92:95], v[168:171]
    ds_read_b64_tr_b16 v[70:71], v44 offset:17408
    s_waitcnt lgkmcnt(10)
    v_mfma_f32_16x16x32_bf16 v[116:119], v[56:59], v[80:83], v[116:119]
    v_add_u32 v45, 0xc000, v45
    ds_read_b64_tr_b16 v[72:73], v45 offset:0
    v_mfma_f32_16x16x32_bf16 v[132:135], v[56:59], v[84:87], v[132:135]
    ds_read_b64_tr_b16 v[74:75], v45 offset:1024
    v_mfma_f32_16x16x32_bf16 v[148:151], v[56:59], v[88:91], v[148:151]
    ds_read_b64_tr_b16 v[76:77], v45 offset:16384
    v_mfma_f32_16x16x32_bf16 v[164:167], v[56:59], v[92:95], v[164:167]
    ds_read_b64_tr_b16 v[78:79], v45 offset:17408
    s_waitcnt lgkmcnt(12)
    v_mfma_f32_16x16x32_bf16 v[124:127], v[60:63], v[80:83], v[124:127]
    ds_read_b64_tr_b16 v[48:49], v42 offset:8192
    v_mfma_f32_16x16x32_bf16 v[140:143], v[60:63], v[84:87], v[140:143]
    ds_read_b64_tr_b16 v[50:51], v42 offset:9216
    v_mfma_f32_16x16x32_bf16 v[156:159], v[60:63], v[88:91], v[156:159]
    v_mfma_f32_16x16x32_bf16 v[172:175], v[60:63], v[92:95], v[172:175]
    s_waitcnt lgkmcnt(8)
    v_mfma_f32_16x16x32_bf16 v[176:179], v[64:67], v[80:83], v[176:179]
    ds_read_b64_tr_b16 v[52:53], v42 offset:24576
    v_mfma_f32_16x16x32_bf16 v[192:195], v[64:67], v[84:87], v[192:195]
    ds_read_b64_tr_b16 v[54:55], v42 offset:25600
    v_mfma_f32_16x16x32_bf16 v[208:211], v[64:67], v[88:91], v[208:211]
    ds_read_b64_tr_b16 v[56:57], v43 offset:8192
    v_mfma_f32_16x16x32_bf16 v[224:227], v[64:67], v[92:95], v[224:227]
    ds_read_b64_tr_b16 v[58:59], v43 offset:9216
    s_waitcnt lgkmcnt(10)
    v_mfma_f32_16x16x32_bf16 v[184:187], v[68:71], v[80:83], v[184:187]
    ds_read_b64_tr_b16 v[60:61], v43 offset:24576
    v_mfma_f32_16x16x32_bf16 v[200:203], v[68:71], v[84:87], v[200:203]
    ds_read_b64_tr_b16 v[62:63], v43 offset:25600
    v_mfma_f32_16x16x32_bf16 v[216:219], v[68:71], v[88:91], v[216:219]
    ds_read_b64_tr_b16 v[64:65], v44 offset:8192
    v_mfma_f32_16x16x32_bf16 v[232:235], v[68:71], v[92:95], v[232:235]
    ds_read_b64_tr_b16 v[66:67], v44 offset:9216
    s_waitcnt lgkmcnt(12)
    v_mfma_f32_16x16x32_bf16 v[180:183], v[72:75], v[80:83], v[180:183]
    ds_read_b64_tr_b16 v[68:69], v44 offset:24576
    v_mfma_f32_16x16x32_bf16 v[196:199], v[72:75], v[84:87], v[196:199]
    ds_read_b64_tr_b16 v[70:71], v44 offset:25600
    v_mfma_f32_16x16x32_bf16 v[212:215], v[72:75], v[88:91], v[212:215]
    v_mfma_f32_16x16x32_bf16 v[228:231], v[72:75], v[92:95], v[228:231]
    s_waitcnt lgkmcnt(12)
    v_mfma_f32_16x16x32_bf16 v[188:191], v[76:79], v[80:83], v[188:191]
    ds_read_b64_tr_b16 v[72:73], v45 offset:8192
    v_mfma_f32_16x16x32_bf16 v[204:207], v[76:79], v[84:87], v[204:207]
    ds_read_b64_tr_b16 v[74:75], v45 offset:9216
    v_mfma_f32_16x16x32_bf16 v[220:223], v[76:79], v[88:91], v[220:223]
    v_mfma_f32_16x16x32_bf16 v[236:239], v[76:79], v[92:95], v[236:239]
    s_waitcnt lgkmcnt(12)
    v_mfma_f32_16x16x32_bf16 v[112:115], v[48:51], v[96:99], v[112:115]
    ds_read_b64_tr_b16 v[76:77], v45 offset:24576
    v_mfma_f32_16x16x32_bf16 v[128:131], v[48:51], v[100:103], v[128:131]
    ds_read_b64_tr_b16 v[78:79], v45 offset:25600
    v_mfma_f32_16x16x32_bf16 v[144:147], v[48:51], v[104:107], v[144:147]
    v_mfma_f32_16x16x32_bf16 v[160:163], v[48:51], v[108:111], v[160:163]
    s_waitcnt lgkmcnt(12)
    v_mfma_f32_16x16x32_bf16 v[120:123], v[52:55], v[96:99], v[120:123]
    v_mfma_f32_16x16x32_bf16 v[136:139], v[52:55], v[100:103], v[136:139]
    v_mfma_f32_16x16x32_bf16 v[152:155], v[52:55], v[104:107], v[152:155]
    v_mfma_f32_16x16x32_bf16 v[168:171], v[52:55], v[108:111], v[168:171]
    s_waitcnt lgkmcnt(10)
    v_mfma_f32_16x16x32_bf16 v[116:119], v[56:59], v[96:99], v[116:119]
    v_mfma_f32_16x16x32_bf16 v[132:135], v[56:59], v[100:103], v[132:135]
    v_mfma_f32_16x16x32_bf16 v[148:151], v[56:59], v[104:107], v[148:151]
    v_mfma_f32_16x16x32_bf16 v[164:167], v[56:59], v[108:111], v[164:167]
    s_waitcnt lgkmcnt(0)
    s_barrier
    v_mfma_f32_16x16x32_bf16 v[124:127], v[60:63], v[96:99], v[124:127]
    v_add_u32 v40, 0xc000, v40
    ds_read_b128 v[80:83], v40 offset:0
    v_mfma_f32_16x16x32_bf16 v[140:143], v[60:63], v[100:103], v[140:143]
    v_add_u32 v42, 0xc000, v42
    ds_read_b64_tr_b16 v[48:49], v42 offset:0
    v_mfma_f32_16x16x32_bf16 v[156:159], v[60:63], v[104:107], v[156:159]
    ds_read_b64_tr_b16 v[50:51], v42 offset:1024
    v_mfma_f32_16x16x32_bf16 v[172:175], v[60:63], v[108:111], v[172:175]
    ds_read_b128 v[84:87], v40 offset:2048
    v_mfma_f32_16x16x32_bf16 v[176:179], v[64:67], v[96:99], v[176:179]
    ds_read_b128 v[88:91], v40 offset:4096
    v_mfma_f32_16x16x32_bf16 v[192:195], v[64:67], v[100:103], v[192:195]
    ds_read_b128 v[92:95], v40 offset:6144
    v_mfma_f32_16x16x32_bf16 v[208:211], v[64:67], v[104:107], v[208:211]
    ds_read_b64_tr_b16 v[52:53], v42 offset:16384
    v_mfma_f32_16x16x32_bf16 v[224:227], v[64:67], v[108:111], v[224:227]
    ds_read_b64_tr_b16 v[54:55], v42 offset:17408
    v_mfma_f32_16x16x32_bf16 v[184:187], v[68:71], v[96:99], v[184:187]
    v_add_u32 v43, 0xc000, v43
    ds_read_b64_tr_b16 v[56:57], v43 offset:0
    v_mfma_f32_16x16x32_bf16 v[200:203], v[68:71], v[100:103], v[200:203]
    ds_read_b64_tr_b16 v[58:59], v43 offset:1024
    v_mfma_f32_16x16x32_bf16 v[216:219], v[68:71], v[104:107], v[216:219]
    ds_read_b64_tr_b16 v[60:61], v43 offset:16384
    v_mfma_f32_16x16x32_bf16 v[232:235], v[68:71], v[108:111], v[232:235]
    ds_read_b64_tr_b16 v[62:63], v43 offset:17408
    v_mfma_f32_16x16x32_bf16 v[180:183], v[72:75], v[96:99], v[180:183]
    v_mfma_f32_16x16x32_bf16 v[196:199], v[72:75], v[100:103], v[196:199]
    v_mfma_f32_16x16x32_bf16 v[212:215], v[72:75], v[104:107], v[212:215]
    v_mfma_f32_16x16x32_bf16 v[228:231], v[72:75], v[108:111], v[228:231]
    v_mfma_f32_16x16x32_bf16 v[188:191], v[76:79], v[96:99], v[188:191]
    v_mfma_f32_16x16x32_bf16 v[204:207], v[76:79], v[100:103], v[204:207]
    v_mfma_f32_16x16x32_bf16 v[220:223], v[76:79], v[104:107], v[220:223]
    v_mfma_f32_16x16x32_bf16 v[236:239], v[76:79], v[108:111], v[236:239]
    s_waitcnt lgkmcnt(9)
    v_mfma_f32_16x16x32_bf16 v[112:115], v[48:51], v[80:83], v[112:115]
    v_add_u32 v41, 0xc000, v41
    ds_read_b128 v[96:99], v41 offset:0
    s_waitcnt lgkmcnt(9)
    v_mfma_f32_16x16x32_bf16 v[128:131], v[48:51], v[84:87], v[128:131]
    ds_read_b128 v[100:103], v41 offset:2048
    s_waitcnt lgkmcnt(9)
    v_mfma_f32_16x16x32_bf16 v[144:147], v[48:51], v[88:91], v[144:147]
    ds_read_b128 v[104:107], v41 offset:4096
    s_waitcnt lgkmcnt(9)
    v_mfma_f32_16x16x32_bf16 v[160:163], v[48:51], v[92:95], v[160:163]
    ds_read_b128 v[108:111], v41 offset:6144
    s_waitcnt lgkmcnt(8)
    v_mfma_f32_16x16x32_bf16 v[120:123], v[52:55], v[80:83], v[120:123]
    v_add_u32 v44, 0xc000, v44
    ds_read_b64_tr_b16 v[64:65], v44 offset:0
    v_mfma_f32_16x16x32_bf16 v[136:139], v[52:55], v[84:87], v[136:139]
    ds_read_b64_tr_b16 v[66:67], v44 offset:1024
    v_mfma_f32_16x16x32_bf16 v[152:155], v[52:55], v[88:91], v[152:155]
    ds_read_b64_tr_b16 v[68:69], v44 offset:16384
    v_mfma_f32_16x16x32_bf16 v[168:171], v[52:55], v[92:95], v[168:171]
    ds_read_b64_tr_b16 v[70:71], v44 offset:17408
    s_waitcnt lgkmcnt(10)
    v_mfma_f32_16x16x32_bf16 v[116:119], v[56:59], v[80:83], v[116:119]
    v_add_u32 v45, 0xc000, v45
    ds_read_b64_tr_b16 v[72:73], v45 offset:0
    v_mfma_f32_16x16x32_bf16 v[132:135], v[56:59], v[84:87], v[132:135]
    ds_read_b64_tr_b16 v[74:75], v45 offset:1024
    v_mfma_f32_16x16x32_bf16 v[148:151], v[56:59], v[88:91], v[148:151]
    ds_read_b64_tr_b16 v[76:77], v45 offset:16384
    v_mfma_f32_16x16x32_bf16 v[164:167], v[56:59], v[92:95], v[164:167]
    ds_read_b64_tr_b16 v[78:79], v45 offset:17408
    s_waitcnt lgkmcnt(12)
    v_mfma_f32_16x16x32_bf16 v[124:127], v[60:63], v[80:83], v[124:127]
    ds_read_b64_tr_b16 v[48:49], v42 offset:8192
    v_mfma_f32_16x16x32_bf16 v[140:143], v[60:63], v[84:87], v[140:143]
    ds_read_b64_tr_b16 v[50:51], v42 offset:9216
    v_mfma_f32_16x16x32_bf16 v[156:159], v[60:63], v[88:91], v[156:159]
    v_mfma_f32_16x16x32_bf16 v[172:175], v[60:63], v[92:95], v[172:175]
    s_waitcnt lgkmcnt(8)
    v_mfma_f32_16x16x32_bf16 v[176:179], v[64:67], v[80:83], v[176:179]
    ds_read_b64_tr_b16 v[52:53], v42 offset:24576
    v_mfma_f32_16x16x32_bf16 v[192:195], v[64:67], v[84:87], v[192:195]
    ds_read_b64_tr_b16 v[54:55], v42 offset:25600
    v_mfma_f32_16x16x32_bf16 v[208:211], v[64:67], v[88:91], v[208:211]
    ds_read_b64_tr_b16 v[56:57], v43 offset:8192
    v_mfma_f32_16x16x32_bf16 v[224:227], v[64:67], v[92:95], v[224:227]
    ds_read_b64_tr_b16 v[58:59], v43 offset:9216
    s_waitcnt lgkmcnt(10)
    v_mfma_f32_16x16x32_bf16 v[184:187], v[68:71], v[80:83], v[184:187]
    ds_read_b64_tr_b16 v[60:61], v43 offset:24576
    v_mfma_f32_16x16x32_bf16 v[200:203], v[68:71], v[84:87], v[200:203]
    ds_read_b64_tr_b16 v[62:63], v43 offset:25600
    v_mfma_f32_16x16x32_bf16 v[216:219], v[68:71], v[88:91], v[216:219]
    ds_read_b64_tr_b16 v[64:65], v44 offset:8192
    v_mfma_f32_16x16x32_bf16 v[232:235], v[68:71], v[92:95], v[232:235]
    ds_read_b64_tr_b16 v[66:67], v44 offset:9216
    s_waitcnt lgkmcnt(12)
    v_mfma_f32_16x16x32_bf16 v[180:183], v[72:75], v[80:83], v[180:183]
    ds_read_b64_tr_b16 v[68:69], v44 offset:24576
    v_mfma_f32_16x16x32_bf16 v[196:199], v[72:75], v[84:87], v[196:199]
    ds_read_b64_tr_b16 v[70:71], v44 offset:25600
    v_mfma_f32_16x16x32_bf16 v[212:215], v[72:75], v[88:91], v[212:215]
    v_mfma_f32_16x16x32_bf16 v[228:231], v[72:75], v[92:95], v[228:231]
    s_waitcnt lgkmcnt(12)
    v_mfma_f32_16x16x32_bf16 v[188:191], v[76:79], v[80:83], v[188:191]
    ds_read_b64_tr_b16 v[72:73], v45 offset:8192
    v_mfma_f32_16x16x32_bf16 v[204:207], v[76:79], v[84:87], v[204:207]
    ds_read_b64_tr_b16 v[74:75], v45 offset:9216
    v_mfma_f32_16x16x32_bf16 v[220:223], v[76:79], v[88:91], v[220:223]
    v_mfma_f32_16x16x32_bf16 v[236:239], v[76:79], v[92:95], v[236:239]
    s_waitcnt lgkmcnt(12)
    v_mfma_f32_16x16x32_bf16 v[112:115], v[48:51], v[96:99], v[112:115]
    ds_read_b64_tr_b16 v[76:77], v45 offset:24576
    v_mfma_f32_16x16x32_bf16 v[128:131], v[48:51], v[100:103], v[128:131]
    ds_read_b64_tr_b16 v[78:79], v45 offset:25600
    v_mfma_f32_16x16x32_bf16 v[144:147], v[48:51], v[104:107], v[144:147]
    v_mfma_f32_16x16x32_bf16 v[160:163], v[48:51], v[108:111], v[160:163]
    s_waitcnt lgkmcnt(12)
    v_mfma_f32_16x16x32_bf16 v[120:123], v[52:55], v[96:99], v[120:123]
    v_mfma_f32_16x16x32_bf16 v[136:139], v[52:55], v[100:103], v[136:139]
    v_mfma_f32_16x16x32_bf16 v[152:155], v[52:55], v[104:107], v[152:155]
    v_mfma_f32_16x16x32_bf16 v[168:171], v[52:55], v[108:111], v[168:171]
    s_waitcnt lgkmcnt(10)
    v_mfma_f32_16x16x32_bf16 v[116:119], v[56:59], v[96:99], v[116:119]
    v_mfma_f32_16x16x32_bf16 v[132:135], v[56:59], v[100:103], v[132:135]
    v_mfma_f32_16x16x32_bf16 v[148:151], v[56:59], v[104:107], v[148:151]
    v_mfma_f32_16x16x32_bf16 v[164:167], v[56:59], v[108:111], v[164:167]
    s_waitcnt lgkmcnt(0)
    s_barrier
    v_mfma_f32_16x16x32_bf16 v[124:127], v[60:63], v[96:99], v[124:127]
    v_add_u32 v40, 0xfffe8000, v40
    ds_read_b128 v[80:83], v40 offset:0
    v_mfma_f32_16x16x32_bf16 v[140:143], v[60:63], v[100:103], v[140:143]
    v_add_u32 v42, 0xfffe8000, v42
    ds_read_b64_tr_b16 v[48:49], v42 offset:0
    v_mfma_f32_16x16x32_bf16 v[156:159], v[60:63], v[104:107], v[156:159]
    ds_read_b64_tr_b16 v[50:51], v42 offset:1024
    v_mfma_f32_16x16x32_bf16 v[172:175], v[60:63], v[108:111], v[172:175]
    ds_read_b128 v[84:87], v40 offset:2048
    v_mfma_f32_16x16x32_bf16 v[176:179], v[64:67], v[96:99], v[176:179]
    ds_read_b128 v[88:91], v40 offset:4096
    v_mfma_f32_16x16x32_bf16 v[192:195], v[64:67], v[100:103], v[192:195]
    ds_read_b128 v[92:95], v40 offset:6144
    v_mfma_f32_16x16x32_bf16 v[208:211], v[64:67], v[104:107], v[208:211]
    ds_read_b64_tr_b16 v[52:53], v42 offset:16384
    v_mfma_f32_16x16x32_bf16 v[224:227], v[64:67], v[108:111], v[224:227]
    ds_read_b64_tr_b16 v[54:55], v42 offset:17408
    v_mfma_f32_16x16x32_bf16 v[184:187], v[68:71], v[96:99], v[184:187]
    v_add_u32 v43, 0xfffe8000, v43
    ds_read_b64_tr_b16 v[56:57], v43 offset:0
    v_mfma_f32_16x16x32_bf16 v[200:203], v[68:71], v[100:103], v[200:203]
    ds_read_b64_tr_b16 v[58:59], v43 offset:1024
    v_mfma_f32_16x16x32_bf16 v[216:219], v[68:71], v[104:107], v[216:219]
    ds_read_b64_tr_b16 v[60:61], v43 offset:16384
    v_mfma_f32_16x16x32_bf16 v[232:235], v[68:71], v[108:111], v[232:235]
    ds_read_b64_tr_b16 v[62:63], v43 offset:17408
    v_mfma_f32_16x16x32_bf16 v[180:183], v[72:75], v[96:99], v[180:183]
    v_mfma_f32_16x16x32_bf16 v[196:199], v[72:75], v[100:103], v[196:199]
    v_mfma_f32_16x16x32_bf16 v[212:215], v[72:75], v[104:107], v[212:215]
    v_mfma_f32_16x16x32_bf16 v[228:231], v[72:75], v[108:111], v[228:231]
    v_mfma_f32_16x16x32_bf16 v[188:191], v[76:79], v[96:99], v[188:191]
    v_mfma_f32_16x16x32_bf16 v[204:207], v[76:79], v[100:103], v[204:207]
    v_mfma_f32_16x16x32_bf16 v[220:223], v[76:79], v[104:107], v[220:223]
    v_mfma_f32_16x16x32_bf16 v[236:239], v[76:79], v[108:111], v[236:239]
    s_waitcnt lgkmcnt(9)
    v_mfma_f32_16x16x32_bf16 v[112:115], v[48:51], v[80:83], v[112:115]
    v_add_u32 v41, 0xfffe8000, v41
    ds_read_b128 v[96:99], v41 offset:0
    s_waitcnt lgkmcnt(9)
    v_mfma_f32_16x16x32_bf16 v[128:131], v[48:51], v[84:87], v[128:131]
    ds_read_b128 v[100:103], v41 offset:2048
    s_waitcnt lgkmcnt(9)
    v_mfma_f32_16x16x32_bf16 v[144:147], v[48:51], v[88:91], v[144:147]
    ds_read_b128 v[104:107], v41 offset:4096
    s_waitcnt lgkmcnt(9)
    v_mfma_f32_16x16x32_bf16 v[160:163], v[48:51], v[92:95], v[160:163]
    ds_read_b128 v[108:111], v41 offset:6144
    s_waitcnt lgkmcnt(8)
    v_mfma_f32_16x16x32_bf16 v[120:123], v[52:55], v[80:83], v[120:123]
    v_add_u32 v44, 0xfffe8000, v44
    ds_read_b64_tr_b16 v[64:65], v44 offset:0
    v_mfma_f32_16x16x32_bf16 v[136:139], v[52:55], v[84:87], v[136:139]
    ds_read_b64_tr_b16 v[66:67], v44 offset:1024
    v_mfma_f32_16x16x32_bf16 v[152:155], v[52:55], v[88:91], v[152:155]
    ds_read_b64_tr_b16 v[68:69], v44 offset:16384
    v_mfma_f32_16x16x32_bf16 v[168:171], v[52:55], v[92:95], v[168:171]
    ds_read_b64_tr_b16 v[70:71], v44 offset:17408
    s_waitcnt lgkmcnt(10)
    v_mfma_f32_16x16x32_bf16 v[116:119], v[56:59], v[80:83], v[116:119]
    v_add_u32 v45, 0xfffe8000, v45
    ds_read_b64_tr_b16 v[72:73], v45 offset:0
    v_mfma_f32_16x16x32_bf16 v[132:135], v[56:59], v[84:87], v[132:135]
    ds_read_b64_tr_b16 v[74:75], v45 offset:1024
    v_mfma_f32_16x16x32_bf16 v[148:151], v[56:59], v[88:91], v[148:151]
    ds_read_b64_tr_b16 v[76:77], v45 offset:16384
    v_mfma_f32_16x16x32_bf16 v[164:167], v[56:59], v[92:95], v[164:167]
    ds_read_b64_tr_b16 v[78:79], v45 offset:17408
    s_waitcnt lgkmcnt(12)
    v_mfma_f32_16x16x32_bf16 v[124:127], v[60:63], v[80:83], v[124:127]
    ds_read_b64_tr_b16 v[48:49], v42 offset:8192
    v_mfma_f32_16x16x32_bf16 v[140:143], v[60:63], v[84:87], v[140:143]
    ds_read_b64_tr_b16 v[50:51], v42 offset:9216
    v_mfma_f32_16x16x32_bf16 v[156:159], v[60:63], v[88:91], v[156:159]
    v_mfma_f32_16x16x32_bf16 v[172:175], v[60:63], v[92:95], v[172:175]
    s_waitcnt lgkmcnt(8)
    v_mfma_f32_16x16x32_bf16 v[176:179], v[64:67], v[80:83], v[176:179]
    ds_read_b64_tr_b16 v[52:53], v42 offset:24576
    v_mfma_f32_16x16x32_bf16 v[192:195], v[64:67], v[84:87], v[192:195]
    ds_read_b64_tr_b16 v[54:55], v42 offset:25600
    v_mfma_f32_16x16x32_bf16 v[208:211], v[64:67], v[88:91], v[208:211]
    ds_read_b64_tr_b16 v[56:57], v43 offset:8192
    v_mfma_f32_16x16x32_bf16 v[224:227], v[64:67], v[92:95], v[224:227]
    ds_read_b64_tr_b16 v[58:59], v43 offset:9216
    s_waitcnt lgkmcnt(10)
    v_mfma_f32_16x16x32_bf16 v[184:187], v[68:71], v[80:83], v[184:187]
    ds_read_b64_tr_b16 v[60:61], v43 offset:24576
    v_mfma_f32_16x16x32_bf16 v[200:203], v[68:71], v[84:87], v[200:203]
    ds_read_b64_tr_b16 v[62:63], v43 offset:25600
    v_mfma_f32_16x16x32_bf16 v[216:219], v[68:71], v[88:91], v[216:219]
    ds_read_b64_tr_b16 v[64:65], v44 offset:8192
    v_mfma_f32_16x16x32_bf16 v[232:235], v[68:71], v[92:95], v[232:235]
    ds_read_b64_tr_b16 v[66:67], v44 offset:9216
    s_waitcnt lgkmcnt(12)
    v_mfma_f32_16x16x32_bf16 v[180:183], v[72:75], v[80:83], v[180:183]
    ds_read_b64_tr_b16 v[68:69], v44 offset:24576
    v_mfma_f32_16x16x32_bf16 v[196:199], v[72:75], v[84:87], v[196:199]
    ds_read_b64_tr_b16 v[70:71], v44 offset:25600
    v_mfma_f32_16x16x32_bf16 v[212:215], v[72:75], v[88:91], v[212:215]
    v_mfma_f32_16x16x32_bf16 v[228:231], v[72:75], v[92:95], v[228:231]
    s_waitcnt lgkmcnt(12)
    v_mfma_f32_16x16x32_bf16 v[188:191], v[76:79], v[80:83], v[188:191]
    ds_read_b64_tr_b16 v[72:73], v45 offset:8192
    v_mfma_f32_16x16x32_bf16 v[204:207], v[76:79], v[84:87], v[204:207]
    ds_read_b64_tr_b16 v[74:75], v45 offset:9216
    v_mfma_f32_16x16x32_bf16 v[220:223], v[76:79], v[88:91], v[220:223]
    v_mfma_f32_16x16x32_bf16 v[236:239], v[76:79], v[92:95], v[236:239]
    s_waitcnt lgkmcnt(12)
    v_mfma_f32_16x16x32_bf16 v[112:115], v[48:51], v[96:99], v[112:115]
    ds_read_b64_tr_b16 v[76:77], v45 offset:24576
    v_mfma_f32_16x16x32_bf16 v[128:131], v[48:51], v[100:103], v[128:131]
    ds_read_b64_tr_b16 v[78:79], v45 offset:25600
    v_mfma_f32_16x16x32_bf16 v[144:147], v[48:51], v[104:107], v[144:147]
    v_mfma_f32_16x16x32_bf16 v[160:163], v[48:51], v[108:111], v[160:163]
    s_waitcnt lgkmcnt(12)
    v_mfma_f32_16x16x32_bf16 v[120:123], v[52:55], v[96:99], v[120:123]
    v_mfma_f32_16x16x32_bf16 v[136:139], v[52:55], v[100:103], v[136:139]
    v_mfma_f32_16x16x32_bf16 v[152:155], v[52:55], v[104:107], v[152:155]
    v_mfma_f32_16x16x32_bf16 v[168:171], v[52:55], v[108:111], v[168:171]
    s_waitcnt lgkmcnt(10)
    v_mfma_f32_16x16x32_bf16 v[116:119], v[56:59], v[96:99], v[116:119]
    v_mfma_f32_16x16x32_bf16 v[132:135], v[56:59], v[100:103], v[132:135]
    v_mfma_f32_16x16x32_bf16 v[148:151], v[56:59], v[104:107], v[148:151]
    v_mfma_f32_16x16x32_bf16 v[164:167], v[56:59], v[108:111], v[164:167]
    s_waitcnt lgkmcnt(0) vmcnt(0)
    s_barrier
    v_mfma_f32_16x16x32_bf16 v[124:127], v[60:63], v[96:99], v[124:127]
    v_add_u32 v40, 0xc000, v40
    ds_read_b128 v[80:83], v40 offset:0
    v_mfma_f32_16x16x32_bf16 v[140:143], v[60:63], v[100:103], v[140:143]
    v_add_u32 v42, 0xc000, v42
    ds_read_b64_tr_b16 v[48:49], v42 offset:0
    v_mfma_f32_16x16x32_bf16 v[156:159], v[60:63], v[104:107], v[156:159]
    ds_read_b64_tr_b16 v[50:51], v42 offset:1024
    v_mfma_f32_16x16x32_bf16 v[172:175], v[60:63], v[108:111], v[172:175]
    ds_read_b128 v[84:87], v40 offset:2048
    v_mfma_f32_16x16x32_bf16 v[176:179], v[64:67], v[96:99], v[176:179]
    ds_read_b128 v[88:91], v40 offset:4096
    v_mfma_f32_16x16x32_bf16 v[192:195], v[64:67], v[100:103], v[192:195]
    ds_read_b128 v[92:95], v40 offset:6144
    v_mfma_f32_16x16x32_bf16 v[208:211], v[64:67], v[104:107], v[208:211]
    ds_read_b64_tr_b16 v[52:53], v42 offset:16384
    v_mfma_f32_16x16x32_bf16 v[224:227], v[64:67], v[108:111], v[224:227]
    ds_read_b64_tr_b16 v[54:55], v42 offset:17408
    v_mfma_f32_16x16x32_bf16 v[184:187], v[68:71], v[96:99], v[184:187]
    v_add_u32 v43, 0xc000, v43
    ds_read_b64_tr_b16 v[56:57], v43 offset:0
    v_mfma_f32_16x16x32_bf16 v[200:203], v[68:71], v[100:103], v[200:203]
    ds_read_b64_tr_b16 v[58:59], v43 offset:1024
    v_mfma_f32_16x16x32_bf16 v[216:219], v[68:71], v[104:107], v[216:219]
    ds_read_b64_tr_b16 v[60:61], v43 offset:16384
    v_mfma_f32_16x16x32_bf16 v[232:235], v[68:71], v[108:111], v[232:235]
    ds_read_b64_tr_b16 v[62:63], v43 offset:17408
    v_mfma_f32_16x16x32_bf16 v[180:183], v[72:75], v[96:99], v[180:183]
    v_mfma_f32_16x16x32_bf16 v[196:199], v[72:75], v[100:103], v[196:199]
    v_mfma_f32_16x16x32_bf16 v[212:215], v[72:75], v[104:107], v[212:215]
    v_mfma_f32_16x16x32_bf16 v[228:231], v[72:75], v[108:111], v[228:231]
    v_mfma_f32_16x16x32_bf16 v[188:191], v[76:79], v[96:99], v[188:191]
    v_mfma_f32_16x16x32_bf16 v[204:207], v[76:79], v[100:103], v[204:207]
    v_mfma_f32_16x16x32_bf16 v[220:223], v[76:79], v[104:107], v[220:223]
    v_mfma_f32_16x16x32_bf16 v[236:239], v[76:79], v[108:111], v[236:239]
    s_waitcnt lgkmcnt(9)
    v_mfma_f32_16x16x32_bf16 v[112:115], v[48:51], v[80:83], v[112:115]
    v_add_u32 v41, 0xc000, v41
    ds_read_b128 v[96:99], v41 offset:0
    s_waitcnt lgkmcnt(9)
    v_mfma_f32_16x16x32_bf16 v[128:131], v[48:51], v[84:87], v[128:131]
    ds_read_b128 v[100:103], v41 offset:2048
    s_waitcnt lgkmcnt(9)
    v_mfma_f32_16x16x32_bf16 v[144:147], v[48:51], v[88:91], v[144:147]
    ds_read_b128 v[104:107], v41 offset:4096
    s_waitcnt lgkmcnt(9)
    v_mfma_f32_16x16x32_bf16 v[160:163], v[48:51], v[92:95], v[160:163]
    ds_read_b128 v[108:111], v41 offset:6144
    s_waitcnt lgkmcnt(8)
    v_mfma_f32_16x16x32_bf16 v[120:123], v[52:55], v[80:83], v[120:123]
    v_add_u32 v44, 0xc000, v44
    ds_read_b64_tr_b16 v[64:65], v44 offset:0
    v_mfma_f32_16x16x32_bf16 v[136:139], v[52:55], v[84:87], v[136:139]
    ds_read_b64_tr_b16 v[66:67], v44 offset:1024
    v_mfma_f32_16x16x32_bf16 v[152:155], v[52:55], v[88:91], v[152:155]
    ds_read_b64_tr_b16 v[68:69], v44 offset:16384
    v_mfma_f32_16x16x32_bf16 v[168:171], v[52:55], v[92:95], v[168:171]
    ds_read_b64_tr_b16 v[70:71], v44 offset:17408
    s_waitcnt lgkmcnt(10)
    v_mfma_f32_16x16x32_bf16 v[116:119], v[56:59], v[80:83], v[116:119]
    v_add_u32 v45, 0xc000, v45
    ds_read_b64_tr_b16 v[72:73], v45 offset:0
    v_mfma_f32_16x16x32_bf16 v[132:135], v[56:59], v[84:87], v[132:135]
    ds_read_b64_tr_b16 v[74:75], v45 offset:1024
    v_mfma_f32_16x16x32_bf16 v[148:151], v[56:59], v[88:91], v[148:151]
    ds_read_b64_tr_b16 v[76:77], v45 offset:16384
    v_mfma_f32_16x16x32_bf16 v[164:167], v[56:59], v[92:95], v[164:167]
    ds_read_b64_tr_b16 v[78:79], v45 offset:17408
    s_waitcnt lgkmcnt(12)
    v_mfma_f32_16x16x32_bf16 v[124:127], v[60:63], v[80:83], v[124:127]
    ds_read_b64_tr_b16 v[48:49], v42 offset:8192
    v_mfma_f32_16x16x32_bf16 v[140:143], v[60:63], v[84:87], v[140:143]
    ds_read_b64_tr_b16 v[50:51], v42 offset:9216
    v_mfma_f32_16x16x32_bf16 v[156:159], v[60:63], v[88:91], v[156:159]
    v_mfma_f32_16x16x32_bf16 v[172:175], v[60:63], v[92:95], v[172:175]
    s_waitcnt lgkmcnt(8)
    v_mfma_f32_16x16x32_bf16 v[176:179], v[64:67], v[80:83], v[176:179]
    ds_read_b64_tr_b16 v[52:53], v42 offset:24576
    v_mfma_f32_16x16x32_bf16 v[192:195], v[64:67], v[84:87], v[192:195]
    ds_read_b64_tr_b16 v[54:55], v42 offset:25600
    v_mfma_f32_16x16x32_bf16 v[208:211], v[64:67], v[88:91], v[208:211]
    ds_read_b64_tr_b16 v[56:57], v43 offset:8192
    v_mfma_f32_16x16x32_bf16 v[224:227], v[64:67], v[92:95], v[224:227]
    ds_read_b64_tr_b16 v[58:59], v43 offset:9216
    s_waitcnt lgkmcnt(10)
    v_mfma_f32_16x16x32_bf16 v[184:187], v[68:71], v[80:83], v[184:187]
    ds_read_b64_tr_b16 v[60:61], v43 offset:24576
    v_mfma_f32_16x16x32_bf16 v[200:203], v[68:71], v[84:87], v[200:203]
    ds_read_b64_tr_b16 v[62:63], v43 offset:25600
    v_mfma_f32_16x16x32_bf16 v[216:219], v[68:71], v[88:91], v[216:219]
    ds_read_b64_tr_b16 v[64:65], v44 offset:8192
    v_mfma_f32_16x16x32_bf16 v[232:235], v[68:71], v[92:95], v[232:235]
    ds_read_b64_tr_b16 v[66:67], v44 offset:9216
    s_waitcnt lgkmcnt(12)
    v_mfma_f32_16x16x32_bf16 v[180:183], v[72:75], v[80:83], v[180:183]
    ds_read_b64_tr_b16 v[68:69], v44 offset:24576
    v_mfma_f32_16x16x32_bf16 v[196:199], v[72:75], v[84:87], v[196:199]
    ds_read_b64_tr_b16 v[70:71], v44 offset:25600
    v_mfma_f32_16x16x32_bf16 v[212:215], v[72:75], v[88:91], v[212:215]
    v_mfma_f32_16x16x32_bf16 v[228:231], v[72:75], v[92:95], v[228:231]
    s_waitcnt lgkmcnt(12)
    v_mfma_f32_16x16x32_bf16 v[188:191], v[76:79], v[80:83], v[188:191]
    ds_read_b64_tr_b16 v[72:73], v45 offset:8192
    v_mfma_f32_16x16x32_bf16 v[204:207], v[76:79], v[84:87], v[204:207]
    ds_read_b64_tr_b16 v[74:75], v45 offset:9216
    v_mfma_f32_16x16x32_bf16 v[220:223], v[76:79], v[88:91], v[220:223]
    v_mfma_f32_16x16x32_bf16 v[236:239], v[76:79], v[92:95], v[236:239]
    s_waitcnt lgkmcnt(12)
    v_mfma_f32_16x16x32_bf16 v[112:115], v[48:51], v[96:99], v[112:115]
    ds_read_b64_tr_b16 v[76:77], v45 offset:24576
    v_mfma_f32_16x16x32_bf16 v[128:131], v[48:51], v[100:103], v[128:131]
    ds_read_b64_tr_b16 v[78:79], v45 offset:25600
    v_mfma_f32_16x16x32_bf16 v[144:147], v[48:51], v[104:107], v[144:147]
    v_mfma_f32_16x16x32_bf16 v[160:163], v[48:51], v[108:111], v[160:163]
    s_waitcnt lgkmcnt(12)
    v_mfma_f32_16x16x32_bf16 v[120:123], v[52:55], v[96:99], v[120:123]
    v_mfma_f32_16x16x32_bf16 v[136:139], v[52:55], v[100:103], v[136:139]
    v_mfma_f32_16x16x32_bf16 v[152:155], v[52:55], v[104:107], v[152:155]
    v_mfma_f32_16x16x32_bf16 v[168:171], v[52:55], v[108:111], v[168:171]
    s_waitcnt lgkmcnt(10)
    v_mfma_f32_16x16x32_bf16 v[116:119], v[56:59], v[96:99], v[116:119]
    v_mfma_f32_16x16x32_bf16 v[132:135], v[56:59], v[100:103], v[132:135]
    v_mfma_f32_16x16x32_bf16 v[148:151], v[56:59], v[104:107], v[148:151]
    v_mfma_f32_16x16x32_bf16 v[164:167], v[56:59], v[108:111], v[164:167]
    s_waitcnt lgkmcnt(0)
    s_barrier
    v_mfma_f32_16x16x32_bf16 v[124:127], v[60:63], v[96:99], v[124:127]
    v_add_u32 v40, 0xc000, v40
    ds_read_b128 v[80:83], v40 offset:0
    v_mfma_f32_16x16x32_bf16 v[140:143], v[60:63], v[100:103], v[140:143]
    v_add_u32 v42, 0xc000, v42
    ds_read_b64_tr_b16 v[48:49], v42 offset:0
    v_mfma_f32_16x16x32_bf16 v[156:159], v[60:63], v[104:107], v[156:159]
    ds_read_b64_tr_b16 v[50:51], v42 offset:1024
    v_mfma_f32_16x16x32_bf16 v[172:175], v[60:63], v[108:111], v[172:175]
    ds_read_b128 v[84:87], v40 offset:2048
    v_mfma_f32_16x16x32_bf16 v[176:179], v[64:67], v[96:99], v[176:179]
    ds_read_b128 v[88:91], v40 offset:4096
    v_mfma_f32_16x16x32_bf16 v[192:195], v[64:67], v[100:103], v[192:195]
    ds_read_b128 v[92:95], v40 offset:6144
    v_mfma_f32_16x16x32_bf16 v[208:211], v[64:67], v[104:107], v[208:211]
    ds_read_b64_tr_b16 v[52:53], v42 offset:16384
    v_mfma_f32_16x16x32_bf16 v[224:227], v[64:67], v[108:111], v[224:227]
    ds_read_b64_tr_b16 v[54:55], v42 offset:17408
    v_mfma_f32_16x16x32_bf16 v[184:187], v[68:71], v[96:99], v[184:187]
    v_add_u32 v43, 0xc000, v43
    ds_read_b64_tr_b16 v[56:57], v43 offset:0
    v_mfma_f32_16x16x32_bf16 v[200:203], v[68:71], v[100:103], v[200:203]
    ds_read_b64_tr_b16 v[58:59], v43 offset:1024
    v_mfma_f32_16x16x32_bf16 v[216:219], v[68:71], v[104:107], v[216:219]
    ds_read_b64_tr_b16 v[60:61], v43 offset:16384
    v_mfma_f32_16x16x32_bf16 v[232:235], v[68:71], v[108:111], v[232:235]
    ds_read_b64_tr_b16 v[62:63], v43 offset:17408
    v_mfma_f32_16x16x32_bf16 v[180:183], v[72:75], v[96:99], v[180:183]
    v_mfma_f32_16x16x32_bf16 v[196:199], v[72:75], v[100:103], v[196:199]
    v_mfma_f32_16x16x32_bf16 v[212:215], v[72:75], v[104:107], v[212:215]
    v_mfma_f32_16x16x32_bf16 v[228:231], v[72:75], v[108:111], v[228:231]
    v_mfma_f32_16x16x32_bf16 v[188:191], v[76:79], v[96:99], v[188:191]
    v_mfma_f32_16x16x32_bf16 v[204:207], v[76:79], v[100:103], v[204:207]
    v_mfma_f32_16x16x32_bf16 v[220:223], v[76:79], v[104:107], v[220:223]
    v_mfma_f32_16x16x32_bf16 v[236:239], v[76:79], v[108:111], v[236:239]
    s_waitcnt lgkmcnt(9)
    v_mfma_f32_16x16x32_bf16 v[112:115], v[48:51], v[80:83], v[112:115]
    v_add_u32 v41, 0xc000, v41
    ds_read_b128 v[96:99], v41 offset:0
    s_waitcnt lgkmcnt(9)
    v_mfma_f32_16x16x32_bf16 v[128:131], v[48:51], v[84:87], v[128:131]
    ds_read_b128 v[100:103], v41 offset:2048
    s_waitcnt lgkmcnt(9)
    v_mfma_f32_16x16x32_bf16 v[144:147], v[48:51], v[88:91], v[144:147]
    ds_read_b128 v[104:107], v41 offset:4096
    s_waitcnt lgkmcnt(9)
    v_mfma_f32_16x16x32_bf16 v[160:163], v[48:51], v[92:95], v[160:163]
    ds_read_b128 v[108:111], v41 offset:6144
    s_waitcnt lgkmcnt(8)
    v_mfma_f32_16x16x32_bf16 v[120:123], v[52:55], v[80:83], v[120:123]
    v_add_u32 v44, 0xc000, v44
    ds_read_b64_tr_b16 v[64:65], v44 offset:0
    v_mfma_f32_16x16x32_bf16 v[136:139], v[52:55], v[84:87], v[136:139]
    ds_read_b64_tr_b16 v[66:67], v44 offset:1024
    v_mfma_f32_16x16x32_bf16 v[152:155], v[52:55], v[88:91], v[152:155]
    ds_read_b64_tr_b16 v[68:69], v44 offset:16384
    v_mfma_f32_16x16x32_bf16 v[168:171], v[52:55], v[92:95], v[168:171]
    ds_read_b64_tr_b16 v[70:71], v44 offset:17408
    s_waitcnt lgkmcnt(10)
    v_mfma_f32_16x16x32_bf16 v[116:119], v[56:59], v[80:83], v[116:119]
    v_add_u32 v45, 0xc000, v45
    ds_read_b64_tr_b16 v[72:73], v45 offset:0
    v_mfma_f32_16x16x32_bf16 v[132:135], v[56:59], v[84:87], v[132:135]
    ds_read_b64_tr_b16 v[74:75], v45 offset:1024
    v_mfma_f32_16x16x32_bf16 v[148:151], v[56:59], v[88:91], v[148:151]
    ds_read_b64_tr_b16 v[76:77], v45 offset:16384
    v_mfma_f32_16x16x32_bf16 v[164:167], v[56:59], v[92:95], v[164:167]
    ds_read_b64_tr_b16 v[78:79], v45 offset:17408
    s_waitcnt lgkmcnt(12)
    v_mfma_f32_16x16x32_bf16 v[124:127], v[60:63], v[80:83], v[124:127]
    ds_read_b64_tr_b16 v[48:49], v42 offset:8192
    v_mfma_f32_16x16x32_bf16 v[140:143], v[60:63], v[84:87], v[140:143]
    ds_read_b64_tr_b16 v[50:51], v42 offset:9216
    v_mfma_f32_16x16x32_bf16 v[156:159], v[60:63], v[88:91], v[156:159]
    v_mfma_f32_16x16x32_bf16 v[172:175], v[60:63], v[92:95], v[172:175]
    s_waitcnt lgkmcnt(8)
    v_mfma_f32_16x16x32_bf16 v[176:179], v[64:67], v[80:83], v[176:179]
    ds_read_b64_tr_b16 v[52:53], v42 offset:24576
    v_mfma_f32_16x16x32_bf16 v[192:195], v[64:67], v[84:87], v[192:195]
    ds_read_b64_tr_b16 v[54:55], v42 offset:25600
    v_mfma_f32_16x16x32_bf16 v[208:211], v[64:67], v[88:91], v[208:211]
    ds_read_b64_tr_b16 v[56:57], v43 offset:8192
    v_mfma_f32_16x16x32_bf16 v[224:227], v[64:67], v[92:95], v[224:227]
    ds_read_b64_tr_b16 v[58:59], v43 offset:9216
    s_waitcnt lgkmcnt(10)
    v_mfma_f32_16x16x32_bf16 v[184:187], v[68:71], v[80:83], v[184:187]
    ds_read_b64_tr_b16 v[60:61], v43 offset:24576
    v_mfma_f32_16x16x32_bf16 v[200:203], v[68:71], v[84:87], v[200:203]
    ds_read_b64_tr_b16 v[62:63], v43 offset:25600
    v_mfma_f32_16x16x32_bf16 v[216:219], v[68:71], v[88:91], v[216:219]
    ds_read_b64_tr_b16 v[64:65], v44 offset:8192
    v_mfma_f32_16x16x32_bf16 v[232:235], v[68:71], v[92:95], v[232:235]
    ds_read_b64_tr_b16 v[66:67], v44 offset:9216
    s_waitcnt lgkmcnt(12)
    v_mfma_f32_16x16x32_bf16 v[180:183], v[72:75], v[80:83], v[180:183]
    ds_read_b64_tr_b16 v[68:69], v44 offset:24576
    v_mfma_f32_16x16x32_bf16 v[196:199], v[72:75], v[84:87], v[196:199]
    ds_read_b64_tr_b16 v[70:71], v44 offset:25600
    v_mfma_f32_16x16x32_bf16 v[212:215], v[72:75], v[88:91], v[212:215]
    v_mfma_f32_16x16x32_bf16 v[228:231], v[72:75], v[92:95], v[228:231]
    s_waitcnt lgkmcnt(12)
    v_mfma_f32_16x16x32_bf16 v[188:191], v[76:79], v[80:83], v[188:191]
    ds_read_b64_tr_b16 v[72:73], v45 offset:8192
    v_mfma_f32_16x16x32_bf16 v[204:207], v[76:79], v[84:87], v[204:207]
    ds_read_b64_tr_b16 v[74:75], v45 offset:9216
    v_mfma_f32_16x16x32_bf16 v[220:223], v[76:79], v[88:91], v[220:223]
    v_mfma_f32_16x16x32_bf16 v[236:239], v[76:79], v[92:95], v[236:239]
    s_waitcnt lgkmcnt(12)
    v_mfma_f32_16x16x32_bf16 v[112:115], v[48:51], v[96:99], v[112:115]
    ds_read_b64_tr_b16 v[76:77], v45 offset:24576
    v_mfma_f32_16x16x32_bf16 v[128:131], v[48:51], v[100:103], v[128:131]
    ds_read_b64_tr_b16 v[78:79], v45 offset:25600
    v_mfma_f32_16x16x32_bf16 v[144:147], v[48:51], v[104:107], v[144:147]
    v_mfma_f32_16x16x32_bf16 v[160:163], v[48:51], v[108:111], v[160:163]
    s_waitcnt lgkmcnt(12)
    v_mfma_f32_16x16x32_bf16 v[120:123], v[52:55], v[96:99], v[120:123]
    v_mfma_f32_16x16x32_bf16 v[136:139], v[52:55], v[100:103], v[136:139]
    v_mfma_f32_16x16x32_bf16 v[152:155], v[52:55], v[104:107], v[152:155]
    v_mfma_f32_16x16x32_bf16 v[168:171], v[52:55], v[108:111], v[168:171]
    s_waitcnt lgkmcnt(10)
    v_mfma_f32_16x16x32_bf16 v[116:119], v[56:59], v[96:99], v[116:119]
    v_mfma_f32_16x16x32_bf16 v[132:135], v[56:59], v[100:103], v[132:135]
    v_mfma_f32_16x16x32_bf16 v[148:151], v[56:59], v[104:107], v[148:151]
    v_mfma_f32_16x16x32_bf16 v[164:167], v[56:59], v[108:111], v[164:167]
    s_waitcnt lgkmcnt(0)
    s_barrier
    v_mfma_f32_16x16x32_bf16 v[124:127], v[60:63], v[96:99], v[124:127]
    v_add_u32 v40, 0xfffe8000, v40
    ds_read_b128 v[80:83], v40 offset:0
    v_mfma_f32_16x16x32_bf16 v[140:143], v[60:63], v[100:103], v[140:143]
    v_add_u32 v42, 0xfffe8000, v42
    ds_read_b64_tr_b16 v[48:49], v42 offset:0
    v_mfma_f32_16x16x32_bf16 v[156:159], v[60:63], v[104:107], v[156:159]
    ds_read_b64_tr_b16 v[50:51], v42 offset:1024
    v_mfma_f32_16x16x32_bf16 v[172:175], v[60:63], v[108:111], v[172:175]
    ds_read_b128 v[84:87], v40 offset:2048
    v_mfma_f32_16x16x32_bf16 v[176:179], v[64:67], v[96:99], v[176:179]
    ds_read_b128 v[88:91], v40 offset:4096
    v_mfma_f32_16x16x32_bf16 v[192:195], v[64:67], v[100:103], v[192:195]
    ds_read_b128 v[92:95], v40 offset:6144
    v_mfma_f32_16x16x32_bf16 v[208:211], v[64:67], v[104:107], v[208:211]
    ds_read_b64_tr_b16 v[52:53], v42 offset:16384
    v_mfma_f32_16x16x32_bf16 v[224:227], v[64:67], v[108:111], v[224:227]
    ds_read_b64_tr_b16 v[54:55], v42 offset:17408
    v_mfma_f32_16x16x32_bf16 v[184:187], v[68:71], v[96:99], v[184:187]
    v_add_u32 v43, 0xfffe8000, v43
    ds_read_b64_tr_b16 v[56:57], v43 offset:0
    v_mfma_f32_16x16x32_bf16 v[200:203], v[68:71], v[100:103], v[200:203]
    ds_read_b64_tr_b16 v[58:59], v43 offset:1024
    v_mfma_f32_16x16x32_bf16 v[216:219], v[68:71], v[104:107], v[216:219]
    ds_read_b64_tr_b16 v[60:61], v43 offset:16384
    v_mfma_f32_16x16x32_bf16 v[232:235], v[68:71], v[108:111], v[232:235]
    ds_read_b64_tr_b16 v[62:63], v43 offset:17408
    v_mfma_f32_16x16x32_bf16 v[180:183], v[72:75], v[96:99], v[180:183]
    v_mfma_f32_16x16x32_bf16 v[196:199], v[72:75], v[100:103], v[196:199]
    v_mfma_f32_16x16x32_bf16 v[212:215], v[72:75], v[104:107], v[212:215]
    v_mfma_f32_16x16x32_bf16 v[228:231], v[72:75], v[108:111], v[228:231]
    v_mfma_f32_16x16x32_bf16 v[188:191], v[76:79], v[96:99], v[188:191]
    v_mfma_f32_16x16x32_bf16 v[204:207], v[76:79], v[100:103], v[204:207]
    v_mfma_f32_16x16x32_bf16 v[220:223], v[76:79], v[104:107], v[220:223]
    v_mfma_f32_16x16x32_bf16 v[236:239], v[76:79], v[108:111], v[236:239]
    s_waitcnt lgkmcnt(9)
    v_mfma_f32_16x16x32_bf16 v[112:115], v[48:51], v[80:83], v[112:115]
    v_add_u32 v41, 0xfffe8000, v41
    ds_read_b128 v[96:99], v41 offset:0
    s_waitcnt lgkmcnt(9)
    v_mfma_f32_16x16x32_bf16 v[128:131], v[48:51], v[84:87], v[128:131]
    ds_read_b128 v[100:103], v41 offset:2048
    s_waitcnt lgkmcnt(9)
    v_mfma_f32_16x16x32_bf16 v[144:147], v[48:51], v[88:91], v[144:147]
    ds_read_b128 v[104:107], v41 offset:4096
    s_waitcnt lgkmcnt(9)
    v_mfma_f32_16x16x32_bf16 v[160:163], v[48:51], v[92:95], v[160:163]
    ds_read_b128 v[108:111], v41 offset:6144
    s_waitcnt lgkmcnt(8)
    v_mfma_f32_16x16x32_bf16 v[120:123], v[52:55], v[80:83], v[120:123]
    v_add_u32 v44, 0xfffe8000, v44
    ds_read_b64_tr_b16 v[64:65], v44 offset:0
    v_mfma_f32_16x16x32_bf16 v[136:139], v[52:55], v[84:87], v[136:139]
    ds_read_b64_tr_b16 v[66:67], v44 offset:1024
    v_mfma_f32_16x16x32_bf16 v[152:155], v[52:55], v[88:91], v[152:155]
    ds_read_b64_tr_b16 v[68:69], v44 offset:16384
    v_mfma_f32_16x16x32_bf16 v[168:171], v[52:55], v[92:95], v[168:171]
    ds_read_b64_tr_b16 v[70:71], v44 offset:17408
    s_waitcnt lgkmcnt(10)
    v_mfma_f32_16x16x32_bf16 v[116:119], v[56:59], v[80:83], v[116:119]
    v_add_u32 v45, 0xfffe8000, v45
    ds_read_b64_tr_b16 v[72:73], v45 offset:0
    v_mfma_f32_16x16x32_bf16 v[132:135], v[56:59], v[84:87], v[132:135]
    ds_read_b64_tr_b16 v[74:75], v45 offset:1024
    v_mfma_f32_16x16x32_bf16 v[148:151], v[56:59], v[88:91], v[148:151]
    ds_read_b64_tr_b16 v[76:77], v45 offset:16384
    v_mfma_f32_16x16x32_bf16 v[164:167], v[56:59], v[92:95], v[164:167]
    ds_read_b64_tr_b16 v[78:79], v45 offset:17408
    s_waitcnt lgkmcnt(12)
    v_mfma_f32_16x16x32_bf16 v[124:127], v[60:63], v[80:83], v[124:127]
    ds_read_b64_tr_b16 v[48:49], v42 offset:8192
    v_mfma_f32_16x16x32_bf16 v[140:143], v[60:63], v[84:87], v[140:143]
    ds_read_b64_tr_b16 v[50:51], v42 offset:9216
    v_mfma_f32_16x16x32_bf16 v[156:159], v[60:63], v[88:91], v[156:159]
    v_mfma_f32_16x16x32_bf16 v[172:175], v[60:63], v[92:95], v[172:175]
    s_waitcnt lgkmcnt(8)
    v_mfma_f32_16x16x32_bf16 v[176:179], v[64:67], v[80:83], v[176:179]
    ds_read_b64_tr_b16 v[52:53], v42 offset:24576
    v_mfma_f32_16x16x32_bf16 v[192:195], v[64:67], v[84:87], v[192:195]
    ds_read_b64_tr_b16 v[54:55], v42 offset:25600
    v_mfma_f32_16x16x32_bf16 v[208:211], v[64:67], v[88:91], v[208:211]
    ds_read_b64_tr_b16 v[56:57], v43 offset:8192
    v_mfma_f32_16x16x32_bf16 v[224:227], v[64:67], v[92:95], v[224:227]
    ds_read_b64_tr_b16 v[58:59], v43 offset:9216
    s_waitcnt lgkmcnt(10)
    v_mfma_f32_16x16x32_bf16 v[184:187], v[68:71], v[80:83], v[184:187]
    ds_read_b64_tr_b16 v[60:61], v43 offset:24576
    v_mfma_f32_16x16x32_bf16 v[200:203], v[68:71], v[84:87], v[200:203]
    ds_read_b64_tr_b16 v[62:63], v43 offset:25600
    v_mfma_f32_16x16x32_bf16 v[216:219], v[68:71], v[88:91], v[216:219]
    ds_read_b64_tr_b16 v[64:65], v44 offset:8192
    v_mfma_f32_16x16x32_bf16 v[232:235], v[68:71], v[92:95], v[232:235]
    ds_read_b64_tr_b16 v[66:67], v44 offset:9216
    s_waitcnt lgkmcnt(12)
    v_mfma_f32_16x16x32_bf16 v[180:183], v[72:75], v[80:83], v[180:183]
    ds_read_b64_tr_b16 v[68:69], v44 offset:24576
    v_mfma_f32_16x16x32_bf16 v[196:199], v[72:75], v[84:87], v[196:199]
    ds_read_b64_tr_b16 v[70:71], v44 offset:25600
    v_mfma_f32_16x16x32_bf16 v[212:215], v[72:75], v[88:91], v[212:215]
    v_mfma_f32_16x16x32_bf16 v[228:231], v[72:75], v[92:95], v[228:231]
    s_waitcnt lgkmcnt(12)
    v_mfma_f32_16x16x32_bf16 v[188:191], v[76:79], v[80:83], v[188:191]
    ds_read_b64_tr_b16 v[72:73], v45 offset:8192
    v_mfma_f32_16x16x32_bf16 v[204:207], v[76:79], v[84:87], v[204:207]
    ds_read_b64_tr_b16 v[74:75], v45 offset:9216
    v_mfma_f32_16x16x32_bf16 v[220:223], v[76:79], v[88:91], v[220:223]
    v_mfma_f32_16x16x32_bf16 v[236:239], v[76:79], v[92:95], v[236:239]
    s_waitcnt lgkmcnt(12)
    v_mfma_f32_16x16x32_bf16 v[112:115], v[48:51], v[96:99], v[112:115]
    ds_read_b64_tr_b16 v[76:77], v45 offset:24576
    v_mfma_f32_16x16x32_bf16 v[128:131], v[48:51], v[100:103], v[128:131]
    ds_read_b64_tr_b16 v[78:79], v45 offset:25600
    v_mfma_f32_16x16x32_bf16 v[144:147], v[48:51], v[104:107], v[144:147]
    v_mfma_f32_16x16x32_bf16 v[160:163], v[48:51], v[108:111], v[160:163]
    s_waitcnt lgkmcnt(12)
    v_mfma_f32_16x16x32_bf16 v[120:123], v[52:55], v[96:99], v[120:123]
    v_mfma_f32_16x16x32_bf16 v[136:139], v[52:55], v[100:103], v[136:139]
    v_mfma_f32_16x16x32_bf16 v[152:155], v[52:55], v[104:107], v[152:155]
    v_mfma_f32_16x16x32_bf16 v[168:171], v[52:55], v[108:111], v[168:171]
    s_waitcnt lgkmcnt(10)
    v_mfma_f32_16x16x32_bf16 v[116:119], v[56:59], v[96:99], v[116:119]
    v_mfma_f32_16x16x32_bf16 v[132:135], v[56:59], v[100:103], v[132:135]
    v_mfma_f32_16x16x32_bf16 v[148:151], v[56:59], v[104:107], v[148:151]
    v_mfma_f32_16x16x32_bf16 v[164:167], v[56:59], v[108:111], v[164:167]
    s_waitcnt lgkmcnt(0)
    s_barrier
    v_mfma_f32_16x16x32_bf16 v[124:127], v[60:63], v[96:99], v[124:127]
    v_add_u32 v40, 0xc000, v40
    ds_read_b128 v[80:83], v40 offset:0
    v_mfma_f32_16x16x32_bf16 v[140:143], v[60:63], v[100:103], v[140:143]
    v_add_u32 v42, 0xc000, v42
    ds_read_b64_tr_b16 v[48:49], v42 offset:0
    v_mfma_f32_16x16x32_bf16 v[156:159], v[60:63], v[104:107], v[156:159]
    ds_read_b64_tr_b16 v[50:51], v42 offset:1024
    v_mfma_f32_16x16x32_bf16 v[172:175], v[60:63], v[108:111], v[172:175]
    ds_read_b128 v[84:87], v40 offset:2048
    v_mfma_f32_16x16x32_bf16 v[176:179], v[64:67], v[96:99], v[176:179]
    ds_read_b128 v[88:91], v40 offset:4096
    v_mfma_f32_16x16x32_bf16 v[192:195], v[64:67], v[100:103], v[192:195]
    ds_read_b128 v[92:95], v40 offset:6144
    v_mfma_f32_16x16x32_bf16 v[208:211], v[64:67], v[104:107], v[208:211]
    ds_read_b64_tr_b16 v[52:53], v42 offset:16384
    v_mfma_f32_16x16x32_bf16 v[224:227], v[64:67], v[108:111], v[224:227]
    ds_read_b64_tr_b16 v[54:55], v42 offset:17408
    v_mfma_f32_16x16x32_bf16 v[184:187], v[68:71], v[96:99], v[184:187]
    v_add_u32 v43, 0xc000, v43
    ds_read_b64_tr_b16 v[56:57], v43 offset:0
    v_mfma_f32_16x16x32_bf16 v[200:203], v[68:71], v[100:103], v[200:203]
    ds_read_b64_tr_b16 v[58:59], v43 offset:1024
    v_mfma_f32_16x16x32_bf16 v[216:219], v[68:71], v[104:107], v[216:219]
    ds_read_b64_tr_b16 v[60:61], v43 offset:16384
    v_mfma_f32_16x16x32_bf16 v[232:235], v[68:71], v[108:111], v[232:235]
    ds_read_b64_tr_b16 v[62:63], v43 offset:17408
    v_mfma_f32_16x16x32_bf16 v[180:183], v[72:75], v[96:99], v[180:183]
    v_mfma_f32_16x16x32_bf16 v[196:199], v[72:75], v[100:103], v[196:199]
    v_mfma_f32_16x16x32_bf16 v[212:215], v[72:75], v[104:107], v[212:215]
    v_mfma_f32_16x16x32_bf16 v[228:231], v[72:75], v[108:111], v[228:231]
    v_mfma_f32_16x16x32_bf16 v[188:191], v[76:79], v[96:99], v[188:191]
    v_mfma_f32_16x16x32_bf16 v[204:207], v[76:79], v[100:103], v[204:207]
    v_mfma_f32_16x16x32_bf16 v[220:223], v[76:79], v[104:107], v[220:223]
    v_mfma_f32_16x16x32_bf16 v[236:239], v[76:79], v[108:111], v[236:239]
    s_waitcnt lgkmcnt(9)
    v_mfma_f32_16x16x32_bf16 v[112:115], v[48:51], v[80:83], v[112:115]
    v_add_u32 v41, 0xc000, v41
    ds_read_b128 v[96:99], v41 offset:0
    s_waitcnt lgkmcnt(9)
    v_mfma_f32_16x16x32_bf16 v[128:131], v[48:51], v[84:87], v[128:131]
    ds_read_b128 v[100:103], v41 offset:2048
    s_waitcnt lgkmcnt(9)
    v_mfma_f32_16x16x32_bf16 v[144:147], v[48:51], v[88:91], v[144:147]
    ds_read_b128 v[104:107], v41 offset:4096
    s_waitcnt lgkmcnt(9)
    v_mfma_f32_16x16x32_bf16 v[160:163], v[48:51], v[92:95], v[160:163]
    ds_read_b128 v[108:111], v41 offset:6144
    s_waitcnt lgkmcnt(8)
    v_mfma_f32_16x16x32_bf16 v[120:123], v[52:55], v[80:83], v[120:123]
    v_add_u32 v44, 0xc000, v44
    ds_read_b64_tr_b16 v[64:65], v44 offset:0
    v_mfma_f32_16x16x32_bf16 v[136:139], v[52:55], v[84:87], v[136:139]
    ds_read_b64_tr_b16 v[66:67], v44 offset:1024
    v_mfma_f32_16x16x32_bf16 v[152:155], v[52:55], v[88:91], v[152:155]
    ds_read_b64_tr_b16 v[68:69], v44 offset:16384
    v_mfma_f32_16x16x32_bf16 v[168:171], v[52:55], v[92:95], v[168:171]
    ds_read_b64_tr_b16 v[70:71], v44 offset:17408
    s_waitcnt lgkmcnt(10)
    v_mfma_f32_16x16x32_bf16 v[116:119], v[56:59], v[80:83], v[116:119]
    v_add_u32 v45, 0xc000, v45
    ds_read_b64_tr_b16 v[72:73], v45 offset:0
    v_mfma_f32_16x16x32_bf16 v[132:135], v[56:59], v[84:87], v[132:135]
    ds_read_b64_tr_b16 v[74:75], v45 offset:1024
    v_mfma_f32_16x16x32_bf16 v[148:151], v[56:59], v[88:91], v[148:151]
    ds_read_b64_tr_b16 v[76:77], v45 offset:16384
    v_mfma_f32_16x16x32_bf16 v[164:167], v[56:59], v[92:95], v[164:167]
    ds_read_b64_tr_b16 v[78:79], v45 offset:17408
    s_waitcnt lgkmcnt(12)
    v_mfma_f32_16x16x32_bf16 v[124:127], v[60:63], v[80:83], v[124:127]
    ds_read_b64_tr_b16 v[48:49], v42 offset:8192
    v_mfma_f32_16x16x32_bf16 v[140:143], v[60:63], v[84:87], v[140:143]
    ds_read_b64_tr_b16 v[50:51], v42 offset:9216
    v_mfma_f32_16x16x32_bf16 v[156:159], v[60:63], v[88:91], v[156:159]
    v_mfma_f32_16x16x32_bf16 v[172:175], v[60:63], v[92:95], v[172:175]
    s_waitcnt lgkmcnt(8)
    v_mfma_f32_16x16x32_bf16 v[176:179], v[64:67], v[80:83], v[176:179]
    ds_read_b64_tr_b16 v[52:53], v42 offset:24576
    v_mfma_f32_16x16x32_bf16 v[192:195], v[64:67], v[84:87], v[192:195]
    ds_read_b64_tr_b16 v[54:55], v42 offset:25600
    v_mfma_f32_16x16x32_bf16 v[208:211], v[64:67], v[88:91], v[208:211]
    ds_read_b64_tr_b16 v[56:57], v43 offset:8192
    v_mfma_f32_16x16x32_bf16 v[224:227], v[64:67], v[92:95], v[224:227]
    ds_read_b64_tr_b16 v[58:59], v43 offset:9216
    s_waitcnt lgkmcnt(10)
    v_mfma_f32_16x16x32_bf16 v[184:187], v[68:71], v[80:83], v[184:187]
    ds_read_b64_tr_b16 v[60:61], v43 offset:24576
    v_mfma_f32_16x16x32_bf16 v[200:203], v[68:71], v[84:87], v[200:203]
    ds_read_b64_tr_b16 v[62:63], v43 offset:25600
    v_mfma_f32_16x16x32_bf16 v[216:219], v[68:71], v[88:91], v[216:219]
    ds_read_b64_tr_b16 v[64:65], v44 offset:8192
    v_mfma_f32_16x16x32_bf16 v[232:235], v[68:71], v[92:95], v[232:235]
    ds_read_b64_tr_b16 v[66:67], v44 offset:9216
    s_waitcnt lgkmcnt(12)
    v_mfma_f32_16x16x32_bf16 v[180:183], v[72:75], v[80:83], v[180:183]
    ds_read_b64_tr_b16 v[68:69], v44 offset:24576
    v_mfma_f32_16x16x32_bf16 v[196:199], v[72:75], v[84:87], v[196:199]
    ds_read_b64_tr_b16 v[70:71], v44 offset:25600
    v_mfma_f32_16x16x32_bf16 v[212:215], v[72:75], v[88:91], v[212:215]
    v_mfma_f32_16x16x32_bf16 v[228:231], v[72:75], v[92:95], v[228:231]
    s_waitcnt lgkmcnt(12)
    v_mfma_f32_16x16x32_bf16 v[188:191], v[76:79], v[80:83], v[188:191]
    ds_read_b64_tr_b16 v[72:73], v45 offset:8192
    v_mfma_f32_16x16x32_bf16 v[204:207], v[76:79], v[84:87], v[204:207]
    ds_read_b64_tr_b16 v[74:75], v45 offset:9216
    v_mfma_f32_16x16x32_bf16 v[220:223], v[76:79], v[88:91], v[220:223]
    v_mfma_f32_16x16x32_bf16 v[236:239], v[76:79], v[92:95], v[236:239]
    s_waitcnt lgkmcnt(12)
    v_mfma_f32_16x16x32_bf16 v[112:115], v[48:51], v[96:99], v[112:115]
    ds_read_b64_tr_b16 v[76:77], v45 offset:24576
    v_mfma_f32_16x16x32_bf16 v[128:131], v[48:51], v[100:103], v[128:131]
    ds_read_b64_tr_b16 v[78:79], v45 offset:25600
    v_mfma_f32_16x16x32_bf16 v[144:147], v[48:51], v[104:107], v[144:147]
    v_mfma_f32_16x16x32_bf16 v[160:163], v[48:51], v[108:111], v[160:163]
    s_waitcnt lgkmcnt(12)
    v_mfma_f32_16x16x32_bf16 v[120:123], v[52:55], v[96:99], v[120:123]
    v_mfma_f32_16x16x32_bf16 v[136:139], v[52:55], v[100:103], v[136:139]
    v_mfma_f32_16x16x32_bf16 v[152:155], v[52:55], v[104:107], v[152:155]
    v_mfma_f32_16x16x32_bf16 v[168:171], v[52:55], v[108:111], v[168:171]
    s_waitcnt lgkmcnt(10)
    v_mfma_f32_16x16x32_bf16 v[116:119], v[56:59], v[96:99], v[116:119]
    v_mfma_f32_16x16x32_bf16 v[132:135], v[56:59], v[100:103], v[132:135]
    v_mfma_f32_16x16x32_bf16 v[148:151], v[56:59], v[104:107], v[148:151]
    v_mfma_f32_16x16x32_bf16 v[164:167], v[56:59], v[108:111], v[164:167]
    s_waitcnt lgkmcnt(0)
    s_barrier
    v_mfma_f32_16x16x32_bf16 v[124:127], v[60:63], v[96:99], v[124:127]
    v_mfma_f32_16x16x32_bf16 v[140:143], v[60:63], v[100:103], v[140:143]
    v_mfma_f32_16x16x32_bf16 v[156:159], v[60:63], v[104:107], v[156:159]
    v_mfma_f32_16x16x32_bf16 v[172:175], v[60:63], v[108:111], v[172:175]
    v_mfma_f32_16x16x32_bf16 v[176:179], v[64:67], v[96:99], v[176:179]
    v_mfma_f32_16x16x32_bf16 v[192:195], v[64:67], v[100:103], v[192:195]
    v_mfma_f32_16x16x32_bf16 v[208:211], v[64:67], v[104:107], v[208:211]
    v_mfma_f32_16x16x32_bf16 v[224:227], v[64:67], v[108:111], v[224:227]
    v_mfma_f32_16x16x32_bf16 v[184:187], v[68:71], v[96:99], v[184:187]
    v_mfma_f32_16x16x32_bf16 v[200:203], v[68:71], v[100:103], v[200:203]
    v_mfma_f32_16x16x32_bf16 v[216:219], v[68:71], v[104:107], v[216:219]
    v_mfma_f32_16x16x32_bf16 v[232:235], v[68:71], v[108:111], v[232:235]
    v_mfma_f32_16x16x32_bf16 v[180:183], v[72:75], v[96:99], v[180:183]
    v_mfma_f32_16x16x32_bf16 v[196:199], v[72:75], v[100:103], v[196:199]
    v_mfma_f32_16x16x32_bf16 v[212:215], v[72:75], v[104:107], v[212:215]
    v_mfma_f32_16x16x32_bf16 v[228:231], v[72:75], v[108:111], v[228:231]
    v_mfma_f32_16x16x32_bf16 v[188:191], v[76:79], v[96:99], v[188:191]
    v_mfma_f32_16x16x32_bf16 v[204:207], v[76:79], v[100:103], v[204:207]
    v_mfma_f32_16x16x32_bf16 v[220:223], v[76:79], v[104:107], v[220:223]
    v_mfma_f32_16x16x32_bf16 v[236:239], v[76:79], v[108:111], v[236:239]
    s_nop 7
    v_pk_mul_f32 v[16:17], v[112:113], s[74:75]
    v_pk_mul_f32 v[18:19], v[114:115], s[74:75]
    v_pk_mul_f32 v[20:21], v[116:117], s[74:75]
    v_pk_mul_f32 v[22:23], v[118:119], s[74:75]
    v_exp_f32 v16, v16
    v_exp_f32 v17, v17
    v_exp_f32 v18, v18
    v_exp_f32 v19, v19
    v_exp_f32 v20, v20
    v_exp_f32 v21, v21
    v_exp_f32 v22, v22
    v_exp_f32 v23, v23
    v_pk_mul_f32 v[112:113], v[112:113], v[120:121]
    v_pk_mul_f32 v[114:115], v[114:115], v[122:123]
    v_pk_mul_f32 v[116:117], v[116:117], v[124:125]
    v_pk_mul_f32 v[118:119], v[118:119], v[126:127]
    v_pk_add_f32 v[16:17], v[16:17], 1.0 op_sel_hi:[1,0]
    v_pk_add_f32 v[18:19], v[18:19], 1.0 op_sel_hi:[1,0]
    v_pk_add_f32 v[20:21], v[20:21], 1.0 op_sel_hi:[1,0]
    v_pk_add_f32 v[22:23], v[22:23], 1.0 op_sel_hi:[1,0]
    v_rcp_f32 v16, v16
    v_rcp_f32 v17, v17
    v_rcp_f32 v18, v18
    v_rcp_f32 v19, v19
    v_rcp_f32 v20, v20
    v_rcp_f32 v21, v21
    v_rcp_f32 v22, v22
    v_rcp_f32 v23, v23
    s_nop 0
    v_pk_mul_f32 v[112:113], v[112:113], v[16:17]
    v_pk_mul_f32 v[114:115], v[114:115], v[18:19]
    v_pk_mul_f32 v[116:117], v[116:117], v[20:21]
    v_pk_mul_f32 v[118:119], v[118:119], v[22:23]
    v_cvt_pk_bf16_f32 v24, v112, v113
    v_cvt_pk_bf16_f32 v25, v114, v115
    v_cvt_pk_bf16_f32 v26, v116, v117
    v_cvt_pk_bf16_f32 v27, v118, v119
    buffer_store_dwordx4 v[24:27], v254, s[64:67], s86 offen offset:0 sc1
    v_pk_mul_f32 v[28:29], v[128:129], s[74:75]
    v_pk_mul_f32 v[30:31], v[130:131], s[74:75]
    v_pk_mul_f32 v[32:33], v[132:133], s[74:75]
    v_pk_mul_f32 v[34:35], v[134:135], s[74:75]
    v_exp_f32 v28, v28
    v_exp_f32 v29, v29
    v_exp_f32 v30, v30
    v_exp_f32 v31, v31
    v_exp_f32 v32, v32
    v_exp_f32 v33, v33
    v_exp_f32 v34, v34
    v_exp_f32 v35, v35
    v_pk_mul_f32 v[128:129], v[128:129], v[136:137]
    v_pk_mul_f32 v[130:131], v[130:131], v[138:139]
    v_pk_mul_f32 v[132:133], v[132:133], v[140:141]
    v_pk_mul_f32 v[134:135], v[134:135], v[142:143]
    v_pk_add_f32 v[28:29], v[28:29], 1.0 op_sel_hi:[1,0]
    v_pk_add_f32 v[30:31], v[30:31], 1.0 op_sel_hi:[1,0]
    v_pk_add_f32 v[32:33], v[32:33], 1.0 op_sel_hi:[1,0]
    v_pk_add_f32 v[34:35], v[34:35], 1.0 op_sel_hi:[1,0]
    v_rcp_f32 v28, v28
    v_rcp_f32 v29, v29
    v_rcp_f32 v30, v30
    v_rcp_f32 v31, v31
    v_rcp_f32 v32, v32
    v_rcp_f32 v33, v33
    v_rcp_f32 v34, v34
    v_rcp_f32 v35, v35
    s_nop 0
    v_pk_mul_f32 v[128:129], v[128:129], v[28:29]
    v_pk_mul_f32 v[130:131], v[130:131], v[30:31]
    v_pk_mul_f32 v[132:133], v[132:133], v[32:33]
    v_pk_mul_f32 v[134:135], v[134:135], v[34:35]
    v_cvt_pk_bf16_f32 v36, v128, v129
    v_cvt_pk_bf16_f32 v37, v130, v131
    v_cvt_pk_bf16_f32 v38, v132, v133
    v_cvt_pk_bf16_f32 v39, v134, v135
    buffer_store_dwordx4 v[36:39], v254, s[64:67], s86 offen offset:256 sc1
    v_pk_mul_f32 v[16:17], v[144:145], s[74:75]
    v_pk_mul_f32 v[18:19], v[146:147], s[74:75]
    v_pk_mul_f32 v[20:21], v[148:149], s[74:75]
    v_pk_mul_f32 v[22:23], v[150:151], s[74:75]
    v_exp_f32 v16, v16
    v_exp_f32 v17, v17
    v_exp_f32 v18, v18
    v_exp_f32 v19, v19
    v_exp_f32 v20, v20
    v_exp_f32 v21, v21
    v_exp_f32 v22, v22
    v_exp_f32 v23, v23
    v_pk_mul_f32 v[144:145], v[144:145], v[152:153]
    v_pk_mul_f32 v[146:147], v[146:147], v[154:155]
    v_pk_mul_f32 v[148:149], v[148:149], v[156:157]
    v_pk_mul_f32 v[150:151], v[150:151], v[158:159]
    v_pk_add_f32 v[16:17], v[16:17], 1.0 op_sel_hi:[1,0]
    v_pk_add_f32 v[18:19], v[18:19], 1.0 op_sel_hi:[1,0]
    v_pk_add_f32 v[20:21], v[20:21], 1.0 op_sel_hi:[1,0]
    v_pk_add_f32 v[22:23], v[22:23], 1.0 op_sel_hi:[1,0]
    v_rcp_f32 v16, v16
    v_rcp_f32 v17, v17
    v_rcp_f32 v18, v18
    v_rcp_f32 v19, v19
    v_rcp_f32 v20, v20
    v_rcp_f32 v21, v21
    v_rcp_f32 v22, v22
    v_rcp_f32 v23, v23
    s_nop 0
    v_pk_mul_f32 v[144:145], v[144:145], v[16:17]
    v_pk_mul_f32 v[146:147], v[146:147], v[18:19]
    v_pk_mul_f32 v[148:149], v[148:149], v[20:21]
    v_pk_mul_f32 v[150:151], v[150:151], v[22:23]
    v_cvt_pk_bf16_f32 v24, v144, v145
    v_cvt_pk_bf16_f32 v25, v146, v147
    v_cvt_pk_bf16_f32 v26, v148, v149
    v_cvt_pk_bf16_f32 v27, v150, v151
    buffer_store_dwordx4 v[24:27], v254, s[64:67], s87 offen offset:0 sc1
    v_pk_mul_f32 v[28:29], v[160:161], s[74:75]
    v_pk_mul_f32 v[30:31], v[162:163], s[74:75]
    v_pk_mul_f32 v[32:33], v[164:165], s[74:75]
    v_pk_mul_f32 v[34:35], v[166:167], s[74:75]
    v_exp_f32 v28, v28
    v_exp_f32 v29, v29
    v_exp_f32 v30, v30
    v_exp_f32 v31, v31
    v_exp_f32 v32, v32
    v_exp_f32 v33, v33
    v_exp_f32 v34, v34
    v_exp_f32 v35, v35
    v_pk_mul_f32 v[160:161], v[160:161], v[168:169]
    v_pk_mul_f32 v[162:163], v[162:163], v[170:171]
    v_pk_mul_f32 v[164:165], v[164:165], v[172:173]
    v_pk_mul_f32 v[166:167], v[166:167], v[174:175]
    v_pk_add_f32 v[28:29], v[28:29], 1.0 op_sel_hi:[1,0]
    v_pk_add_f32 v[30:31], v[30:31], 1.0 op_sel_hi:[1,0]
    v_pk_add_f32 v[32:33], v[32:33], 1.0 op_sel_hi:[1,0]
    v_pk_add_f32 v[34:35], v[34:35], 1.0 op_sel_hi:[1,0]
    v_rcp_f32 v28, v28
    v_rcp_f32 v29, v29
    v_rcp_f32 v30, v30
    v_rcp_f32 v31, v31
    v_rcp_f32 v32, v32
    v_rcp_f32 v33, v33
    v_rcp_f32 v34, v34
    v_rcp_f32 v35, v35
    s_nop 0
    v_pk_mul_f32 v[160:161], v[160:161], v[28:29]
    v_pk_mul_f32 v[162:163], v[162:163], v[30:31]
    v_pk_mul_f32 v[164:165], v[164:165], v[32:33]
    v_pk_mul_f32 v[166:167], v[166:167], v[34:35]
    v_cvt_pk_bf16_f32 v36, v160, v161
    v_cvt_pk_bf16_f32 v37, v162, v163
    v_cvt_pk_bf16_f32 v38, v164, v165
    v_cvt_pk_bf16_f32 v39, v166, v167
    buffer_store_dwordx4 v[36:39], v254, s[64:67], s87 offen offset:256 sc1
    v_pk_mul_f32 v[16:17], v[176:177], s[74:75]
    v_pk_mul_f32 v[18:19], v[178:179], s[74:75]
    v_pk_mul_f32 v[20:21], v[180:181], s[74:75]
    v_pk_mul_f32 v[22:23], v[182:183], s[74:75]
    v_exp_f32 v16, v16
    v_exp_f32 v17, v17
    v_exp_f32 v18, v18
    v_exp_f32 v19, v19
    v_exp_f32 v20, v20
    v_exp_f32 v21, v21
    v_exp_f32 v22, v22
    v_exp_f32 v23, v23
    v_pk_mul_f32 v[176:177], v[176:177], v[184:185]
    v_pk_mul_f32 v[178:179], v[178:179], v[186:187]
    v_pk_mul_f32 v[180:181], v[180:181], v[188:189]
    v_pk_mul_f32 v[182:183], v[182:183], v[190:191]
    v_pk_add_f32 v[16:17], v[16:17], 1.0 op_sel_hi:[1,0]
    v_pk_add_f32 v[18:19], v[18:19], 1.0 op_sel_hi:[1,0]
    v_pk_add_f32 v[20:21], v[20:21], 1.0 op_sel_hi:[1,0]
    v_pk_add_f32 v[22:23], v[22:23], 1.0 op_sel_hi:[1,0]
    v_rcp_f32 v16, v16
    v_rcp_f32 v17, v17
    v_rcp_f32 v18, v18
    v_rcp_f32 v19, v19
    v_rcp_f32 v20, v20
    v_rcp_f32 v21, v21
    v_rcp_f32 v22, v22
    v_rcp_f32 v23, v23
    s_nop 0
    v_pk_mul_f32 v[176:177], v[176:177], v[16:17]
    v_pk_mul_f32 v[178:179], v[178:179], v[18:19]
    v_pk_mul_f32 v[180:181], v[180:181], v[20:21]
    v_pk_mul_f32 v[182:183], v[182:183], v[22:23]
    v_cvt_pk_bf16_f32 v24, v176, v177
    v_cvt_pk_bf16_f32 v25, v178, v179
    v_cvt_pk_bf16_f32 v26, v180, v181
    v_cvt_pk_bf16_f32 v27, v182, v183
    buffer_store_dwordx4 v[24:27], v254, s[64:67], s86 offen offset:2048 sc1
    v_pk_mul_f32 v[28:29], v[192:193], s[74:75]
    v_pk_mul_f32 v[30:31], v[194:195], s[74:75]
    v_pk_mul_f32 v[32:33], v[196:197], s[74:75]
    v_pk_mul_f32 v[34:35], v[198:199], s[74:75]
    v_exp_f32 v28, v28
    v_exp_f32 v29, v29
    v_exp_f32 v30, v30
    v_exp_f32 v31, v31
    v_exp_f32 v32, v32
    v_exp_f32 v33, v33
    v_exp_f32 v34, v34
    v_exp_f32 v35, v35
    v_pk_mul_f32 v[192:193], v[192:193], v[200:201]
    v_pk_mul_f32 v[194:195], v[194:195], v[202:203]
    v_pk_mul_f32 v[196:197], v[196:197], v[204:205]
    v_pk_mul_f32 v[198:199], v[198:199], v[206:207]
    v_pk_add_f32 v[28:29], v[28:29], 1.0 op_sel_hi:[1,0]
    v_pk_add_f32 v[30:31], v[30:31], 1.0 op_sel_hi:[1,0]
    v_pk_add_f32 v[32:33], v[32:33], 1.0 op_sel_hi:[1,0]
    v_pk_add_f32 v[34:35], v[34:35], 1.0 op_sel_hi:[1,0]
    v_rcp_f32 v28, v28
    v_rcp_f32 v29, v29
    v_rcp_f32 v30, v30
    v_rcp_f32 v31, v31
    v_rcp_f32 v32, v32
    v_rcp_f32 v33, v33
    v_rcp_f32 v34, v34
    v_rcp_f32 v35, v35
    s_nop 0
    v_pk_mul_f32 v[192:193], v[192:193], v[28:29]
    v_pk_mul_f32 v[194:195], v[194:195], v[30:31]
    v_pk_mul_f32 v[196:197], v[196:197], v[32:33]
    v_pk_mul_f32 v[198:199], v[198:199], v[34:35]
    v_cvt_pk_bf16_f32 v36, v192, v193
    v_cvt_pk_bf16_f32 v37, v194, v195
    v_cvt_pk_bf16_f32 v38, v196, v197
    v_cvt_pk_bf16_f32 v39, v198, v199
    buffer_store_dwordx4 v[36:39], v254, s[64:67], s86 offen offset:2304 sc1
    v_pk_mul_f32 v[16:17], v[208:209], s[74:75]
    v_pk_mul_f32 v[18:19], v[210:211], s[74:75]
    v_pk_mul_f32 v[20:21], v[212:213], s[74:75]
    v_pk_mul_f32 v[22:23], v[214:215], s[74:75]
    v_exp_f32 v16, v16
    v_exp_f32 v17, v17
    v_exp_f32 v18, v18
    v_exp_f32 v19, v19
    v_exp_f32 v20, v20
    v_exp_f32 v21, v21
    v_exp_f32 v22, v22
    v_exp_f32 v23, v23
    v_pk_mul_f32 v[208:209], v[208:209], v[216:217]
    v_pk_mul_f32 v[210:211], v[210:211], v[218:219]
    v_pk_mul_f32 v[212:213], v[212:213], v[220:221]
    v_pk_mul_f32 v[214:215], v[214:215], v[222:223]
    v_pk_add_f32 v[16:17], v[16:17], 1.0 op_sel_hi:[1,0]
    v_pk_add_f32 v[18:19], v[18:19], 1.0 op_sel_hi:[1,0]
    v_pk_add_f32 v[20:21], v[20:21], 1.0 op_sel_hi:[1,0]
    v_pk_add_f32 v[22:23], v[22:23], 1.0 op_sel_hi:[1,0]
    v_rcp_f32 v16, v16
    v_rcp_f32 v17, v17
    v_rcp_f32 v18, v18
    v_rcp_f32 v19, v19
    v_rcp_f32 v20, v20
    v_rcp_f32 v21, v21
    v_rcp_f32 v22, v22
    v_rcp_f32 v23, v23
    s_nop 0
    v_pk_mul_f32 v[208:209], v[208:209], v[16:17]
    v_pk_mul_f32 v[210:211], v[210:211], v[18:19]
    v_pk_mul_f32 v[212:213], v[212:213], v[20:21]
    v_pk_mul_f32 v[214:215], v[214:215], v[22:23]
    v_cvt_pk_bf16_f32 v24, v208, v209
    v_cvt_pk_bf16_f32 v25, v210, v211
    v_cvt_pk_bf16_f32 v26, v212, v213
    v_cvt_pk_bf16_f32 v27, v214, v215
    buffer_store_dwordx4 v[24:27], v254, s[64:67], s87 offen offset:2048 sc1
    v_pk_mul_f32 v[28:29], v[224:225], s[74:75]
    v_pk_mul_f32 v[30:31], v[226:227], s[74:75]
    v_pk_mul_f32 v[32:33], v[228:229], s[74:75]
    v_pk_mul_f32 v[34:35], v[230:231], s[74:75]
    v_exp_f32 v28, v28
    v_exp_f32 v29, v29
    v_exp_f32 v30, v30
    v_exp_f32 v31, v31
    v_exp_f32 v32, v32
    v_exp_f32 v33, v33
    v_exp_f32 v34, v34
    v_exp_f32 v35, v35
    v_pk_mul_f32 v[224:225], v[224:225], v[232:233]
    v_pk_mul_f32 v[226:227], v[226:227], v[234:235]
    v_pk_mul_f32 v[228:229], v[228:229], v[236:237]
    v_pk_mul_f32 v[230:231], v[230:231], v[238:239]
    v_pk_add_f32 v[28:29], v[28:29], 1.0 op_sel_hi:[1,0]
    v_pk_add_f32 v[30:31], v[30:31], 1.0 op_sel_hi:[1,0]
    v_pk_add_f32 v[32:33], v[32:33], 1.0 op_sel_hi:[1,0]
    v_pk_add_f32 v[34:35], v[34:35], 1.0 op_sel_hi:[1,0]
    v_rcp_f32 v28, v28
    v_rcp_f32 v29, v29
    v_rcp_f32 v30, v30
    v_rcp_f32 v31, v31
    v_rcp_f32 v32, v32
    v_rcp_f32 v33, v33
    v_rcp_f32 v34, v34
    v_rcp_f32 v35, v35
    s_nop 0
    v_pk_mul_f32 v[224:225], v[224:225], v[28:29]
    v_pk_mul_f32 v[226:227], v[226:227], v[30:31]
    v_pk_mul_f32 v[228:229], v[228:229], v[32:33]
    v_pk_mul_f32 v[230:231], v[230:231], v[34:35]
    v_cvt_pk_bf16_f32 v36, v224, v225
    v_cvt_pk_bf16_f32 v37, v226, v227
    v_cvt_pk_bf16_f32 v38, v228, v229
    v_cvt_pk_bf16_f32 v39, v230, v231
    buffer_store_dwordx4 v[36:39], v254, s[64:67], s87 offen offset:2304 sc1
    s_branch L_g1done
L_g1b:
    s_barrier
    ds_read_b128 v[80:83], v40 offset:0
    ds_read_b64_tr_b16 v[48:49], v42 offset:0
    ds_read_b64_tr_b16 v[50:51], v42 offset:1024
    ds_read_b128 v[84:87], v40 offset:2048
    ds_read_b64_tr_b16 v[52:53], v42 offset:16384
    ds_read_b64_tr_b16 v[54:55], v42 offset:17408
    ds_read_b64_tr_b16 v[56:57], v43 offset:0
    ds_read_b64_tr_b16 v[58:59], v43 offset:1024
    ds_read_b64_tr_b16 v[60:61], v43 offset:16384
    ds_read_b64_tr_b16 v[62:63], v43 offset:17408
    ds_read_b128 v[96:99], v41 offset:0
    ds_read_b128 v[100:103], v41 offset:2048
    ds_read_b64_tr_b16 v[64:65], v44 offset:0
    ds_read_b64_tr_b16 v[66:67], v44 offset:1024
    s_waitcnt lgkmcnt(11)
    v_mfma_f32_16x16x32_bf16 v[112:115], v[48:51], v[80:83], 0
    ds_read_b64_tr_b16 v[68:69], v44 offset:16384
    ds_read_b64_tr_b16 v[70:71], v44 offset:17408
    s_waitcnt lgkmcnt(12)
    v_mfma_f32_16x16x32_bf16 v[128:131], v[48:51], v[84:87], 0
    ds_read_b64_tr_b16 v[72:73], v45 offset:0
    ds_read_b64_tr_b16 v[74:75], v45 offset:1024
    s_waitcnt lgkmcnt(12)
    v_mfma_f32_16x16x32_bf16 v[120:123], v[52:55], v[80:83], 0
    ds_read_b64_tr_b16 v[76:77], v45 offset:16384
    ds_read_b64_tr_b16 v[78:79], v45 offset:17408
    v_mfma_f32_16x16x32_bf16 v[136:139], v[52:55], v[84:87], 0
    s_waitcnt lgkmcnt(12)
    v_mfma_f32_16x16x32_bf16 v[116:119], v[56:59], v[80:83], 0
    ds_read_b64_tr_b16 v[48:49], v46 offset:0
    ds_read_b64_tr_b16 v[50:51], v46 offset:1024
    v_mfma_f32_16x16x32_bf16 v[132:135], v[56:59], v[84:87], 0
    s_waitcnt lgkmcnt(12)
    v_mfma_f32_16x16x32_bf16 v[124:127], v[60:63], v[80:83], 0
    ds_read_b64_tr_b16 v[52:53], v46 offset:16384
    ds_read_b64_tr_b16 v[54:55], v46 offset:17408
    v_mfma_f32_16x16x32_bf16 v[140:143], v[60:63], v[84:87], 0
    s_waitcnt lgkmcnt(10)
    v_mfma_f32_16x16x32_bf16 v[144:147], v[64:67], v[80:83], 0
    ds_read_b64_tr_b16 v[56:57], v47 offset:0
    ds_read_b64_tr_b16 v[58:59], v47 offset:1024
    v_mfma_f32_16x16x32_bf16 v[160:163], v[64:67], v[84:87], 0
    ds_read_b64_tr_b16 v[60:61], v47 offset:16384
    ds_read_b64_tr_b16 v[62:63], v47 offset:17408
    s_waitcnt lgkmcnt(12)
    v_mfma_f32_16x16x32_bf16 v[152:155], v[68:71], v[80:83], 0
    ds_read_b64_tr_b16 v[64:65], v42 offset:8192
    ds_read_b64_tr_b16 v[66:67], v42 offset:9216
    v_mfma_f32_16x16x32_bf16 v[168:171], v[68:71], v[84:87], 0
    s_waitcnt lgkmcnt(12)
    v_mfma_f32_16x16x32_bf16 v[148:151], v[72:75], v[80:83], 0
    ds_read_b64_tr_b16 v[68:69], v42 offset:24576
    ds_read_b64_tr_b16 v[70:71], v42 offset:25600
    v_mfma_f32_16x16x32_bf16 v[164:167], v[72:75], v[84:87], 0
    s_waitcnt lgkmcnt(12)
    v_mfma_f32_16x16x32_bf16 v[156:159], v[76:79], v[80:83], 0
    ds_read_b64_tr_b16 v[72:73], v43 offset:8192
    ds_read_b64_tr_b16 v[74:75], v43 offset:9216
    v_mfma_f32_16x16x32_bf16 v[172:175], v[76:79], v[84:87], 0
    s_waitcnt lgkmcnt(12)
    v_mfma_f32_16x16x32_bf16 v[176:179], v[48:51], v[80:83], 0
    ds_read_b64_tr_b16 v[76:77], v43 offset:24576
    ds_read_b64_tr_b16 v[78:79], v43 offset:25600
    v_mfma_f32_16x16x32_bf16 v[192:195], v[48:51], v[84:87], 0
    s_waitcnt lgkmcnt(12)
    v_mfma_f32_16x16x32_bf16 v[184:187], v[52:55], v[80:83], 0
    ds_read_b64_tr_b16 v[48:49], v44 offset:8192
    ds_read_b64_tr_b16 v[50:51], v44 offset:9216
    v_mfma_f32_16x16x32_bf16 v[200:203], v[52:55], v[84:87], 0
    s_waitcnt lgkmcnt(12)
    v_mfma_f32_16x16x32_bf16 v[180:183], v[56:59], v[80:83], 0
    ds_read_b64_tr_b16 v[52:53], v44 offset:24576
    ds_read_b64_tr_b16 v[54:55], v44 offset:25600
    v_mfma_f32_16x16x32_bf16 v[196:199], v[56:59], v[84:87], 0
    s_waitcnt lgkmcnt(12)
    v_mfma_f32_16x16x32_bf16 v[188:191], v[60:63], v[80:83], 0
    ds_read_b64_tr_b16 v[56:57], v45 offset:8192
    ds_read_b64_tr_b16 v[58:59], v45 offset:9216
    v_mfma_f32_16x16x32_bf16 v[204:207], v[60:63], v[84:87], 0
    s_waitcnt lgkmcnt(12)
    v_mfma_f32_16x16x32_bf16 v[112:115], v[64:67], v[96:99], v[112:115]
    ds_read_b64_tr_b16 v[60:61], v45 offset:24576
    ds_read_b64_tr_b16 v[62:63], v45 offset:25600
    v_mfma_f32_16x16x32_bf16 v[128:131], v[64:67], v[100:103], v[128:131]
    s_waitcnt lgkmcnt(12)
    v_mfma_f32_16x16x32_bf16 v[120:123], v[68:71], v[96:99], v[120:123]
    ds_read_b64_tr_b16 v[64:65], v46 offset:8192
    ds_read_b64_tr_b16 v[66:67], v46 offset:9216
    v_mfma_f32_16x16x32_bf16 v[136:139], v[68:71], v[100:103], v[136:139]
    s_waitcnt lgkmcnt(12)
    v_mfma_f32_16x16x32_bf16 v[116:119], v[72:75], v[96:99], v[116:119]
    ds_read_b64_tr_b16 v[68:69], v46 offset:24576
    ds_read_b64_tr_b16 v[70:71], v46 offset:25600
    v_mfma_f32_16x16x32_bf16 v[132:135], v[72:75], v[100:103], v[132:135]
    s_waitcnt lgkmcnt(12)
    v_mfma_f32_16x16x32_bf16 v[124:127], v[76:79], v[96:99], v[124:127]
    ds_read_b64_tr_b16 v[72:73], v47 offset:8192
    ds_read_b64_tr_b16 v[74:75], v47 offset:9216
    v_mfma_f32_16x16x32_bf16 v[140:143], v[76:79], v[100:103], v[140:143]
    s_waitcnt lgkmcnt(12)
    v_mfma_f32_16x16x32_bf16 v[144:147], v[48:51], v[96:99], v[144:147]
    ds_read_b64_tr_b16 v[76:77], v47 offset:24576
    ds_read_b64_tr_b16 v[78:79], v47 offset:25600
    v_mfma_f32_16x16x32_bf16 v[160:163], v[48:51], v[100:103], v[160:163]
    s_waitcnt lgkmcnt(12)
    v_mfma_f32_16x16x32_bf16 v[152:155], v[52:55], v[96:99], v[152:155]
    v_mfma_f32_16x16x32_bf16 v[168:171], v[52:55], v[100:103], v[168:171]
    s_waitcnt lgkmcnt(10)
    v_mfma_f32_16x16x32_bf16 v[148:151], v[56:59], v[96:99], v[148:151]
    v_mfma_f32_16x16x32_bf16 v[164:167], v[56:59], v[100:103], v[164:167]
    s_waitcnt lgkmcnt(0)
    s_barrier
    v_mfma_f32_16x16x32_bf16 v[156:159], v[60:63], v[96:99], v[156:159]
    v_add_u32 v40, 0xc000, v40
    ds_read_b128 v[80:83], v40 offset:0
    v_add_u32 v42, 0xc000, v42
    ds_read_b64_tr_b16 v[48:49], v42 offset:0
    v_mfma_f32_16x16x32_bf16 v[172:175], v[60:63], v[100:103], v[172:175]
    ds_read_b64_tr_b16 v[50:51], v42 offset:1024
    ds_read_b128 v[84:87], v40 offset:2048
    v_mfma_f32_16x16x32_bf16 v[176:179], v[64:67], v[96:99], v[176:179]
    ds_read_b64_tr_b16 v[52:53], v42 offset:16384
    ds_read_b64_tr_b16 v[54:55], v42 offset:17408
    v_mfma_f32_16x16x32_bf16 v[192:195], v[64:67], v[100:103], v[192:195]
    v_add_u32 v43, 0xc000, v43
    ds_read_b64_tr_b16 v[56:57], v43 offset:0
    ds_read_b64_tr_b16 v[58:59], v43 offset:1024
    v_mfma_f32_16x16x32_bf16 v[184:187], v[68:71], v[96:99], v[184:187]
    ds_read_b64_tr_b16 v[60:61], v43 offset:16384
    ds_read_b64_tr_b16 v[62:63], v43 offset:17408
    v_mfma_f32_16x16x32_bf16 v[200:203], v[68:71], v[100:103], v[200:203]
    v_mfma_f32_16x16x32_bf16 v[180:183], v[72:75], v[96:99], v[180:183]
    v_mfma_f32_16x16x32_bf16 v[196:199], v[72:75], v[100:103], v[196:199]
    v_mfma_f32_16x16x32_bf16 v[188:191], v[76:79], v[96:99], v[188:191]
    v_mfma_f32_16x16x32_bf16 v[204:207], v[76:79], v[100:103], v[204:207]
    s_waitcnt lgkmcnt(7)
    v_mfma_f32_16x16x32_bf16 v[112:115], v[48:51], v[80:83], v[112:115]
    v_add_u32 v41, 0xc000, v41
    ds_read_b128 v[96:99], v41 offset:0
    ds_read_b128 v[100:103], v41 offset:2048
    s_waitcnt lgkmcnt(8)
    v_mfma_f32_16x16x32_bf16 v[128:131], v[48:51], v[84:87], v[128:131]
    v_add_u32 v44, 0xc000, v44
    ds_read_b64_tr_b16 v[64:65], v44 offset:0
    ds_read_b64_tr_b16 v[66:67], v44 offset:1024
    s_waitcnt lgkmcnt(8)
    v_mfma_f32_16x16x32_bf16 v[120:123], v[52:55], v[80:83], v[120:123]
    ds_read_b64_tr_b16 v[68:69], v44 offset:16384
    ds_read_b64_tr_b16 v[70:71], v44 offset:17408
    v_mfma_f32_16x16x32_bf16 v[136:139], v[52:55], v[84:87], v[136:139]
    v_add_u32 v45, 0xc000, v45
    ds_read_b64_tr_b16 v[72:73], v45 offset:0
    ds_read_b64_tr_b16 v[74:75], v45 offset:1024
    s_waitcnt lgkmcnt(10)
    v_mfma_f32_16x16x32_bf16 v[116:119], v[56:59], v[80:83], v[116:119]
    ds_read_b64_tr_b16 v[76:77], v45 offset:16384
    ds_read_b64_tr_b16 v[78:79], v45 offset:17408
    v_mfma_f32_16x16x32_bf16 v[132:135], v[56:59], v[84:87], v[132:135]
    v_add_u32 v46, 0xc000, v46
    ds_read_b64_tr_b16 v[48:49], v46 offset:0
    ds_read_b64_tr_b16 v[50:51], v46 offset:1024
    s_waitcnt lgkmcnt(12)
    v_mfma_f32_16x16x32_bf16 v[124:127], v[60:63], v[80:83], v[124:127]
    ds_read_b64_tr_b16 v[52:53], v46 offset:16384
    ds_read_b64_tr_b16 v[54:55], v46 offset:17408
    v_mfma_f32_16x16x32_bf16 v[140:143], v[60:63], v[84:87], v[140:143]
    s_waitcnt lgkmcnt(10)
    v_mfma_f32_16x16x32_bf16 v[144:147], v[64:67], v[80:83], v[144:147]
    v_add_u32 v47, 0xc000, v47
    ds_read_b64_tr_b16 v[56:57], v47 offset:0
    ds_read_b64_tr_b16 v[58:59], v47 offset:1024
    v_mfma_f32_16x16x32_bf16 v[160:163], v[64:67], v[84:87], v[160:163]
    ds_read_b64_tr_b16 v[60:61], v47 offset:16384
    ds_read_b64_tr_b16 v[62:63], v47 offset:17408
    s_waitcnt lgkmcnt(12)
    v_mfma_f32_16x16x32_bf16 v[152:155], v[68:71], v[80:83], v[152:155]
    ds_read_b64_tr_b16 v[64:65], v42 offset:8192
    ds_read_b64_tr_b16 v[66:67], v42 offset:9216
    v_mfma_f32_16x16x32_bf16 v[168:171], v[68:71], v[84:87], v[168:171]
    s_waitcnt lgkmcnt(12)
    v_mfma_f32_16x16x32_bf16 v[148:151], v[72:75], v[80:83], v[148:151]
    ds_read_b64_tr_b16 v[68:69], v42 offset:24576
    ds_read_b64_tr_b16 v[70:71], v42 offset:25600
    v_mfma_f32_16x16x32_bf16 v[164:167], v[72:75], v[84:87], v[164:167]
    s_waitcnt lgkmcnt(12)
    v_mfma_f32_16x16x32_bf16 v[156:159], v[76:79], v[80:83], v[156:159]
    ds_read_b64_tr_b16 v[72:73], v43 offset:8192
    ds_read_b64_tr_b16 v[74:75], v43 offset:9216
    v_mfma_f32_16x16x32_bf16 v[172:175], v[76:79], v[84:87], v[172:175]
    s_waitcnt lgkmcnt(12)
    v_mfma_f32_16x16x32_bf16 v[176:179], v[48:51], v[80:83], v[176:179]
    ds_read_b64_tr_b16 v[76:77], v43 offset:24576
    ds_read_b64_tr_b16 v[78:79], v43 offset:25600
    v_mfma_f32_16x16x32_bf16 v[192:195], v[48:51], v[84:87], v[192:195]
    s_waitcnt lgkmcnt(12)
    v_mfma_f32_16x16x32_bf16 v[184:187], v[52:55], v[80:83], v[184:187]
    ds_read_b64_tr_b16 v[48:49], v44 offset:8192
    ds_read_b64_tr_b16 v[50:51], v44 offset:9216
    v_mfma_f32_16x16x32_bf16 v[200:203], v[52:55], v[84:87], v[200:203]
    s_waitcnt lgkmcnt(12)
    v_mfma_f32_16x16x32_bf16 v[180:183], v[56:59], v[80:83], v[180:183]
    ds_read_b64_tr_b16 v[52:53], v44 offset:24576
    ds_read_b64_tr_b16 v[54:55], v44 offset:25600
    v_mfma_f32_16x16x32_bf16 v[196:199], v[56:59], v[84:87], v[196:199]
    s_waitcnt lgkmcnt(12)
    v_mfma_f32_16x16x32_bf16 v[188:191], v[60:63], v[80:83], v[188:191]
    ds_read_b64_tr_b16 v[56:57], v45 offset:8192
    ds_read_b64_tr_b16 v[58:59], v45 offset:9216
    v_mfma_f32_16x16x32_bf16 v[204:207], v[60:63], v[84:87], v[204:207]
    s_waitcnt lgkmcnt(12)
    v_mfma_f32_16x16x32_bf16 v[112:115], v[64:67], v[96:99], v[112:115]
    ds_read_b64_tr_b16 v[60:61], v45 offset:24576
    ds_read_b64_tr_b16 v[62:63], v45 offset:25600
    v_mfma_f32_16x16x32_bf16 v[128:131], v[64:67], v[100:103], v[128:131]
    s_waitcnt lgkmcnt(12)
    v_mfma_f32_16x16x32_bf16 v[120:123], v[68:71], v[96:99], v[120:123]
    ds_read_b64_tr_b16 v[64:65], v46 offset:8192
    ds_read_b64_tr_b16 v[66:67], v46 offset:9216
    v_mfma_f32_16x16x32_bf16 v[136:139], v[68:71], v[100:103], v[136:139]
    s_waitcnt lgkmcnt(12)
    v_mfma_f32_16x16x32_bf16 v[116:119], v[72:75], v[96:99], v[116:119]
    ds_read_b64_tr_b16 v[68:69], v46 offset:24576
    ds_read_b64_tr_b16 v[70:71], v46 offset:25600
    v_mfma_f32_16x16x32_bf16 v[132:135], v[72:75], v[100:103], v[132:135]
    s_waitcnt lgkmcnt(12)
    v_mfma_f32_16x16x32_bf16 v[124:127], v[76:79], v[96:99], v[124:127]
    ds_read_b64_tr_b16 v[72:73], v47 offset:8192
    ds_read_b64_tr_b16 v[74:75], v47 offset:9216
    v_mfma_f32_16x16x32_bf16 v[140:143], v[76:79], v[100:103], v[140:143]
    s_waitcnt lgkmcnt(12)
    v_mfma_f32_16x16x32_bf16 v[144:147], v[48:51], v[96:99], v[144:147]
    ds_read_b64_tr_b16 v[76:77], v47 offset:24576
    ds_read_b64_tr_b16 v[78:79], v47 offset:25600
    v_mfma_f32_16x16x32_bf16 v[160:163], v[48:51], v[100:103], v[160:163]
    s_waitcnt lgkmcnt(12)
    v_mfma_f32_16x16x32_bf16 v[152:155], v[52:55], v[96:99], v[152:155]
    v_mfma_f32_16x16x32_bf16 v[168:171], v[52:55], v[100:103], v[168:171]
    s_waitcnt lgkmcnt(10)
    v_mfma_f32_16x16x32_bf16 v[148:151], v[56:59], v[96:99], v[148:151]
    v_mfma_f32_16x16x32_bf16 v[164:167], v[56:59], v[100:103], v[164:167]
    s_waitcnt lgkmcnt(0)
    s_barrier
    v_mfma_f32_16x16x32_bf16 v[156:159], v[60:63], v[96:99], v[156:159]
    v_add_u32 v40, 0xc000, v40
    ds_read_b128 v[80:83], v40 offset:0
    v_add_u32 v42, 0xc000, v42
    ds_read_b64_tr_b16 v[48:49], v42 offset:0
    v_mfma_f32_16x16x32_bf16 v[172:175], v[60:63], v[100:103], v[172:175]
    ds_read_b64_tr_b16 v[50:51], v42 offset:1024
    ds_read_b128 v[84:87], v40 offset:2048
    v_mfma_f32_16x16x32_bf16 v[176:179], v[64:67], v[96:99], v[176:179]
    ds_read_b64_tr_b16 v[52:53], v42 offset:16384
    ds_read_b64_tr_b16 v[54:55], v42 offset:17408
    v_mfma_f32_16x16x32_bf16 v[192:195], v[64:67], v[100:103], v[192:195]
    v_add_u32 v43, 0xc000, v43
    ds_read_b64_tr_b16 v[56:57], v43 offset:0
    ds_read_b64_tr_b16 v[58:59], v43 offset:1024
    v_mfma_f32_16x16x32_bf16 v[184:187], v[68:71], v[96:99], v[184:187]
    ds_read_b64_tr_b16 v[60:61], v43 offset:16384
    ds_read_b64_tr_b16 v[62:63], v43 offset:17408
    v_mfma_f32_16x16x32_bf16 v[200:203], v[68:71], v[100:103], v[200:203]
    v_mfma_f32_16x16x32_bf16 v[180:183], v[72:75], v[96:99], v[180:183]
    v_mfma_f32_16x16x32_bf16 v[196:199], v[72:75], v[100:103], v[196:199]
    v_mfma_f32_16x16x32_bf16 v[188:191], v[76:79], v[96:99], v[188:191]
    v_mfma_f32_16x16x32_bf16 v[204:207], v[76:79], v[100:103], v[204:207]
    s_waitcnt lgkmcnt(7)
    v_mfma_f32_16x16x32_bf16 v[112:115], v[48:51], v[80:83], v[112:115]
    v_add_u32 v41, 0xc000, v41
    ds_read_b128 v[96:99], v41 offset:0
    ds_read_b128 v[100:103], v41 offset:2048
    s_waitcnt lgkmcnt(8)
    v_mfma_f32_16x16x32_bf16 v[128:131], v[48:51], v[84:87], v[128:131]
    v_add_u32 v44, 0xc000, v44
    ds_read_b64_tr_b16 v[64:65], v44 offset:0
    ds_read_b64_tr_b16 v[66:67], v44 offset:1024
    s_waitcnt lgkmcnt(8)
    v_mfma_f32_16x16x32_bf16 v[120:123], v[52:55], v[80:83], v[120:123]
    ds_read_b64_tr_b16 v[68:69], v44 offset:16384
    ds_read_b64_tr_b16 v[70:71], v44 offset:17408
    v_mfma_f32_16x16x32_bf16 v[136:139], v[52:55], v[84:87], v[136:139]
    v_add_u32 v45, 0xc000, v45
    ds_read_b64_tr_b16 v[72:73], v45 offset:0
    ds_read_b64_tr_b16 v[74:75], v45 offset:1024
    s_waitcnt lgkmcnt(10)
    v_mfma_f32_16x16x32_bf16 v[116:119], v[56:59], v[80:83], v[116:119]
    ds_read_b64_tr_b16 v[76:77], v45 offset:16384
    ds_read_b64_tr_b16 v[78:79], v45 offset:17408
    v_mfma_f32_16x16x32_bf16 v[132:135], v[56:59], v[84:87], v[132:135]
    v_add_u32 v46, 0xc000, v46
    ds_read_b64_tr_b16 v[48:49], v46 offset:0
    ds_read_b64_tr_b16 v[50:51], v46 offset:1024
    s_waitcnt lgkmcnt(12)
    v_mfma_f32_16x16x32_bf16 v[124:127], v[60:63], v[80:83], v[124:127]
    ds_read_b64_tr_b16 v[52:53], v46 offset:16384
    ds_read_b64_tr_b16 v[54:55], v46 offset:17408
    v_mfma_f32_16x16x32_bf16 v[140:143], v[60:63], v[84:87], v[140:143]
    s_waitcnt lgkmcnt(10)
    v_mfma_f32_16x16x32_bf16 v[144:147], v[64:67], v[80:83], v[144:147]
    v_add_u32 v47, 0xc000, v47
    ds_read_b64_tr_b16 v[56:57], v47 offset:0
    ds_read_b64_tr_b16 v[58:59], v47 offset:1024
    v_mfma_f32_16x16x32_bf16 v[160:163], v[64:67], v[84:87], v[160:163]
    ds_read_b64_tr_b16 v[60:61], v47 offset:16384
    ds_read_b64_tr_b16 v[62:63], v47 offset:17408
    s_waitcnt lgkmcnt(12)
    v_mfma_f32_16x16x32_bf16 v[152:155], v[68:71], v[80:83], v[152:155]
    ds_read_b64_tr_b16 v[64:65], v42 offset:8192
    ds_read_b64_tr_b16 v[66:67], v42 offset:9216
    v_mfma_f32_16x16x32_bf16 v[168:171], v[68:71], v[84:87], v[168:171]
    s_waitcnt lgkmcnt(12)
    v_mfma_f32_16x16x32_bf16 v[148:151], v[72:75], v[80:83], v[148:151]
    ds_read_b64_tr_b16 v[68:69], v42 offset:24576
    ds_read_b64_tr_b16 v[70:71], v42 offset:25600
    v_mfma_f32_16x16x32_bf16 v[164:167], v[72:75], v[84:87], v[164:167]
    s_waitcnt lgkmcnt(12)
    v_mfma_f32_16x16x32_bf16 v[156:159], v[76:79], v[80:83], v[156:159]
    ds_read_b64_tr_b16 v[72:73], v43 offset:8192
    ds_read_b64_tr_b16 v[74:75], v43 offset:9216
    v_mfma_f32_16x16x32_bf16 v[172:175], v[76:79], v[84:87], v[172:175]
    s_waitcnt lgkmcnt(12)
    v_mfma_f32_16x16x32_bf16 v[176:179], v[48:51], v[80:83], v[176:179]
    ds_read_b64_tr_b16 v[76:77], v43 offset:24576
    ds_read_b64_tr_b16 v[78:79], v43 offset:25600
    v_mfma_f32_16x16x32_bf16 v[192:195], v[48:51], v[84:87], v[192:195]
    s_waitcnt lgkmcnt(12)
    v_mfma_f32_16x16x32_bf16 v[184:187], v[52:55], v[80:83], v[184:187]
    ds_read_b64_tr_b16 v[48:49], v44 offset:8192
    ds_read_b64_tr_b16 v[50:51], v44 offset:9216
    v_mfma_f32_16x16x32_bf16 v[200:203], v[52:55], v[84:87], v[200:203]
    s_waitcnt lgkmcnt(12)
    v_mfma_f32_16x16x32_bf16 v[180:183], v[56:59], v[80:83], v[180:183]
    ds_read_b64_tr_b16 v[52:53], v44 offset:24576
    ds_read_b64_tr_b16 v[54:55], v44 offset:25600
    v_mfma_f32_16x16x32_bf16 v[196:199], v[56:59], v[84:87], v[196:199]
    s_waitcnt lgkmcnt(12)
    v_mfma_f32_16x16x32_bf16 v[188:191], v[60:63], v[80:83], v[188:191]
    ds_read_b64_tr_b16 v[56:57], v45 offset:8192
    ds_read_b64_tr_b16 v[58:59], v45 offset:9216
    v_mfma_f32_16x16x32_bf16 v[204:207], v[60:63], v[84:87], v[204:207]
    s_waitcnt lgkmcnt(12)
    v_mfma_f32_16x16x32_bf16 v[112:115], v[64:67], v[96:99], v[112:115]
    ds_read_b64_tr_b16 v[60:61], v45 offset:24576
    ds_read_b64_tr_b16 v[62:63], v45 offset:25600
    v_mfma_f32_16x16x32_bf16 v[128:131], v[64:67], v[100:103], v[128:131]
    s_waitcnt lgkmcnt(12)
    v_mfma_f32_16x16x32_bf16 v[120:123], v[68:71], v[96:99], v[120:123]
    ds_read_b64_tr_b16 v[64:65], v46 offset:8192
    ds_read_b64_tr_b16 v[66:67], v46 offset:9216
    v_mfma_f32_16x16x32_bf16 v[136:139], v[68:71], v[100:103], v[136:139]
    s_waitcnt lgkmcnt(12)
    v_mfma_f32_16x16x32_bf16 v[116:119], v[72:75], v[96:99], v[116:119]
    ds_read_b64_tr_b16 v[68:69], v46 offset:24576
    ds_read_b64_tr_b16 v[70:71], v46 offset:25600
    v_mfma_f32_16x16x32_bf16 v[132:135], v[72:75], v[100:103], v[132:135]
    s_waitcnt lgkmcnt(12)
    v_mfma_f32_16x16x32_bf16 v[124:127], v[76:79], v[96:99], v[124:127]
    ds_read_b64_tr_b16 v[72:73], v47 offset:8192
    ds_read_b64_tr_b16 v[74:75], v47 offset:9216
    v_mfma_f32_16x16x32_bf16 v[140:143], v[76:79], v[100:103], v[140:143]
    s_waitcnt lgkmcnt(12)
    v_mfma_f32_16x16x32_bf16 v[144:147], v[48:51], v[96:99], v[144:147]
    ds_read_b64_tr_b16 v[76:77], v47 offset:24576
    ds_read_b64_tr_b16 v[78:79], v47 offset:25600
    v_mfma_f32_16x16x32_bf16 v[160:163], v[48:51], v[100:103], v[160:163]
    s_waitcnt lgkmcnt(12)
    v_mfma_f32_16x16x32_bf16 v[152:155], v[52:55], v[96:99], v[152:155]
    v_mfma_f32_16x16x32_bf16 v[168:171], v[52:55], v[100:103], v[168:171]
    s_waitcnt lgkmcnt(10)
    v_mfma_f32_16x16x32_bf16 v[148:151], v[56:59], v[96:99], v[148:151]
    v_mfma_f32_16x16x32_bf16 v[164:167], v[56:59], v[100:103], v[164:167]
    s_waitcnt lgkmcnt(0)
    s_barrier
    v_mfma_f32_16x16x32_bf16 v[156:159], v[60:63], v[96:99], v[156:159]
    v_add_u32 v40, 0xfffe8000, v40
    ds_read_b128 v[80:83], v40 offset:0
    v_add_u32 v42, 0xfffe8000, v42
    ds_read_b64_tr_b16 v[48:49], v42 offset:0
    v_mfma_f32_16x16x32_bf16 v[172:175], v[60:63], v[100:103], v[172:175]
    ds_read_b64_tr_b16 v[50:51], v42 offset:1024
    ds_read_b128 v[84:87], v40 offset:2048
    v_mfma_f32_16x16x32_bf16 v[176:179], v[64:67], v[96:99], v[176:179]
    ds_read_b64_tr_b16 v[52:53], v42 offset:16384
    ds_read_b64_tr_b16 v[54:55], v42 offset:17408
    v_mfma_f32_16x16x32_bf16 v[192:195], v[64:67], v[100:103], v[192:195]
    v_add_u32 v43, 0xfffe8000, v43
    ds_read_b64_tr_b16 v[56:57], v43 offset:0
    ds_read_b64_tr_b16 v[58:59], v43 offset:1024
    v_mfma_f32_16x16x32_bf16 v[184:187], v[68:71], v[96:99], v[184:187]
    ds_read_b64_tr_b16 v[60:61], v43 offset:16384
    ds_read_b64_tr_b16 v[62:63], v43 offset:17408
    v_mfma_f32_16x16x32_bf16 v[200:203], v[68:71], v[100:103], v[200:203]
    v_mfma_f32_16x16x32_bf16 v[180:183], v[72:75], v[96:99], v[180:183]
    v_mfma_f32_16x16x32_bf16 v[196:199], v[72:75], v[100:103], v[196:199]
    v_mfma_f32_16x16x32_bf16 v[188:191], v[76:79], v[96:99], v[188:191]
    v_mfma_f32_16x16x32_bf16 v[204:207], v[76:79], v[100:103], v[204:207]
    s_waitcnt lgkmcnt(7)
    v_mfma_f32_16x16x32_bf16 v[112:115], v[48:51], v[80:83], v[112:115]
    v_add_u32 v41, 0xfffe8000, v41
    ds_read_b128 v[96:99], v41 offset:0
    ds_read_b128 v[100:103], v41 offset:2048
    s_waitcnt lgkmcnt(8)
    v_mfma_f32_16x16x32_bf16 v[128:131], v[48:51], v[84:87], v[128:131]
    v_add_u32 v44, 0xfffe8000, v44
    ds_read_b64_tr_b16 v[64:65], v44 offset:0
    ds_read_b64_tr_b16 v[66:67], v44 offset:1024
    s_waitcnt lgkmcnt(8)
    v_mfma_f32_16x16x32_bf16 v[120:123], v[52:55], v[80:83], v[120:123]
    ds_read_b64_tr_b16 v[68:69], v44 offset:16384
    ds_read_b64_tr_b16 v[70:71], v44 offset:17408
    v_mfma_f32_16x16x32_bf16 v[136:139], v[52:55], v[84:87], v[136:139]
    v_add_u32 v45, 0xfffe8000, v45
    ds_read_b64_tr_b16 v[72:73], v45 offset:0
    ds_read_b64_tr_b16 v[74:75], v45 offset:1024
    s_waitcnt lgkmcnt(10)
    v_mfma_f32_16x16x32_bf16 v[116:119], v[56:59], v[80:83], v[116:119]
    ds_read_b64_tr_b16 v[76:77], v45 offset:16384
    ds_read_b64_tr_b16 v[78:79], v45 offset:17408
    v_mfma_f32_16x16x32_bf16 v[132:135], v[56:59], v[84:87], v[132:135]
    v_add_u32 v46, 0xfffe8000, v46
    ds_read_b64_tr_b16 v[48:49], v46 offset:0
    ds_read_b64_tr_b16 v[50:51], v46 offset:1024
    s_waitcnt lgkmcnt(12)
    v_mfma_f32_16x16x32_bf16 v[124:127], v[60:63], v[80:83], v[124:127]
    ds_read_b64_tr_b16 v[52:53], v46 offset:16384
    ds_read_b64_tr_b16 v[54:55], v46 offset:17408
    v_mfma_f32_16x16x32_bf16 v[140:143], v[60:63], v[84:87], v[140:143]
    s_waitcnt lgkmcnt(10)
    v_mfma_f32_16x16x32_bf16 v[144:147], v[64:67], v[80:83], v[144:147]
    v_add_u32 v47, 0xfffe8000, v47
    ds_read_b64_tr_b16 v[56:57], v47 offset:0
    ds_read_b64_tr_b16 v[58:59], v47 offset:1024
    v_mfma_f32_16x16x32_bf16 v[160:163], v[64:67], v[84:87], v[160:163]
    ds_read_b64_tr_b16 v[60:61], v47 offset:16384
    ds_read_b64_tr_b16 v[62:63], v47 offset:17408
    s_waitcnt lgkmcnt(12)
    v_mfma_f32_16x16x32_bf16 v[152:155], v[68:71], v[80:83], v[152:155]
    ds_read_b64_tr_b16 v[64:65], v42 offset:8192
    ds_read_b64_tr_b16 v[66:67], v42 offset:9216
    v_mfma_f32_16x16x32_bf16 v[168:171], v[68:71], v[84:87], v[168:171]
    s_waitcnt lgkmcnt(12)
    v_mfma_f32_16x16x32_bf16 v[148:151], v[72:75], v[80:83], v[148:151]
    ds_read_b64_tr_b16 v[68:69], v42 offset:24576
    ds_read_b64_tr_b16 v[70:71], v42 offset:25600
    v_mfma_f32_16x16x32_bf16 v[164:167], v[72:75], v[84:87], v[164:167]
    s_waitcnt lgkmcnt(12)
    v_mfma_f32_16x16x32_bf16 v[156:159], v[76:79], v[80:83], v[156:159]
    ds_read_b64_tr_b16 v[72:73], v43 offset:8192
    ds_read_b64_tr_b16 v[74:75], v43 offset:9216
    v_mfma_f32_16x16x32_bf16 v[172:175], v[76:79], v[84:87], v[172:175]
    s_waitcnt lgkmcnt(12)
    v_mfma_f32_16x16x32_bf16 v[176:179], v[48:51], v[80:83], v[176:179]
    ds_read_b64_tr_b16 v[76:77], v43 offset:24576
    ds_read_b64_tr_b16 v[78:79], v43 offset:25600
    v_mfma_f32_16x16x32_bf16 v[192:195], v[48:51], v[84:87], v[192:195]
    s_waitcnt lgkmcnt(12)
    v_mfma_f32_16x16x32_bf16 v[184:187], v[52:55], v[80:83], v[184:187]
    ds_read_b64_tr_b16 v[48:49], v44 offset:8192
    ds_read_b64_tr_b16 v[50:51], v44 offset:9216
    v_mfma_f32_16x16x32_bf16 v[200:203], v[52:55], v[84:87], v[200:203]
    s_waitcnt lgkmcnt(12)
    v_mfma_f32_16x16x32_bf16 v[180:183], v[56:59], v[80:83], v[180:183]
    ds_read_b64_tr_b16 v[52:53], v44 offset:24576
    ds_read_b64_tr_b16 v[54:55], v44 offset:25600
    v_mfma_f32_16x16x32_bf16 v[196:199], v[56:59], v[84:87], v[196:199]
    s_waitcnt lgkmcnt(12)
    v_mfma_f32_16x16x32_bf16 v[188:191], v[60:63], v[80:83], v[188:191]
    ds_read_b64_tr_b16 v[56:57], v45 offset:8192
    ds_read_b64_tr_b16 v[58:59], v45 offset:9216
    v_mfma_f32_16x16x32_bf16 v[204:207], v[60:63], v[84:87], v[204:207]
    s_waitcnt lgkmcnt(12)
    v_mfma_f32_16x16x32_bf16 v[112:115], v[64:67], v[96:99], v[112:115]
    ds_read_b64_tr_b16 v[60:61], v45 offset:24576
    ds_read_b64_tr_b16 v[62:63], v45 offset:25600
    v_mfma_f32_16x16x32_bf16 v[128:131], v[64:67], v[100:103], v[128:131]
    s_waitcnt lgkmcnt(12)
    v_mfma_f32_16x16x32_bf16 v[120:123], v[68:71], v[96:99], v[120:123]
    ds_read_b64_tr_b16 v[64:65], v46 offset:8192
    ds_read_b64_tr_b16 v[66:67], v46 offset:9216
    v_mfma_f32_16x16x32_bf16 v[136:139], v[68:71], v[100:103], v[136:139]
    s_waitcnt lgkmcnt(12)
    v_mfma_f32_16x16x32_bf16 v[116:119], v[72:75], v[96:99], v[116:119]
    ds_read_b64_tr_b16 v[68:69], v46 offset:24576
    ds_read_b64_tr_b16 v[70:71], v46 offset:25600
    v_mfma_f32_16x16x32_bf16 v[132:135], v[72:75], v[100:103], v[132:135]
    s_waitcnt lgkmcnt(12)
    v_mfma_f32_16x16x32_bf16 v[124:127], v[76:79], v[96:99], v[124:127]
    ds_read_b64_tr_b16 v[72:73], v47 offset:8192
    ds_read_b64_tr_b16 v[74:75], v47 offset:9216
    v_mfma_f32_16x16x32_bf16 v[140:143], v[76:79], v[100:103], v[140:143]
    s_waitcnt lgkmcnt(12)
    v_mfma_f32_16x16x32_bf16 v[144:147], v[48:51], v[96:99], v[144:147]
    ds_read_b64_tr_b16 v[76:77], v47 offset:24576
    ds_read_b64_tr_b16 v[78:79], v47 offset:25600
    v_mfma_f32_16x16x32_bf16 v[160:163], v[48:51], v[100:103], v[160:163]
    s_waitcnt lgkmcnt(12)
    v_mfma_f32_16x16x32_bf16 v[152:155], v[52:55], v[96:99], v[152:155]
    v_mfma_f32_16x16x32_bf16 v[168:171], v[52:55], v[100:103], v[168:171]
    s_waitcnt lgkmcnt(10)
    v_mfma_f32_16x16x32_bf16 v[148:151], v[56:59], v[96:99], v[148:151]
    v_mfma_f32_16x16x32_bf16 v[164:167], v[56:59], v[100:103], v[164:167]
    s_waitcnt lgkmcnt(0) vmcnt(0)
    s_barrier
    v_mfma_f32_16x16x32_bf16 v[156:159], v[60:63], v[96:99], v[156:159]
    v_add_u32 v40, 0xc000, v40
    ds_read_b128 v[80:83], v40 offset:0
    v_add_u32 v42, 0xc000, v42
    ds_read_b64_tr_b16 v[48:49], v42 offset:0
    v_mfma_f32_16x16x32_bf16 v[172:175], v[60:63], v[100:103], v[172:175]
    ds_read_b64_tr_b16 v[50:51], v42 offset:1024
    ds_read_b128 v[84:87], v40 offset:2048
    v_mfma_f32_16x16x32_bf16 v[176:179], v[64:67], v[96:99], v[176:179]
    ds_read_b64_tr_b16 v[52:53], v42 offset:16384
    ds_read_b64_tr_b16 v[54:55], v42 offset:17408
    v_mfma_f32_16x16x32_bf16 v[192:195], v[64:67], v[100:103], v[192:195]
    v_add_u32 v43, 0xc000, v43
    ds_read_b64_tr_b16 v[56:57], v43 offset:0
    ds_read_b64_tr_b16 v[58:59], v43 offset:1024
    v_mfma_f32_16x16x32_bf16 v[184:187], v[68:71], v[96:99], v[184:187]
    ds_read_b64_tr_b16 v[60:61], v43 offset:16384
    ds_read_b64_tr_b16 v[62:63], v43 offset:17408
    v_mfma_f32_16x16x32_bf16 v[200:203], v[68:71], v[100:103], v[200:203]
    v_mfma_f32_16x16x32_bf16 v[180:183], v[72:75], v[96:99], v[180:183]
    v_mfma_f32_16x16x32_bf16 v[196:199], v[72:75], v[100:103], v[196:199]
    v_mfma_f32_16x16x32_bf16 v[188:191], v[76:79], v[96:99], v[188:191]
    v_mfma_f32_16x16x32_bf16 v[204:207], v[76:79], v[100:103], v[204:207]
    s_waitcnt lgkmcnt(7)
    v_mfma_f32_16x16x32_bf16 v[112:115], v[48:51], v[80:83], v[112:115]
    v_add_u32 v41, 0xc000, v41
    ds_read_b128 v[96:99], v41 offset:0
    ds_read_b128 v[100:103], v41 offset:2048
    s_waitcnt lgkmcnt(8)
    v_mfma_f32_16x16x32_bf16 v[128:131], v[48:51], v[84:87], v[128:131]
    v_add_u32 v44, 0xc000, v44
    ds_read_b64_tr_b16 v[64:65], v44 offset:0
    ds_read_b64_tr_b16 v[66:67], v44 offset:1024
    s_waitcnt lgkmcnt(8)
    v_mfma_f32_16x16x32_bf16 v[120:123], v[52:55], v[80:83], v[120:123]
    ds_read_b64_tr_b16 v[68:69], v44 offset:16384
    ds_read_b64_tr_b16 v[70:71], v44 offset:17408
    v_mfma_f32_16x16x32_bf16 v[136:139], v[52:55], v[84:87], v[136:139]
    v_add_u32 v45, 0xc000, v45
    ds_read_b64_tr_b16 v[72:73], v45 offset:0
    ds_read_b64_tr_b16 v[74:75], v45 offset:1024
    s_waitcnt lgkmcnt(10)
    v_mfma_f32_16x16x32_bf16 v[116:119], v[56:59], v[80:83], v[116:119]
    ds_read_b64_tr_b16 v[76:77], v45 offset:16384
    ds_read_b64_tr_b16 v[78:79], v45 offset:17408
    v_mfma_f32_16x16x32_bf16 v[132:135], v[56:59], v[84:87], v[132:135]
    v_add_u32 v46, 0xc000, v46
    ds_read_b64_tr_b16 v[48:49], v46 offset:0
    ds_read_b64_tr_b16 v[50:51], v46 offset:1024
    s_waitcnt lgkmcnt(12)
    v_mfma_f32_16x16x32_bf16 v[124:127], v[60:63], v[80:83], v[124:127]
    ds_read_b64_tr_b16 v[52:53], v46 offset:16384
    ds_read_b64_tr_b16 v[54:55], v46 offset:17408
    v_mfma_f32_16x16x32_bf16 v[140:143], v[60:63], v[84:87], v[140:143]
    s_waitcnt lgkmcnt(10)
    v_mfma_f32_16x16x32_bf16 v[144:147], v[64:67], v[80:83], v[144:147]
    v_add_u32 v47, 0xc000, v47
    ds_read_b64_tr_b16 v[56:57], v47 offset:0
    ds_read_b64_tr_b16 v[58:59], v47 offset:1024
    v_mfma_f32_16x16x32_bf16 v[160:163], v[64:67], v[84:87], v[160:163]
    ds_read_b64_tr_b16 v[60:61], v47 offset:16384
    ds_read_b64_tr_b16 v[62:63], v47 offset:17408
    s_waitcnt lgkmcnt(12)
    v_mfma_f32_16x16x32_bf16 v[152:155], v[68:71], v[80:83], v[152:155]
    ds_read_b64_tr_b16 v[64:65], v42 offset:8192
    ds_read_b64_tr_b16 v[66:67], v42 offset:9216
    v_mfma_f32_16x16x32_bf16 v[168:171], v[68:71], v[84:87], v[168:171]
    s_waitcnt lgkmcnt(12)
    v_mfma_f32_16x16x32_bf16 v[148:151], v[72:75], v[80:83], v[148:151]
    ds_read_b64_tr_b16 v[68:69], v42 offset:24576
    ds_read_b64_tr_b16 v[70:71], v42 offset:25600
    v_mfma_f32_16x16x32_bf16 v[164:167], v[72:75], v[84:87], v[164:167]
    s_waitcnt lgkmcnt(12)
    v_mfma_f32_16x16x32_bf16 v[156:159], v[76:79], v[80:83], v[156:159]
    ds_read_b64_tr_b16 v[72:73], v43 offset:8192
    ds_read_b64_tr_b16 v[74:75], v43 offset:9216
    v_mfma_f32_16x16x32_bf16 v[172:175], v[76:79], v[84:87], v[172:175]
    s_waitcnt lgkmcnt(12)
    v_mfma_f32_16x16x32_bf16 v[176:179], v[48:51], v[80:83], v[176:179]
    ds_read_b64_tr_b16 v[76:77], v43 offset:24576
    ds_read_b64_tr_b16 v[78:79], v43 offset:25600
    v_mfma_f32_16x16x32_bf16 v[192:195], v[48:51], v[84:87], v[192:195]
    s_waitcnt lgkmcnt(12)
    v_mfma_f32_16x16x32_bf16 v[184:187], v[52:55], v[80:83], v[184:187]
    ds_read_b64_tr_b16 v[48:49], v44 offset:8192
    ds_read_b64_tr_b16 v[50:51], v44 offset:9216
    v_mfma_f32_16x16x32_bf16 v[200:203], v[52:55], v[84:87], v[200:203]
    s_waitcnt lgkmcnt(12)
    v_mfma_f32_16x16x32_bf16 v[180:183], v[56:59], v[80:83], v[180:183]
    ds_read_b64_tr_b16 v[52:53], v44 offset:24576
    ds_read_b64_tr_b16 v[54:55], v44 offset:25600
    v_mfma_f32_16x16x32_bf16 v[196:199], v[56:59], v[84:87], v[196:199]
    s_waitcnt lgkmcnt(12)
    v_mfma_f32_16x16x32_bf16 v[188:191], v[60:63], v[80:83], v[188:191]
    ds_read_b64_tr_b16 v[56:57], v45 offset:8192
    ds_read_b64_tr_b16 v[58:59], v45 offset:9216
    v_mfma_f32_16x16x32_bf16 v[204:207], v[60:63], v[84:87], v[204:207]
    s_waitcnt lgkmcnt(12)
    v_mfma_f32_16x16x32_bf16 v[112:115], v[64:67], v[96:99], v[112:115]
    ds_read_b64_tr_b16 v[60:61], v45 offset:24576
    ds_read_b64_tr_b16 v[62:63], v45 offset:25600
    v_mfma_f32_16x16x32_bf16 v[128:131], v[64:67], v[100:103], v[128:131]
    s_waitcnt lgkmcnt(12)
    v_mfma_f32_16x16x32_bf16 v[120:123], v[68:71], v[96:99], v[120:123]
    ds_read_b64_tr_b16 v[64:65], v46 offset:8192
    ds_read_b64_tr_b16 v[66:67], v46 offset:9216
    v_mfma_f32_16x16x32_bf16 v[136:139], v[68:71], v[100:103], v[136:139]
    s_waitcnt lgkmcnt(12)
    v_mfma_f32_16x16x32_bf16 v[116:119], v[72:75], v[96:99], v[116:119]
    ds_read_b64_tr_b16 v[68:69], v46 offset:24576
    ds_read_b64_tr_b16 v[70:71], v46 offset:25600
    v_mfma_f32_16x16x32_bf16 v[132:135], v[72:75], v[100:103], v[132:135]
    s_waitcnt lgkmcnt(12)
    v_mfma_f32_16x16x32_bf16 v[124:127], v[76:79], v[96:99], v[124:127]
    ds_read_b64_tr_b16 v[72:73], v47 offset:8192
    ds_read_b64_tr_b16 v[74:75], v47 offset:9216
    v_mfma_f32_16x16x32_bf16 v[140:143], v[76:79], v[100:103], v[140:143]
    s_waitcnt lgkmcnt(12)
    v_mfma_f32_16x16x32_bf16 v[144:147], v[48:51], v[96:99], v[144:147]
    ds_read_b64_tr_b16 v[76:77], v47 offset:24576
    ds_read_b64_tr_b16 v[78:79], v47 offset:25600
    v_mfma_f32_16x16x32_bf16 v[160:163], v[48:51], v[100:103], v[160:163]
    s_waitcnt lgkmcnt(12)
    v_mfma_f32_16x16x32_bf16 v[152:155], v[52:55], v[96:99], v[152:155]
    v_mfma_f32_16x16x32_bf16 v[168:171], v[52:55], v[100:103], v[168:171]
    s_waitcnt lgkmcnt(10)
    v_mfma_f32_16x16x32_bf16 v[148:151], v[56:59], v[96:99], v[148:151]
    v_mfma_f32_16x16x32_bf16 v[164:167], v[56:59], v[100:103], v[164:167]
    s_waitcnt lgkmcnt(0)
    s_barrier
    v_mfma_f32_16x16x32_bf16 v[156:159], v[60:63], v[96:99], v[156:159]
    v_add_u32 v40, 0xc000, v40
    ds_read_b128 v[80:83], v40 offset:0
    v_add_u32 v42, 0xc000, v42
    ds_read_b64_tr_b16 v[48:49], v42 offset:0
    v_mfma_f32_16x16x32_bf16 v[172:175], v[60:63], v[100:103], v[172:175]
    ds_read_b64_tr_b16 v[50:51], v42 offset:1024
    ds_read_b128 v[84:87], v40 offset:2048
    v_mfma_f32_16x16x32_bf16 v[176:179], v[64:67], v[96:99], v[176:179]
    ds_read_b64_tr_b16 v[52:53], v42 offset:16384
    ds_read_b64_tr_b16 v[54:55], v42 offset:17408
    v_mfma_f32_16x16x32_bf16 v[192:195], v[64:67], v[100:103], v[192:195]
    v_add_u32 v43, 0xc000, v43
    ds_read_b64_tr_b16 v[56:57], v43 offset:0
    ds_read_b64_tr_b16 v[58:59], v43 offset:1024
    v_mfma_f32_16x16x32_bf16 v[184:187], v[68:71], v[96:99], v[184:187]
    ds_read_b64_tr_b16 v[60:61], v43 offset:16384
    ds_read_b64_tr_b16 v[62:63], v43 offset:17408
    v_mfma_f32_16x16x32_bf16 v[200:203], v[68:71], v[100:103], v[200:203]
    v_mfma_f32_16x16x32_bf16 v[180:183], v[72:75], v[96:99], v[180:183]
    v_mfma_f32_16x16x32_bf16 v[196:199], v[72:75], v[100:103], v[196:199]
    v_mfma_f32_16x16x32_bf16 v[188:191], v[76:79], v[96:99], v[188:191]
    v_mfma_f32_16x16x32_bf16 v[204:207], v[76:79], v[100:103], v[204:207]
    s_waitcnt lgkmcnt(7)
    v_mfma_f32_16x16x32_bf16 v[112:115], v[48:51], v[80:83], v[112:115]
    v_add_u32 v41, 0xc000, v41
    ds_read_b128 v[96:99], v41 offset:0
    ds_read_b128 v[100:103], v41 offset:2048
    s_waitcnt lgkmcnt(8)
    v_mfma_f32_16x16x32_bf16 v[128:131], v[48:51], v[84:87], v[128:131]
    v_add_u32 v44, 0xc000, v44
    ds_read_b64_tr_b16 v[64:65], v44 offset:0
    ds_read_b64_tr_b16 v[66:67], v44 offset:1024
    s_waitcnt lgkmcnt(8)
    v_mfma_f32_16x16x32_bf16 v[120:123], v[52:55], v[80:83], v[120:123]
    ds_read_b64_tr_b16 v[68:69], v44 offset:16384
    ds_read_b64_tr_b16 v[70:71], v44 offset:17408
    v_mfma_f32_16x16x32_bf16 v[136:139], v[52:55], v[84:87], v[136:139]
    v_add_u32 v45, 0xc000, v45
    ds_read_b64_tr_b16 v[72:73], v45 offset:0
    ds_read_b64_tr_b16 v[74:75], v45 offset:1024
    s_waitcnt lgkmcnt(10)
    v_mfma_f32_16x16x32_bf16 v[116:119], v[56:59], v[80:83], v[116:119]
    ds_read_b64_tr_b16 v[76:77], v45 offset:16384
    ds_read_b64_tr_b16 v[78:79], v45 offset:17408
    v_mfma_f32_16x16x32_bf16 v[132:135], v[56:59], v[84:87], v[132:135]
    v_add_u32 v46, 0xc000, v46
    ds_read_b64_tr_b16 v[48:49], v46 offset:0
    ds_read_b64_tr_b16 v[50:51], v46 offset:1024
    s_waitcnt lgkmcnt(12)
    v_mfma_f32_16x16x32_bf16 v[124:127], v[60:63], v[80:83], v[124:127]
    ds_read_b64_tr_b16 v[52:53], v46 offset:16384
    ds_read_b64_tr_b16 v[54:55], v46 offset:17408
    v_mfma_f32_16x16x32_bf16 v[140:143], v[60:63], v[84:87], v[140:143]
    s_waitcnt lgkmcnt(10)
    v_mfma_f32_16x16x32_bf16 v[144:147], v[64:67], v[80:83], v[144:147]
    v_add_u32 v47, 0xc000, v47
    ds_read_b64_tr_b16 v[56:57], v47 offset:0
    ds_read_b64_tr_b16 v[58:59], v47 offset:1024
    v_mfma_f32_16x16x32_bf16 v[160:163], v[64:67], v[84:87], v[160:163]
    ds_read_b64_tr_b16 v[60:61], v47 offset:16384
    ds_read_b64_tr_b16 v[62:63], v47 offset:17408
    s_waitcnt lgkmcnt(12)
    v_mfma_f32_16x16x32_bf16 v[152:155], v[68:71], v[80:83], v[152:155]
    ds_read_b64_tr_b16 v[64:65], v42 offset:8192
    ds_read_b64_tr_b16 v[66:67], v42 offset:9216
    v_mfma_f32_16x16x32_bf16 v[168:171], v[68:71], v[84:87], v[168:171]
    s_waitcnt lgkmcnt(12)
    v_mfma_f32_16x16x32_bf16 v[148:151], v[72:75], v[80:83], v[148:151]
    ds_read_b64_tr_b16 v[68:69], v42 offset:24576
    ds_read_b64_tr_b16 v[70:71], v42 offset:25600
    v_mfma_f32_16x16x32_bf16 v[164:167], v[72:75], v[84:87], v[164:167]
    s_waitcnt lgkmcnt(12)
    v_mfma_f32_16x16x32_bf16 v[156:159], v[76:79], v[80:83], v[156:159]
    ds_read_b64_tr_b16 v[72:73], v43 offset:8192
    ds_read_b64_tr_b16 v[74:75], v43 offset:9216
    v_mfma_f32_16x16x32_bf16 v[172:175], v[76:79], v[84:87], v[172:175]
    s_waitcnt lgkmcnt(12)
    v_mfma_f32_16x16x32_bf16 v[176:179], v[48:51], v[80:83], v[176:179]
    ds_read_b64_tr_b16 v[76:77], v43 offset:24576
    ds_read_b64_tr_b16 v[78:79], v43 offset:25600
    v_mfma_f32_16x16x32_bf16 v[192:195], v[48:51], v[84:87], v[192:195]
    s_waitcnt lgkmcnt(12)
    v_mfma_f32_16x16x32_bf16 v[184:187], v[52:55], v[80:83], v[184:187]
    ds_read_b64_tr_b16 v[48:49], v44 offset:8192
    ds_read_b64_tr_b16 v[50:51], v44 offset:9216
    v_mfma_f32_16x16x32_bf16 v[200:203], v[52:55], v[84:87], v[200:203]
    s_waitcnt lgkmcnt(12)
    v_mfma_f32_16x16x32_bf16 v[180:183], v[56:59], v[80:83], v[180:183]
    ds_read_b64_tr_b16 v[52:53], v44 offset:24576
    ds_read_b64_tr_b16 v[54:55], v44 offset:25600
    v_mfma_f32_16x16x32_bf16 v[196:199], v[56:59], v[84:87], v[196:199]
    s_waitcnt lgkmcnt(12)
    v_mfma_f32_16x16x32_bf16 v[188:191], v[60:63], v[80:83], v[188:191]
    ds_read_b64_tr_b16 v[56:57], v45 offset:8192
    ds_read_b64_tr_b16 v[58:59], v45 offset:9216
    v_mfma_f32_16x16x32_bf16 v[204:207], v[60:63], v[84:87], v[204:207]
    s_waitcnt lgkmcnt(12)
    v_mfma_f32_16x16x32_bf16 v[112:115], v[64:67], v[96:99], v[112:115]
    ds_read_b64_tr_b16 v[60:61], v45 offset:24576
    ds_read_b64_tr_b16 v[62:63], v45 offset:25600
    v_mfma_f32_16x16x32_bf16 v[128:131], v[64:67], v[100:103], v[128:131]
    s_waitcnt lgkmcnt(12)
    v_mfma_f32_16x16x32_bf16 v[120:123], v[68:71], v[96:99], v[120:123]
    ds_read_b64_tr_b16 v[64:65], v46 offset:8192
    ds_read_b64_tr_b16 v[66:67], v46 offset:9216
    v_mfma_f32_16x16x32_bf16 v[136:139], v[68:71], v[100:103], v[136:139]
    s_waitcnt lgkmcnt(12)
    v_mfma_f32_16x16x32_bf16 v[116:119], v[72:75], v[96:99], v[116:119]
    ds_read_b64_tr_b16 v[68:69], v46 offset:24576
    ds_read_b64_tr_b16 v[70:71], v46 offset:25600
    v_mfma_f32_16x16x32_bf16 v[132:135], v[72:75], v[100:103], v[132:135]
    s_waitcnt lgkmcnt(12)
    v_mfma_f32_16x16x32_bf16 v[124:127], v[76:79], v[96:99], v[124:127]
    ds_read_b64_tr_b16 v[72:73], v47 offset:8192
    ds_read_b64_tr_b16 v[74:75], v47 offset:9216
    v_mfma_f32_16x16x32_bf16 v[140:143], v[76:79], v[100:103], v[140:143]
    s_waitcnt lgkmcnt(12)
    v_mfma_f32_16x16x32_bf16 v[144:147], v[48:51], v[96:99], v[144:147]
    ds_read_b64_tr_b16 v[76:77], v47 offset:24576
    ds_read_b64_tr_b16 v[78:79], v47 offset:25600
    v_mfma_f32_16x16x32_bf16 v[160:163], v[48:51], v[100:103], v[160:163]
    s_waitcnt lgkmcnt(12)
    v_mfma_f32_16x16x32_bf16 v[152:155], v[52:55], v[96:99], v[152:155]
    v_mfma_f32_16x16x32_bf16 v[168:171], v[52:55], v[100:103], v[168:171]
    s_waitcnt lgkmcnt(10)
    v_mfma_f32_16x16x32_bf16 v[148:151], v[56:59], v[96:99], v[148:151]
    v_mfma_f32_16x16x32_bf16 v[164:167], v[56:59], v[100:103], v[164:167]
    s_waitcnt lgkmcnt(0)
    s_barrier
    v_mfma_f32_16x16x32_bf16 v[156:159], v[60:63], v[96:99], v[156:159]
    v_add_u32 v40, 0xfffe8000, v40
    ds_read_b128 v[80:83], v40 offset:0
    v_add_u32 v42, 0xfffe8000, v42
    ds_read_b64_tr_b16 v[48:49], v42 offset:0
    v_mfma_f32_16x16x32_bf16 v[172:175], v[60:63], v[100:103], v[172:175]
    ds_read_b64_tr_b16 v[50:51], v42 offset:1024
    ds_read_b128 v[84:87], v40 offset:2048
    v_mfma_f32_16x16x32_bf16 v[176:179], v[64:67], v[96:99], v[176:179]
    ds_read_b64_tr_b16 v[52:53], v42 offset:16384
    ds_read_b64_tr_b16 v[54:55], v42 offset:17408
    v_mfma_f32_16x16x32_bf16 v[192:195], v[64:67], v[100:103], v[192:195]
    v_add_u32 v43, 0xfffe8000, v43
    ds_read_b64_tr_b16 v[56:57], v43 offset:0
    ds_read_b64_tr_b16 v[58:59], v43 offset:1024
    v_mfma_f32_16x16x32_bf16 v[184:187], v[68:71], v[96:99], v[184:187]
    ds_read_b64_tr_b16 v[60:61], v43 offset:16384
    ds_read_b64_tr_b16 v[62:63], v43 offset:17408
    v_mfma_f32_16x16x32_bf16 v[200:203], v[68:71], v[100:103], v[200:203]
    v_mfma_f32_16x16x32_bf16 v[180:183], v[72:75], v[96:99], v[180:183]
    v_mfma_f32_16x16x32_bf16 v[196:199], v[72:75], v[100:103], v[196:199]
    v_mfma_f32_16x16x32_bf16 v[188:191], v[76:79], v[96:99], v[188:191]
    v_mfma_f32_16x16x32_bf16 v[204:207], v[76:79], v[100:103], v[204:207]
    s_waitcnt lgkmcnt(7)
    v_mfma_f32_16x16x32_bf16 v[112:115], v[48:51], v[80:83], v[112:115]
    v_add_u32 v41, 0xfffe8000, v41
    ds_read_b128 v[96:99], v41 offset:0
    ds_read_b128 v[100:103], v41 offset:2048
    s_waitcnt lgkmcnt(8)
    v_mfma_f32_16x16x32_bf16 v[128:131], v[48:51], v[84:87], v[128:131]
    v_add_u32 v44, 0xfffe8000, v44
    ds_read_b64_tr_b16 v[64:65], v44 offset:0
    ds_read_b64_tr_b16 v[66:67], v44 offset:1024
    s_waitcnt lgkmcnt(8)
    v_mfma_f32_16x16x32_bf16 v[120:123], v[52:55], v[80:83], v[120:123]
    ds_read_b64_tr_b16 v[68:69], v44 offset:16384
    ds_read_b64_tr_b16 v[70:71], v44 offset:17408
    v_mfma_f32_16x16x32_bf16 v[136:139], v[52:55], v[84:87], v[136:139]
    v_add_u32 v45, 0xfffe8000, v45
    ds_read_b64_tr_b16 v[72:73], v45 offset:0
    ds_read_b64_tr_b16 v[74:75], v45 offset:1024
    s_waitcnt lgkmcnt(10)
    v_mfma_f32_16x16x32_bf16 v[116:119], v[56:59], v[80:83], v[116:119]
    ds_read_b64_tr_b16 v[76:77], v45 offset:16384
    ds_read_b64_tr_b16 v[78:79], v45 offset:17408
    v_mfma_f32_16x16x32_bf16 v[132:135], v[56:59], v[84:87], v[132:135]
    v_add_u32 v46, 0xfffe8000, v46
    ds_read_b64_tr_b16 v[48:49], v46 offset:0
    ds_read_b64_tr_b16 v[50:51], v46 offset:1024
    s_waitcnt lgkmcnt(12)
    v_mfma_f32_16x16x32_bf16 v[124:127], v[60:63], v[80:83], v[124:127]
    ds_read_b64_tr_b16 v[52:53], v46 offset:16384
    ds_read_b64_tr_b16 v[54:55], v46 offset:17408
    v_mfma_f32_16x16x32_bf16 v[140:143], v[60:63], v[84:87], v[140:143]
    s_waitcnt lgkmcnt(10)
    v_mfma_f32_16x16x32_bf16 v[144:147], v[64:67], v[80:83], v[144:147]
    v_add_u32 v47, 0xfffe8000, v47
    ds_read_b64_tr_b16 v[56:57], v47 offset:0
    ds_read_b64_tr_b16 v[58:59], v47 offset:1024
    v_mfma_f32_16x16x32_bf16 v[160:163], v[64:67], v[84:87], v[160:163]
    ds_read_b64_tr_b16 v[60:61], v47 offset:16384
    ds_read_b64_tr_b16 v[62:63], v47 offset:17408
    s_waitcnt lgkmcnt(12)
    v_mfma_f32_16x16x32_bf16 v[152:155], v[68:71], v[80:83], v[152:155]
    ds_read_b64_tr_b16 v[64:65], v42 offset:8192
    ds_read_b64_tr_b16 v[66:67], v42 offset:9216
    v_mfma_f32_16x16x32_bf16 v[168:171], v[68:71], v[84:87], v[168:171]
    s_waitcnt lgkmcnt(12)
    v_mfma_f32_16x16x32_bf16 v[148:151], v[72:75], v[80:83], v[148:151]
    ds_read_b64_tr_b16 v[68:69], v42 offset:24576
    ds_read_b64_tr_b16 v[70:71], v42 offset:25600
    v_mfma_f32_16x16x32_bf16 v[164:167], v[72:75], v[84:87], v[164:167]
    s_waitcnt lgkmcnt(12)
    v_mfma_f32_16x16x32_bf16 v[156:159], v[76:79], v[80:83], v[156:159]
    ds_read_b64_tr_b16 v[72:73], v43 offset:8192
    ds_read_b64_tr_b16 v[74:75], v43 offset:9216
    v_mfma_f32_16x16x32_bf16 v[172:175], v[76:79], v[84:87], v[172:175]
    s_waitcnt lgkmcnt(12)
    v_mfma_f32_16x16x32_bf16 v[176:179], v[48:51], v[80:83], v[176:179]
    ds_read_b64_tr_b16 v[76:77], v43 offset:24576
    ds_read_b64_tr_b16 v[78:79], v43 offset:25600
    v_mfma_f32_16x16x32_bf16 v[192:195], v[48:51], v[84:87], v[192:195]
    s_waitcnt lgkmcnt(12)
    v_mfma_f32_16x16x32_bf16 v[184:187], v[52:55], v[80:83], v[184:187]
    ds_read_b64_tr_b16 v[48:49], v44 offset:8192
    ds_read_b64_tr_b16 v[50:51], v44 offset:9216
    v_mfma_f32_16x16x32_bf16 v[200:203], v[52:55], v[84:87], v[200:203]
    s_waitcnt lgkmcnt(12)
    v_mfma_f32_16x16x32_bf16 v[180:183], v[56:59], v[80:83], v[180:183]
    ds_read_b64_tr_b16 v[52:53], v44 offset:24576
    ds_read_b64_tr_b16 v[54:55], v44 offset:25600
    v_mfma_f32_16x16x32_bf16 v[196:199], v[56:59], v[84:87], v[196:199]
    s_waitcnt lgkmcnt(12)
    v_mfma_f32_16x16x32_bf16 v[188:191], v[60:63], v[80:83], v[188:191]
    ds_read_b64_tr_b16 v[56:57], v45 offset:8192
    ds_read_b64_tr_b16 v[58:59], v45 offset:9216
    v_mfma_f32_16x16x32_bf16 v[204:207], v[60:63], v[84:87], v[204:207]
    s_waitcnt lgkmcnt(12)
    v_mfma_f32_16x16x32_bf16 v[112:115], v[64:67], v[96:99], v[112:115]
    ds_read_b64_tr_b16 v[60:61], v45 offset:24576
    ds_read_b64_tr_b16 v[62:63], v45 offset:25600
    v_mfma_f32_16x16x32_bf16 v[128:131], v[64:67], v[100:103], v[128:131]
    s_waitcnt lgkmcnt(12)
    v_mfma_f32_16x16x32_bf16 v[120:123], v[68:71], v[96:99], v[120:123]
    ds_read_b64_tr_b16 v[64:65], v46 offset:8192
    ds_read_b64_tr_b16 v[66:67], v46 offset:9216
    v_mfma_f32_16x16x32_bf16 v[136:139], v[68:71], v[100:103], v[136:139]
    s_waitcnt lgkmcnt(12)
    v_mfma_f32_16x16x32_bf16 v[116:119], v[72:75], v[96:99], v[116:119]
    ds_read_b64_tr_b16 v[68:69], v46 offset:24576
    ds_read_b64_tr_b16 v[70:71], v46 offset:25600
    v_mfma_f32_16x16x32_bf16 v[132:135], v[72:75], v[100:103], v[132:135]
    s_waitcnt lgkmcnt(12)
    v_mfma_f32_16x16x32_bf16 v[124:127], v[76:79], v[96:99], v[124:127]
    ds_read_b64_tr_b16 v[72:73], v47 offset:8192
    ds_read_b64_tr_b16 v[74:75], v47 offset:9216
    v_mfma_f32_16x16x32_bf16 v[140:143], v[76:79], v[100:103], v[140:143]
    s_waitcnt lgkmcnt(12)
    v_mfma_f32_16x16x32_bf16 v[144:147], v[48:51], v[96:99], v[144:147]
    ds_read_b64_tr_b16 v[76:77], v47 offset:24576
    ds_read_b64_tr_b16 v[78:79], v47 offset:25600
    v_mfma_f32_16x16x32_bf16 v[160:163], v[48:51], v[100:103], v[160:163]
    s_waitcnt lgkmcnt(12)
    v_mfma_f32_16x16x32_bf16 v[152:155], v[52:55], v[96:99], v[152:155]
    v_mfma_f32_16x16x32_bf16 v[168:171], v[52:55], v[100:103], v[168:171]
    s_waitcnt lgkmcnt(10)
    v_mfma_f32_16x16x32_bf16 v[148:151], v[56:59], v[96:99], v[148:151]
    v_mfma_f32_16x16x32_bf16 v[164:167], v[56:59], v[100:103], v[164:167]
    s_waitcnt lgkmcnt(0)
    s_barrier
    v_mfma_f32_16x16x32_bf16 v[156:159], v[60:63], v[96:99], v[156:159]
    v_add_u32 v40, 0xc000, v40
    ds_read_b128 v[80:83], v40 offset:0
    v_add_u32 v42, 0xc000, v42
    ds_read_b64_tr_b16 v[48:49], v42 offset:0
    v_mfma_f32_16x16x32_bf16 v[172:175], v[60:63], v[100:103], v[172:175]
    ds_read_b64_tr_b16 v[50:51], v42 offset:1024
    ds_read_b128 v[84:87], v40 offset:2048
    v_mfma_f32_16x16x32_bf16 v[176:179], v[64:67], v[96:99], v[176:179]
    ds_read_b64_tr_b16 v[52:53], v42 offset:16384
    ds_read_b64_tr_b16 v[54:55], v42 offset:17408
    v_mfma_f32_16x16x32_bf16 v[192:195], v[64:67], v[100:103], v[192:195]
    v_add_u32 v43, 0xc000, v43
    ds_read_b64_tr_b16 v[56:57], v43 offset:0
    ds_read_b64_tr_b16 v[58:59], v43 offset:1024
    v_mfma_f32_16x16x32_bf16 v[184:187], v[68:71], v[96:99], v[184:187]
    ds_read_b64_tr_b16 v[60:61], v43 offset:16384
    ds_read_b64_tr_b16 v[62:63], v43 offset:17408
    v_mfma_f32_16x16x32_bf16 v[200:203], v[68:71], v[100:103], v[200:203]
    v_mfma_f32_16x16x32_bf16 v[180:183], v[72:75], v[96:99], v[180:183]
    v_mfma_f32_16x16x32_bf16 v[196:199], v[72:75], v[100:103], v[196:199]
    v_mfma_f32_16x16x32_bf16 v[188:191], v[76:79], v[96:99], v[188:191]
    v_mfma_f32_16x16x32_bf16 v[204:207], v[76:79], v[100:103], v[204:207]
    s_waitcnt lgkmcnt(7)
    v_mfma_f32_16x16x32_bf16 v[112:115], v[48:51], v[80:83], v[112:115]
    v_add_u32 v41, 0xc000, v41
    ds_read_b128 v[96:99], v41 offset:0
    ds_read_b128 v[100:103], v41 offset:2048
    s_waitcnt lgkmcnt(8)
    v_mfma_f32_16x16x32_bf16 v[128:131], v[48:51], v[84:87], v[128:131]
    v_add_u32 v44, 0xc000, v44
    ds_read_b64_tr_b16 v[64:65], v44 offset:0
    ds_read_b64_tr_b16 v[66:67], v44 offset:1024
    s_waitcnt lgkmcnt(8)
    v_mfma_f32_16x16x32_bf16 v[120:123], v[52:55], v[80:83], v[120:123]
    ds_read_b64_tr_b16 v[68:69], v44 offset:16384
    ds_read_b64_tr_b16 v[70:71], v44 offset:17408
    v_mfma_f32_16x16x32_bf16 v[136:139], v[52:55], v[84:87], v[136:139]
    v_add_u32 v45, 0xc000, v45
    ds_read_b64_tr_b16 v[72:73], v45 offset:0
    ds_read_b64_tr_b16 v[74:75], v45 offset:1024
    s_waitcnt lgkmcnt(10)
    v_mfma_f32_16x16x32_bf16 v[116:119], v[56:59], v[80:83], v[116:119]
    ds_read_b64_tr_b16 v[76:77], v45 offset:16384
    ds_read_b64_tr_b16 v[78:79], v45 offset:17408
    v_mfma_f32_16x16x32_bf16 v[132:135], v[56:59], v[84:87], v[132:135]
    v_add_u32 v46, 0xc000, v46
    ds_read_b64_tr_b16 v[48:49], v46 offset:0
    ds_read_b64_tr_b16 v[50:51], v46 offset:1024
    s_waitcnt lgkmcnt(12)
    v_mfma_f32_16x16x32_bf16 v[124:127], v[60:63], v[80:83], v[124:127]
    ds_read_b64_tr_b16 v[52:53], v46 offset:16384
    ds_read_b64_tr_b16 v[54:55], v46 offset:17408
    v_mfma_f32_16x16x32_bf16 v[140:143], v[60:63], v[84:87], v[140:143]
    s_waitcnt lgkmcnt(10)
    v_mfma_f32_16x16x32_bf16 v[144:147], v[64:67], v[80:83], v[144:147]
    v_add_u32 v47, 0xc000, v47
    ds_read_b64_tr_b16 v[56:57], v47 offset:0
    ds_read_b64_tr_b16 v[58:59], v47 offset:1024
    v_mfma_f32_16x16x32_bf16 v[160:163], v[64:67], v[84:87], v[160:163]
    ds_read_b64_tr_b16 v[60:61], v47 offset:16384
    ds_read_b64_tr_b16 v[62:63], v47 offset:17408
    s_waitcnt lgkmcnt(12)
    v_mfma_f32_16x16x32_bf16 v[152:155], v[68:71], v[80:83], v[152:155]
    ds_read_b64_tr_b16 v[64:65], v42 offset:8192
    ds_read_b64_tr_b16 v[66:67], v42 offset:9216
    v_mfma_f32_16x16x32_bf16 v[168:171], v[68:71], v[84:87], v[168:171]
    s_waitcnt lgkmcnt(12)
    v_mfma_f32_16x16x32_bf16 v[148:151], v[72:75], v[80:83], v[148:151]
    ds_read_b64_tr_b16 v[68:69], v42 offset:24576
    ds_read_b64_tr_b16 v[70:71], v42 offset:25600
    v_mfma_f32_16x16x32_bf16 v[164:167], v[72:75], v[84:87], v[164:167]
    s_waitcnt lgkmcnt(12)
    v_mfma_f32_16x16x32_bf16 v[156:159], v[76:79], v[80:83], v[156:159]
    ds_read_b64_tr_b16 v[72:73], v43 offset:8192
    ds_read_b64_tr_b16 v[74:75], v43 offset:9216
    v_mfma_f32_16x16x32_bf16 v[172:175], v[76:79], v[84:87], v[172:175]
    s_waitcnt lgkmcnt(12)
    v_mfma_f32_16x16x32_bf16 v[176:179], v[48:51], v[80:83], v[176:179]
    ds_read_b64_tr_b16 v[76:77], v43 offset:24576
    ds_read_b64_tr_b16 v[78:79], v43 offset:25600
    v_mfma_f32_16x16x32_bf16 v[192:195], v[48:51], v[84:87], v[192:195]
    s_waitcnt lgkmcnt(12)
    v_mfma_f32_16x16x32_bf16 v[184:187], v[52:55], v[80:83], v[184:187]
    ds_read_b64_tr_b16 v[48:49], v44 offset:8192
    ds_read_b64_tr_b16 v[50:51], v44 offset:9216
    v_mfma_f32_16x16x32_bf16 v[200:203], v[52:55], v[84:87], v[200:203]
    s_waitcnt lgkmcnt(12)
    v_mfma_f32_16x16x32_bf16 v[180:183], v[56:59], v[80:83], v[180:183]
    ds_read_b64_tr_b16 v[52:53], v44 offset:24576
    ds_read_b64_tr_b16 v[54:55], v44 offset:25600
    v_mfma_f32_16x16x32_bf16 v[196:199], v[56:59], v[84:87], v[196:199]
    s_waitcnt lgkmcnt(12)
    v_mfma_f32_16x16x32_bf16 v[188:191], v[60:63], v[80:83], v[188:191]
    ds_read_b64_tr_b16 v[56:57], v45 offset:8192
    ds_read_b64_tr_b16 v[58:59], v45 offset:9216
    v_mfma_f32_16x16x32_bf16 v[204:207], v[60:63], v[84:87], v[204:207]
    s_waitcnt lgkmcnt(12)
    v_mfma_f32_16x16x32_bf16 v[112:115], v[64:67], v[96:99], v[112:115]
    ds_read_b64_tr_b16 v[60:61], v45 offset:24576
    ds_read_b64_tr_b16 v[62:63], v45 offset:25600
    v_mfma_f32_16x16x32_bf16 v[128:131], v[64:67], v[100:103], v[128:131]
    s_waitcnt lgkmcnt(12)
    v_mfma_f32_16x16x32_bf16 v[120:123], v[68:71], v[96:99], v[120:123]
    ds_read_b64_tr_b16 v[64:65], v46 offset:8192
    ds_read_b64_tr_b16 v[66:67], v46 offset:9216
    v_mfma_f32_16x16x32_bf16 v[136:139], v[68:71], v[100:103], v[136:139]
    s_waitcnt lgkmcnt(12)
    v_mfma_f32_16x16x32_bf16 v[116:119], v[72:75], v[96:99], v[116:119]
    ds_read_b64_tr_b16 v[68:69], v46 offset:24576
    ds_read_b64_tr_b16 v[70:71], v46 offset:25600
    v_mfma_f32_16x16x32_bf16 v[132:135], v[72:75], v[100:103], v[132:135]
    s_waitcnt lgkmcnt(12)
    v_mfma_f32_16x16x32_bf16 v[124:127], v[76:79], v[96:99], v[124:127]
    ds_read_b64_tr_b16 v[72:73], v47 offset:8192
    ds_read_b64_tr_b16 v[74:75], v47 offset:9216
    v_mfma_f32_16x16x32_bf16 v[140:143], v[76:79], v[100:103], v[140:143]
    s_waitcnt lgkmcnt(12)
    v_mfma_f32_16x16x32_bf16 v[144:147], v[48:51], v[96:99], v[144:147]
    ds_read_b64_tr_b16 v[76:77], v47 offset:24576
    ds_read_b64_tr_b16 v[78:79], v47 offset:25600
    v_mfma_f32_16x16x32_bf16 v[160:163], v[48:51], v[100:103], v[160:163]
    s_waitcnt lgkmcnt(12)
    v_mfma_f32_16x16x32_bf16 v[152:155], v[52:55], v[96:99], v[152:155]
    v_mfma_f32_16x16x32_bf16 v[168:171], v[52:55], v[100:103], v[168:171]
    s_waitcnt lgkmcnt(10)
    v_mfma_f32_16x16x32_bf16 v[148:151], v[56:59], v[96:99], v[148:151]
    v_mfma_f32_16x16x32_bf16 v[164:167], v[56:59], v[100:103], v[164:167]
    s_waitcnt lgkmcnt(0)
    s_barrier
    v_mfma_f32_16x16x32_bf16 v[156:159], v[60:63], v[96:99], v[156:159]
    v_mfma_f32_16x16x32_bf16 v[172:175], v[60:63], v[100:103], v[172:175]
    v_mfma_f32_16x16x32_bf16 v[176:179], v[64:67], v[96:99], v[176:179]
    v_mfma_f32_16x16x32_bf16 v[192:195], v[64:67], v[100:103], v[192:195]
    v_mfma_f32_16x16x32_bf16 v[184:187], v[68:71], v[96:99], v[184:187]
    v_mfma_f32_16x16x32_bf16 v[200:203], v[68:71], v[100:103], v[200:203]
    v_mfma_f32_16x16x32_bf16 v[180:183], v[72:75], v[96:99], v[180:183]
    v_mfma_f32_16x16x32_bf16 v[196:199], v[72:75], v[100:103], v[196:199]
    v_mfma_f32_16x16x32_bf16 v[188:191], v[76:79], v[96:99], v[188:191]
    v_mfma_f32_16x16x32_bf16 v[204:207], v[76:79], v[100:103], v[204:207]
    s_nop 7
    v_pk_mul_f32 v[16:17], v[112:113], s[74:75]
    v_pk_mul_f32 v[18:19], v[114:115], s[74:75]
    v_pk_mul_f32 v[20:21], v[116:117], s[74:75]
    v_pk_mul_f32 v[22:23], v[118:119], s[74:75]
    v_exp_f32 v16, v16
    v_exp_f32 v17, v17
    v_exp_f32 v18, v18
    v_exp_f32 v19, v19
    v_exp_f32 v20, v20
    v_exp_f32 v21, v21
    v_exp_f32 v22, v22
    v_exp_f32 v23, v23
    v_pk_mul_f32 v[112:113], v[112:113], v[120:121]
    v_pk_mul_f32 v[114:115], v[114:115], v[122:123]
    v_pk_mul_f32 v[116:117], v[116:117], v[124:125]
    v_pk_mul_f32 v[118:119], v[118:119], v[126:127]
    v_pk_add_f32 v[16:17], v[16:17], 1.0 op_sel_hi:[1,0]
    v_pk_add_f32 v[18:19], v[18:19], 1.0 op_sel_hi:[1,0]
    v_pk_add_f32 v[20:21], v[20:21], 1.0 op_sel_hi:[1,0]
    v_pk_add_f32 v[22:23], v[22:23], 1.0 op_sel_hi:[1,0]
    v_rcp_f32 v16, v16
    v_rcp_f32 v17, v17
    v_rcp_f32 v18, v18
    v_rcp_f32 v19, v19
    v_rcp_f32 v20, v20
    v_rcp_f32 v21, v21
    v_rcp_f32 v22, v22
    v_rcp_f32 v23, v23
    s_nop 0
    v_pk_mul_f32 v[112:113], v[112:113], v[16:17]
    v_pk_mul_f32 v[114:115], v[114:115], v[18:19]
    v_pk_mul_f32 v[116:117], v[116:117], v[20:21]
    v_pk_mul_f32 v[118:119], v[118:119], v[22:23]
    v_cvt_pk_bf16_f32 v24, v112, v113
    v_cvt_pk_bf16_f32 v25, v114, v115
    v_cvt_pk_bf16_f32 v26, v116, v117
    v_cvt_pk_bf16_f32 v27, v118, v119
    buffer_store_dwordx4 v[24:27], v254, s[64:67], s86 offen offset:0 sc1
    v_pk_mul_f32 v[28:29], v[128:129], s[74:75]
    v_pk_mul_f32 v[30:31], v[130:131], s[74:75]
    v_pk_mul_f32 v[32:33], v[132:133], s[74:75]
    v_pk_mul_f32 v[34:35], v[134:135], s[74:75]
    v_exp_f32 v28, v28
    v_exp_f32 v29, v29
    v_exp_f32 v30, v30
    v_exp_f32 v31, v31
    v_exp_f32 v32, v32
    v_exp_f32 v33, v33
    v_exp_f32 v34, v34
    v_exp_f32 v35, v35
    v_pk_mul_f32 v[128:129], v[128:129], v[136:137]
    v_pk_mul_f32 v[130:131], v[130:131], v[138:139]
    v_pk_mul_f32 v[132:133], v[132:133], v[140:141]
    v_pk_mul_f32 v[134:135], v[134:135], v[142:143]
    v_pk_add_f32 v[28:29], v[28:29], 1.0 op_sel_hi:[1,0]
    v_pk_add_f32 v[30:31], v[30:31], 1.0 op_sel_hi:[1,0]
    v_pk_add_f32 v[32:33], v[32:33], 1.0 op_sel_hi:[1,0]
    v_pk_add_f32 v[34:35], v[34:35], 1.0 op_sel_hi:[1,0]
    v_rcp_f32 v28, v28
    v_rcp_f32 v29, v29
    v_rcp_f32 v30, v30
    v_rcp_f32 v31, v31
    v_rcp_f32 v32, v32
    v_rcp_f32 v33, v33
    v_rcp_f32 v34, v34
    v_rcp_f32 v35, v35
    s_nop 0
    v_pk_mul_f32 v[128:129], v[128:129], v[28:29]
    v_pk_mul_f32 v[130:131], v[130:131], v[30:31]
    v_pk_mul_f32 v[132:133], v[132:133], v[32:33]
    v_pk_mul_f32 v[134:135], v[134:135], v[34:35]
    v_cvt_pk_bf16_f32 v36, v128, v129
    v_cvt_pk_bf16_f32 v37, v130, v131
    v_cvt_pk_bf16_f32 v38, v132, v133
    v_cvt_pk_bf16_f32 v39, v134, v135
    buffer_store_dwordx4 v[36:39], v254, s[64:67], s86 offen offset:256 sc1
    v_pk_mul_f32 v[16:17], v[144:145], s[74:75]
    v_pk_mul_f32 v[18:19], v[146:147], s[74:75]
    v_pk_mul_f32 v[20:21], v[148:149], s[74:75]
    v_pk_mul_f32 v[22:23], v[150:151], s[74:75]
    v_exp_f32 v16, v16
    v_exp_f32 v17, v17
    v_exp_f32 v18, v18
    v_exp_f32 v19, v19
    v_exp_f32 v20, v20
    v_exp_f32 v21, v21
    v_exp_f32 v22, v22
    v_exp_f32 v23, v23
    v_pk_mul_f32 v[144:145], v[144:145], v[152:153]
    v_pk_mul_f32 v[146:147], v[146:147], v[154:155]
    v_pk_mul_f32 v[148:149], v[148:149], v[156:157]
    v_pk_mul_f32 v[150:151], v[150:151], v[158:159]
    v_pk_add_f32 v[16:17], v[16:17], 1.0 op_sel_hi:[1,0]
    v_pk_add_f32 v[18:19], v[18:19], 1.0 op_sel_hi:[1,0]
    v_pk_add_f32 v[20:21], v[20:21], 1.0 op_sel_hi:[1,0]
    v_pk_add_f32 v[22:23], v[22:23], 1.0 op_sel_hi:[1,0]
    v_rcp_f32 v16, v16
    v_rcp_f32 v17, v17
    v_rcp_f32 v18, v18
    v_rcp_f32 v19, v19
    v_rcp_f32 v20, v20
    v_rcp_f32 v21, v21
    v_rcp_f32 v22, v22
    v_rcp_f32 v23, v23
    s_nop 0
    v_pk_mul_f32 v[144:145], v[144:145], v[16:17]
    v_pk_mul_f32 v[146:147], v[146:147], v[18:19]
    v_pk_mul_f32 v[148:149], v[148:149], v[20:21]
    v_pk_mul_f32 v[150:151], v[150:151], v[22:23]
    v_cvt_pk_bf16_f32 v24, v144, v145
    v_cvt_pk_bf16_f32 v25, v146, v147
    v_cvt_pk_bf16_f32 v26, v148, v149
    v_cvt_pk_bf16_f32 v27, v150, v151
    buffer_store_dwordx4 v[24:27], v254, s[64:67], s86 offen offset:2048 sc1
    v_pk_mul_f32 v[28:29], v[160:161], s[74:75]
    v_pk_mul_f32 v[30:31], v[162:163], s[74:75]
    v_pk_mul_f32 v[32:33], v[164:165], s[74:75]
    v_pk_mul_f32 v[34:35], v[166:167], s[74:75]
    v_exp_f32 v28, v28
    v_exp_f32 v29, v29
    v_exp_f32 v30, v30
    v_exp_f32 v31, v31
    v_exp_f32 v32, v32
    v_exp_f32 v33, v33
    v_exp_f32 v34, v34
    v_exp_f32 v35, v35
    v_pk_mul_f32 v[160:161], v[160:161], v[168:169]
    v_pk_mul_f32 v[162:163], v[162:163], v[170:171]
    v_pk_mul_f32 v[164:165], v[164:165], v[172:173]
    v_pk_mul_f32 v[166:167], v[166:167], v[174:175]
    v_pk_add_f32 v[28:29], v[28:29], 1.0 op_sel_hi:[1,0]
    v_pk_add_f32 v[30:31], v[30:31], 1.0 op_sel_hi:[1,0]
    v_pk_add_f32 v[32:33], v[32:33], 1.0 op_sel_hi:[1,0]
    v_pk_add_f32 v[34:35], v[34:35], 1.0 op_sel_hi:[1,0]
    v_rcp_f32 v28, v28
    v_rcp_f32 v29, v29
    v_rcp_f32 v30, v30
    v_rcp_f32 v31, v31
    v_rcp_f32 v32, v32
    v_rcp_f32 v33, v33
    v_rcp_f32 v34, v34
    v_rcp_f32 v35, v35
    s_nop 0
    v_pk_mul_f32 v[160:161], v[160:161], v[28:29]
    v_pk_mul_f32 v[162:163], v[162:163], v[30:31]
    v_pk_mul_f32 v[164:165], v[164:165], v[32:33]
    v_pk_mul_f32 v[166:167], v[166:167], v[34:35]
    v_cvt_pk_bf16_f32 v36, v160, v161
    v_cvt_pk_bf16_f32 v37, v162, v163
    v_cvt_pk_bf16_f32 v38, v164, v165
    v_cvt_pk_bf16_f32 v39, v166, v167
    buffer_store_dwordx4 v[36:39], v254, s[64:67], s86 offen offset:2304 sc1
    v_pk_mul_f32 v[16:17], v[176:177], s[74:75]
    v_pk_mul_f32 v[18:19], v[178:179], s[74:75]
    v_pk_mul_f32 v[20:21], v[180:181], s[74:75]
    v_pk_mul_f32 v[22:23], v[182:183], s[74:75]
    v_exp_f32 v16, v16
    v_exp_f32 v17, v17
    v_exp_f32 v18, v18
    v_exp_f32 v19, v19
    v_exp_f32 v20, v20
    v_exp_f32 v21, v21
    v_exp_f32 v22, v22
    v_exp_f32 v23, v23
    v_pk_mul_f32 v[176:177], v[176:177], v[184:185]
    v_pk_mul_f32 v[178:179], v[178:179], v[186:187]
    v_pk_mul_f32 v[180:181], v[180:181], v[188:189]
    v_pk_mul_f32 v[182:183], v[182:183], v[190:191]
    v_pk_add_f32 v[16:17], v[16:17], 1.0 op_sel_hi:[1,0]
    v_pk_add_f32 v[18:19], v[18:19], 1.0 op_sel_hi:[1,0]
    v_pk_add_f32 v[20:21], v[20:21], 1.0 op_sel_hi:[1,0]
    v_pk_add_f32 v[22:23], v[22:23], 1.0 op_sel_hi:[1,0]
    v_rcp_f32 v16, v16
    v_rcp_f32 v17, v17
    v_rcp_f32 v18, v18
    v_rcp_f32 v19, v19
    v_rcp_f32 v20, v20
    v_rcp_f32 v21, v21
    v_rcp_f32 v22, v22
    v_rcp_f32 v23, v23
    s_nop 0
    v_pk_mul_f32 v[176:177], v[176:177], v[16:17]
    v_pk_mul_f32 v[178:179], v[178:179], v[18:19]
    v_pk_mul_f32 v[180:181], v[180:181], v[20:21]
    v_pk_mul_f32 v[182:183], v[182:183], v[22:23]
    v_cvt_pk_bf16_f32 v24, v176, v177
    v_cvt_pk_bf16_f32 v25, v178, v179
    v_cvt_pk_bf16_f32 v26, v180, v181
    v_cvt_pk_bf16_f32 v27, v182, v183
    buffer_store_dwordx4 v[24:27], v254, s[64:67], s88 offen offset:0 sc1
    v_pk_mul_f32 v[28:29], v[192:193], s[74:75]
    v_pk_mul_f32 v[30:31], v[194:195], s[74:75]
    v_pk_mul_f32 v[32:33], v[196:197], s[74:75]
    v_pk_mul_f32 v[34:35], v[198:199], s[74:75]
    v_exp_f32 v28, v28
    v_exp_f32 v29, v29
    v_exp_f32 v30, v30
    v_exp_f32 v31, v31
    v_exp_f32 v32, v32
    v_exp_f32 v33, v33
    v_exp_f32 v34, v34
    v_exp_f32 v35, v35
    v_pk_mul_f32 v[192:193], v[192:193], v[200:201]
    v_pk_mul_f32 v[194:195], v[194:195], v[202:203]
    v_pk_mul_f32 v[196:197], v[196:197], v[204:205]
    v_pk_mul_f32 v[198:199], v[198:199], v[206:207]
    v_pk_add_f32 v[28:29], v[28:29], 1.0 op_sel_hi:[1,0]
    v_pk_add_f32 v[30:31], v[30:31], 1.0 op_sel_hi:[1,0]
    v_pk_add_f32 v[32:33], v[32:33], 1.0 op_sel_hi:[1,0]
    v_pk_add_f32 v[34:35], v[34:35], 1.0 op_sel_hi:[1,0]
    v_rcp_f32 v28, v28
    v_rcp_f32 v29, v29
    v_rcp_f32 v30, v30
    v_rcp_f32 v31, v31
    v_rcp_f32 v32, v32
    v_rcp_f32 v33, v33
    v_rcp_f32 v34, v34
    v_rcp_f32 v35, v35
    s_nop 0
    v_pk_mul_f32 v[192:193], v[192:193], v[28:29]
    v_pk_mul_f32 v[194:195], v[194:195], v[30:31]
    v_pk_mul_f32 v[196:197], v[196:197], v[32:33]
    v_pk_mul_f32 v[198:199], v[198:199], v[34:35]
    v_cvt_pk_bf16_f32 v36, v192, v193
    v_cvt_pk_bf16_f32 v37, v194, v195
    v_cvt_pk_bf16_f32 v38, v196, v197
    v_cvt_pk_bf16_f32 v39, v198, v199
    buffer_store_dwordx4 v[36:39], v254, s[64:67], s88 offen offset:256 sc1
L_g1done:
    v_readfirstlane_b32 s15, v250
    s_mov_b32 s5, 0
    s_cmp_lg_u32 s15, 0
    s_cbranch_scc1 L_epok3
L_eppoll3:
    buffer_load_dword v250, v248, s[60:63], 0 offen sc1
    s_add_u32 s5, s5, 1
    s_cmp_gt_u32 s5, 400000
    s_cbranch_scc1 L_epok3
    s_waitcnt vmcnt(0)
    v_readfirstlane_b32 s15, v250
    s_cmp_eq_u32 s15, 0
    s_cbranch_scc1 L_eppoll3
L_epok3:
    v_and_b32 v2, 31, v0
    v_lshlrev_b32 v2, 2, v2
    v_lshlrev_b32 v4, 2, v246
    s_lshl_b32 s4, s81, 9
    s_lshl_b32 s5, s3, 6
    s_add_u32 s4, s4, s5
    s_add_u32 s54, s4, 65536
    v_and_b32 v5, 15, v0
    v_lshlrev_b32 v5, 2, v5
    v_bfe_u32 v6, v0, 4, 1
    v_lshl_add_u32 v5, v6, 8, v5
    s_lshl_b32 s55, s81, 18
    s_lshl_b32 s5, s80, 7
    s_add_u32 s55, s55, s5
    s_lshl_b32 s5, s3, 16
    s_add_u32 s55, s55, s5
    s_setprio 3
    s_barrier
    ds_read_b64_tr_b16 v[48:49], v244 offset:0
    ds_read_b64_tr_b16 v[50:51], v244 offset:2048
    ds_read_b64_tr_b16 v[52:53], v245 offset:0
    ds_read_b64_tr_b16 v[54:55], v245 offset:2048
    ds_read_b64_tr_b16 v[56:57], v244 offset:1024
    ds_read_b64_tr_b16 v[58:59], v244 offset:3072
    ds_read_b64_tr_b16 v[60:61], v245 offset:1024
    ds_read_b64_tr_b16 v[62:63], v245 offset:3072
    ds_read_b64_tr_b16 v[64:65], v244 offset:8192
    ds_read_b64_tr_b16 v[66:67], v244 offset:10240
    ds_read_b64_tr_b16 v[68:69], v245 offset:8192
    ds_read_b64_tr_b16 v[70:71], v245 offset:10240
    ds_read_b64_tr_b16 v[72:73], v244 offset:9216
    ds_read_b64_tr_b16 v[74:75], v244 offset:11264
    ds_read_b64_tr_b16 v[76:77], v245 offset:9216
    ds_read_b64_tr_b16 v[78:79], v245 offset:11264
    ds_read_b64_tr_b16 v[80:81], v244 offset:16384
    ds_read_b64_tr_b16 v[82:83], v244 offset:18432
    ds_read_b64_tr_b16 v[84:85], v245 offset:16384
    ds_read_b64_tr_b16 v[86:87], v245 offset:18432
    ds_read_b64_tr_b16 v[88:89], v244 offset:17408
    ds_read_b64_tr_b16 v[90:91], v244 offset:19456
    ds_read_b64_tr_b16 v[92:93], v245 offset:17408
    ds_read_b64_tr_b16 v[94:95], v245 offset:19456
    ds_read_b64_tr_b16 v[96:97], v244 offset:24576
    ds_read_b64_tr_b16 v[98:99], v244 offset:26624
    ds_read_b64_tr_b16 v[100:101], v245 offset:24576
    ds_read_b64_tr_b16 v[102:103], v245 offset:26624
    ds_read_b64_tr_b16 v[104:105], v244 offset:25600
    ds_read_b64_tr_b16 v[106:107], v244 offset:27648
    ds_read_b64_tr_b16 v[108:109], v245 offset:25600
    ds_read_b64_tr_b16 v[110:111], v245 offset:27648
    ds_read_b64_tr_b16 v[112:113], v241 offset:0
    ds_read_b64_tr_b16 v[114:115], v241 offset:2048
    ds_read_b64_tr_b16 v[116:117], v242 offset:0
    ds_read_b64_tr_b16 v[118:119], v242 offset:2048
    ds_read_b64_tr_b16 v[120:121], v241 offset:1024
    ds_read_b64_tr_b16 v[122:123], v241 offset:3072
    ds_read_b64_tr_b16 v[124:125], v242 offset:1024
    ds_read_b64_tr_b16 v[126:127], v242 offset:3072
    ds_read_b64_tr_b16 v[128:129], v241 offset:8192
    ds_read_b64_tr_b16 v[130:131], v241 offset:10240
    ds_read_b64_tr_b16 v[132:133], v242 offset:8192
    ds_read_b64_tr_b16 v[134:135], v242 offset:10240
    ds_read_b64_tr_b16 v[136:137], v241 offset:9216
    ds_read_b64_tr_b16 v[138:139], v241 offset:11264
    ds_read_b64_tr_b16 v[140:141], v242 offset:9216
    ds_read_b64_tr_b16 v[142:143], v242 offset:11264
    s_waitcnt vmcnt(0)
    buffer_store_dword v250, v249, s[56:59], s79 offen sc1
    ds_read_b64_tr_b16 v[144:145], v241 offset:16384
    ds_read_b64_tr_b16 v[146:147], v241 offset:18432
    ds_read_b64_tr_b16 v[148:149], v242 offset:16384
    ds_read_b64_tr_b16 v[150:151], v242 offset:18432
    ds_read_b64_tr_b16 v[152:153], v241 offset:17408
    ds_read_b64_tr_b16 v[154:155], v241 offset:19456
    ds_read_b64_tr_b16 v[156:157], v242 offset:17408
    ds_read_b64_tr_b16 v[158:159], v242 offset:19456
    ds_read_b64_tr_b16 v[160:161], v241 offset:24576
    ds_read_b64_tr_b16 v[162:163], v241 offset:26624
    ds_read_b64_tr_b16 v[164:165], v242 offset:24576
    ds_read_b64_tr_b16 v[166:167], v242 offset:26624
    ds_read_b64_tr_b16 v[168:169], v241 offset:25600
    ds_read_b64_tr_b16 v[170:171], v241 offset:27648
    ds_read_b64_tr_b16 v[172:173], v242 offset:25600
    ds_read_b64_tr_b16 v[174:175], v242 offset:27648
    ds_read_b64_tr_b16 v[176:177], v241 offset:32768
    ds_read_b64_tr_b16 v[178:179], v241 offset:34816
    ds_read_b64_tr_b16 v[180:181], v242 offset:32768
    ds_read_b64_tr_b16 v[182:183], v242 offset:34816
    ds_read_b64_tr_b16 v[184:185], v241 offset:33792
    ds_read_b64_tr_b16 v[186:187], v241 offset:35840
    ds_read_b64_tr_b16 v[188:189], v242 offset:33792
    ds_read_b64_tr_b16 v[190:191], v242 offset:35840
    ds_read_b64_tr_b16 v[192:193], v241 offset:40960
    ds_read_b64_tr_b16 v[194:195], v241 offset:43008
    ds_read_b64_tr_b16 v[196:197], v242 offset:40960
    ds_read_b64_tr_b16 v[198:199], v242 offset:43008
    ds_read_b64_tr_b16 v[200:201], v241 offset:41984
    ds_read_b64_tr_b16 v[202:203], v241 offset:44032
    ds_read_b64_tr_b16 v[204:205], v242 offset:41984
    ds_read_b64_tr_b16 v[206:207], v242 offset:44032
    s_waitcnt lgkmcnt(0)
    s_barrier
    s_lshl_b32 s6, s80, 8
    s_add_u32 s77, s82, 18
    s_sub_u32 s4, s77, 28
    s_cmp_ge_u32 s77, 28
    s_cselect_b32 s77, s4, s77
    s_lshl_b32 s77, s77, 16
    s_add_u32 s77, s77, s72
    s_add_u32 m0, s73, 0
    s_nop 0
    buffer_load_dwordx4 v240, s[68:71], s77 offen lds
    s_add_u32 m0, s73, 1024
    s_add_u32 s77, s77, 8192
    buffer_load_dwordx4 v240, s[68:71], s77 offen lds
    s_add_u32 s77, s82, 19
    s_sub_u32 s4, s77, 28
    s_cmp_ge_u32 s77, 28
    s_cselect_b32 s77, s4, s77
    s_lshl_b32 s77, s77, 16
    s_add_u32 s77, s77, s72
    s_add_u32 m0, s73, 8192
    s_nop 0
    buffer_load_dwordx4 v240, s[68:71], s77 offen lds
    s_add_u32 m0, s73, 9216
    s_add_u32 s77, s77, 8192
    buffer_load_dwordx4 v240, s[68:71], s77 offen lds
    s_add_u32 s77, s82, 20
    s_sub_u32 s4, s77, 28
    s_cmp_ge_u32 s77, 28
    s_cselect_b32 s77, s4, s77
    s_lshl_b32 s77, s77, 16
    s_add_u32 s77, s77, s72
    s_add_u32 m0, s73, 16384
    s_nop 0
    buffer_load_dwordx4 v240, s[68:71], s77 offen lds
    s_add_u32 m0, s73, 17408
    s_add_u32 s77, s77, 8192
    buffer_load_dwordx4 v240, s[68:71], s77 offen lds
    s_add_u32 s77, s82, 21
    s_sub_u32 s4, s77, 28
    s_cmp_ge_u32 s77, 28
    s_cselect_b32 s77, s4, s77
    s_lshl_b32 s77, s77, 16
    s_add_u32 s77, s77, s72
    s_add_u32 m0, s73, 24576
    s_nop 0
    buffer_load_dwordx4 v240, s[68:71], s77 offen lds
    s_add_u32 m0, s73, 25600
    s_add_u32 s77, s77, 8192
    buffer_load_dwordx4 v240, s[68:71], s77 offen lds
    s_add_u32 s77, s82, 22
    s_sub_u32 s4, s77, 28
    s_cmp_ge_u32 s77, 28
    s_cselect_b32 s77, s4, s77
    s_lshl_b32 s77, s77, 16
    s_add_u32 s77, s77, s72
    s_add_u32 m0, s73, 32768
    s_nop 0
    buffer_load_dwordx4 v240, s[68:71], s77 offen lds
    s_add_u32 m0, s73, 33792
    s_add_u32 s77, s77, 8192
    buffer_load_dwordx4 v240, s[68:71], s77 offen lds
    s_add_u32 s77, s82, 23
    s_sub_u32 s4, s77, 28
    s_cmp_ge_u32 s77, 28
    s_cselect_b32 s77, s4, s77
    s_lshl_b32 s77, s77, 16
    s_add_u32 s77, s77, s72
    s_add_u32 m0, s73, 40960
    s_nop 0
    buffer_load_dwordx4 v240, s[68:71], s77 offen lds
    s_add_u32 m0, s73, 41984
    s_add_u32 s77, s77, 8192
    buffer_load_dwordx4 v240, s[68:71], s77 offen lds
    s_add_u32 s77, s82, 24
    s_sub_u32 s4, s77, 28
    s_cmp_ge_u32 s77, 28
    s_cselect_b32 s77, s4, s77
    s_lshl_b32 s77, s77, 16
    s_add_u32 s77, s77, s72
    s_add_u32 m0, s73, 98304
    s_nop 0
    buffer_load_dwordx4 v240, s[68:71], s77 offen lds
    s_add_u32 m0, s73, 99328
    s_add_u32 s77, s77, 8192
    buffer_load_dwordx4 v240, s[68:71], s77 offen lds
    s_add_u32 s77, s82, 25
    s_sub_u32 s4, s77, 28
    s_cmp_ge_u32 s77, 28
    s_cselect_b32 s77, s4, s77
    s_lshl_b32 s77, s77, 16
    s_add_u32 s77, s77, s72
    s_add_u32 m0, s73, 106496
    s_nop 0
    buffer_load_dwordx4 v240, s[68:71], s77 offen lds
    s_add_u32 m0, s73, 107520
    s_add_u32 s77, s77, 8192
    buffer_load_dwordx4 v240, s[68:71], s77 offen lds
    s_add_u32 s77, s82, 26
    s_sub_u32 s4, s77, 28
    s_cmp_ge_u32 s77, 28
    s_cselect_b32 s77, s4, s77
    s_lshl_b32 s77, s77, 16
    s_add_u32 s77, s77, s72
    s_add_u32 m0, s73, 114688
    s_nop 0
    buffer_load_dwordx4 v240, s[68:71], s77 offen lds
    s_add_u32 m0, s73, 115712
    s_add_u32 s77, s77, 8192
    buffer_load_dwordx4 v240, s[68:71], s77 offen lds
    buffer_load_dword v3, v2, s[56:59], s6 offen sc1
    s_add_u32 s77, s82, 27
    s_sub_u32 s4, s77, 28
    s_cmp_ge_u32 s77, 28
    s_cselect_b32 s77, s4, s77
    s_lshl_b32 s77, s77, 16
    s_add_u32 s77, s77, s72
    s_add_u32 m0, s73, 122880
    s_nop 0
    buffer_load_dwordx4 v240, s[68:71], s77 offen lds
    s_add_u32 m0, s73, 123904
    s_add_u32 s77, s77, 8192
    buffer_load_dwordx4 v240, s[68:71], s77 offen lds
    s_add_u32 s77, s82, 10
    s_sub_u32 s4, s77, 28
    s_cmp_ge_u32 s77, 28
    s_cselect_b32 s77, s4, s77
    s_lshl_b32 s77, s77, 16
    s_add_u32 s77, s77, s72
    s_add_u32 m0, s73, 131072
    s_nop 0
    buffer_load_dwordx4 v240, s[68:71], s77 offen lds
    s_add_u32 m0, s73, 132096
    s_add_u32 s77, s77, 8192
    buffer_load_dwordx4 v240, s[68:71], s77 offen lds
    s_add_u32 s77, s82, 11
    s_sub_u32 s4, s77, 28
    s_cmp_ge_u32 s77, 28
    s_cselect_b32 s77, s4, s77
    s_lshl_b32 s77, s77, 16
    s_add_u32 s77, s77, s72
    s_add_u32 m0, s73, 139264
    s_nop 0
    buffer_load_dwordx4 v240, s[68:71], s77 offen lds
    s_add_u32 m0, s73, 140288
    s_add_u32 s77, s77, 8192
    buffer_load_dwordx4 v240, s[68:71], s77 offen lds
    s_waitcnt vmcnt(6)
    s_mov_b32 s5, 0
    v_cmp_ne_u32 vcc, s15, v3
    s_cbranch_vccz L_hpoll_done
L_hpoll:
    buffer_load_dword v3, v2, s[56:59], s6 offen sc1
    s_add_u32 s5, s5, 1
    s_cmp_gt_u32 s5, 400000
    s_cbranch_scc1 L_hpoll_done
    s_waitcnt vmcnt(0)
    v_cmp_ne_u32 vcc, s15, v3
    s_cbranch_vccnz L_hpoll
L_hpoll_done:
    s_mov_b32 s64, s48
    s_and_b32 s65, s49, 0xffff
    s_mov_b32 s66, 7340032
    s_mov_b32 s67, 0x00020000
    s_lshl_b32 s4, s80, 1
    s_add_u32 s4, s4, s84
    s_mul_i32 s4, s4, 112
    s_lshl_b32 s5, s83, 1
    s_add_u32 s4, s4, s5
    s_lshl_b32 s74, s4, 10
    s_add_u32 s60, s48, 14680064
    s_addc_u32 s61, s49, 0
    s_and_b32 s61, s61, 0xffff
    s_mov_b32 s62, 8192
    s_mov_b32 s63, 0x00020000
    s_mov_b32 s68, s40
    s_and_b32 s69, s41, 0xffff
    s_mov_b32 s70, 1835008
    s_mov_b32 s71, 0x00020000
    s_lshl_b32 s72, s81, 7
    s_lshl_b32 s4, s83, 15
    s_add_u32 s72, s72, s4
    s_lshl_b32 s73, s83, 12
    buffer_load_dword v251, v4, s[60:63], 0 offen sc1
    s_add_u32 s75, s82, 0
    s_sub_u32 s4, s75, 28
    s_cmp_ge_u32 s75, 28
    s_cselect_b32 s75, s4, s75
    s_lshl_b32 s75, s75, 12
    s_add_u32 s75, s75, s74
    buffer_load_dwordx4 v[208:211], v247, s[64:67], s75 offen offset:0 sc1
    buffer_load_dwordx4 v[212:215], v247, s[64:67], s75 offen offset:1024 sc1
    s_add_u32 s75, s82, 1
    s_sub_u32 s4, s75, 28
    s_cmp_ge_u32 s75, 28
    s_cselect_b32 s75, s4, s75
    s_lshl_b32 s75, s75, 12
    s_add_u32 s75, s75, s74
    buffer_load_dwordx4 v[216:219], v247, s[64:67], s75 offen offset:0 sc1
    buffer_load_dwordx4 v[220:223], v247, s[64:67], s75 offen offset:1024 sc1
    s_add_u32 s75, s82, 2
    s_sub_u32 s4, s75, 28
    s_cmp_ge_u32 s75, 28
    s_cselect_b32 s75, s4, s75
    s_lshl_b32 s75, s75, 12
    s_add_u32 s75, s75, s74
    buffer_load_dwordx4 v[224:227], v247, s[64:67], s75 offen offset:0 sc1
    buffer_load_dwordx4 v[228:231], v247, s[64:67], s75 offen offset:1024 sc1
    s_add_u32 s75, s82, 3
    s_sub_u32 s4, s75, 28
    s_cmp_ge_u32 s75, 28
    s_cselect_b32 s75, s4, s75
    s_lshl_b32 s75, s75, 12
    s_add_u32 s75, s75, s74
    buffer_load_dwordx4 v[232:235], v247, s[64:67], s75 offen offset:0 sc1
    buffer_load_dwordx4 v[236:239], v247, s[64:67], s75 offen offset:1024 sc1
    s_waitcnt vmcnt(9)
    s_barrier
    s_waitcnt vmcnt(7)
    v_mfma_f32_32x32x16_bf16 v[16:31], v[48:51], v[208:211], 0
    v_mfma_f32_32x32x16_bf16 v[32:47], v[52:55], v[208:211], 0
    s_add_u32 s75, s82, 4
    s_sub_u32 s4, s75, 28
    s_cmp_ge_u32 s75, 28
    s_cselect_b32 s75, s4, s75
    s_lshl_b32 s75, s75, 12
    s_add_u32 s75, s75, s74
    buffer_load_dwordx4 v[208:211], v247, s[64:67], s75 offen offset:0 sc1
    s_waitcnt vmcnt(7)
    v_mfma_f32_32x32x16_bf16 v[16:31], v[56:59], v[212:215], v[16:31]
    v_mfma_f32_32x32x16_bf16 v[32:47], v[60:63], v[212:215], v[32:47]
    buffer_load_dwordx4 v[212:215], v247, s[64:67], s75 offen offset:1024 sc1
    s_waitcnt vmcnt(7)
    v_mfma_f32_32x32x16_bf16 v[16:31], v[64:67], v[216:219], v[16:31]
    v_mfma_f32_32x32x16_bf16 v[32:47], v[68:71], v[216:219], v[32:47]
    s_add_u32 s75, s82, 5
    s_sub_u32 s4, s75, 28
    s_cmp_ge_u32 s75, 28
    s_cselect_b32 s75, s4, s75
    s_lshl_b32 s75, s75, 12
    s_add_u32 s75, s75, s74
    buffer_load_dwordx4 v[216:219], v247, s[64:67], s75 offen offset:0 sc1
    s_waitcnt vmcnt(7)
    v_mfma_f32_32x32x16_bf16 v[16:31], v[72:75], v[220:223], v[16:31]
    v_mfma_f32_32x32x16_bf16 v[32:47], v[76:79], v[220:223], v[32:47]
    buffer_load_dwordx4 v[220:223], v247, s[64:67], s75 offen offset:1024 sc1
    s_waitcnt vmcnt(7)
    v_mfma_f32_32x32x16_bf16 v[16:31], v[80:83], v[224:227], v[16:31]
    v_mfma_f32_32x32x16_bf16 v[32:47], v[84:87], v[224:227], v[32:47]
    s_add_u32 s75, s82, 6
    s_sub_u32 s4, s75, 28
    s_cmp_ge_u32 s75, 28
    s_cselect_b32 s75, s4, s75
    s_lshl_b32 s75, s75, 12
    s_add_u32 s75, s75, s74
    buffer_load_dwordx4 v[224:227], v247, s[64:67], s75 offen offset:0 sc1
    s_waitcnt vmcnt(7)
    v_mfma_f32_32x32x16_bf16 v[16:31], v[88:91], v[228:231], v[16:31]
    v_mfma_f32_32x32x16_bf16 v[32:47], v[92:95], v[228:231], v[32:47]
    buffer_load_dwordx4 v[228:231], v247, s[64:67], s75 offen offset:1024 sc1
    s_waitcnt vmcnt(7)
    v_mfma_f32_32x32x16_bf16 v[16:31], v[96:99], v[232:235], v[16:31]
    v_mfma_f32_32x32x16_bf16 v[32:47], v[100:103], v[232:235], v[32:47]
    s_add_u32 s75, s82, 7
    s_sub_u32 s4, s75, 28
    s_cmp_ge_u32 s75, 28
    s_cselect_b32 s75, s4, s75
    s_lshl_b32 s75, s75, 12
    s_add_u32 s75, s75, s74
    buffer_load_dwordx4 v[232:235], v247, s[64:67], s75 offen offset:0 sc1
    s_waitcnt vmcnt(7)
    v_mfma_f32_32x32x16_bf16 v[16:31], v[104:107], v[236:239], v[16:31]
    v_mfma_f32_32x32x16_bf16 v[32:47], v[108:111], v[236:239], v[32:47]
    buffer_load_dwordx4 v[236:239], v247, s[64:67], s75 offen offset:1024 sc1
    s_waitcnt vmcnt(7)
    v_mfma_f32_32x32x16_bf16 v[16:31], v[112:115], v[208:211], v[16:31]
    v_mfma_f32_32x32x16_bf16 v[32:47], v[116:119], v[208:211], v[32:47]
    s_add_u32 s75, s82, 8
    s_sub_u32 s4, s75, 28
    s_cmp_ge_u32 s75, 28
    s_cselect_b32 s75, s4, s75
    s_lshl_b32 s75, s75, 12
    s_add_u32 s75, s75, s74
    buffer_load_dwordx4 v[208:211], v247, s[64:67], s75 offen offset:0 sc1
    s_waitcnt vmcnt(7)
    v_mfma_f32_32x32x16_bf16 v[16:31], v[120:123], v[212:215], v[16:31]
    v_mfma_f32_32x32x16_bf16 v[32:47], v[124:127], v[212:215], v[32:47]
    buffer_load_dwordx4 v[212:215], v247, s[64:67], s75 offen offset:1024 sc1
    s_waitcnt vmcnt(7)
    v_mfma_f32_32x32x16_bf16 v[16:31], v[128:131], v[216:219], v[16:31]
    v_mfma_f32_32x32x16_bf16 v[32:47], v[132:135], v[216:219], v[32:47]
    s_add_u32 s75, s82, 9
    s_sub_u32 s4, s75, 28
    s_cmp_ge_u32 s75, 28
    s_cselect_b32 s75, s4, s75
    s_lshl_b32 s75, s75, 12
    s_add_u32 s75, s75, s74
    buffer_load_dwordx4 v[216:219], v247, s[64:67], s75 offen offset:0 sc1
    s_waitcnt vmcnt(7)
    v_mfma_f32_32x32x16_bf16 v[16:31], v[136:139], v[220:223], v[16:31]
    v_mfma_f32_32x32x16_bf16 v[32:47], v[140:143], v[220:223], v[32:47]
    buffer_load_dwordx4 v[220:223], v247, s[64:67], s75 offen offset:1024 sc1
    s_waitcnt vmcnt(7)
    v_mfma_f32_32x32x16_bf16 v[16:31], v[144:147], v[224:227], v[16:31]
    v_mfma_f32_32x32x16_bf16 v[32:47], v[148:151], v[224:227], v[32:47]
    s_add_u32 s75, s82, 25
    s_sub_u32 s4, s75, 28
    s_cmp_ge_u32 s75, 28
    s_cselect_b32 s75, s4, s75
    s_lshl_b32 s75, s75, 12
    s_add_u32 s75, s75, s74
    buffer_load_dwordx4 v[224:227], v247, s[64:67], s75 offen offset:0 sc1
    s_waitcnt vmcnt(7)
    v_mfma_f32_32x32x16_bf16 v[16:31], v[152:155], v[228:231], v[16:31]
    v_mfma_f32_32x32x16_bf16 v[32:47], v[156:159], v[228:231], v[32:47]
    buffer_load_dwordx4 v[228:231], v247, s[64:67], s75 offen offset:1024 sc1
    s_waitcnt vmcnt(7)
    v_mfma_f32_32x32x16_bf16 v[16:31], v[160:163], v[232:235], v[16:31]
    v_mfma_f32_32x32x16_bf16 v[32:47], v[164:167], v[232:235], v[32:47]
    s_add_u32 s75, s82, 26
    s_sub_u32 s4, s75, 28
    s_cmp_ge_u32 s75, 28
    s_cselect_b32 s75, s4, s75
    s_lshl_b32 s75, s75, 12
    s_add_u32 s75, s75, s74
    buffer_load_dwordx4 v[232:235], v247, s[64:67], s75 offen offset:0 sc1
    s_waitcnt vmcnt(7)
    v_mfma_f32_32x32x16_bf16 v[16:31], v[168:171], v[236:239], v[16:31]
    v_mfma_f32_32x32x16_bf16 v[32:47], v[172:175], v[236:239], v[32:47]
    buffer_load_dwordx4 v[236:239], v247, s[64:67], s75 offen offset:1024 sc1
    s_waitcnt vmcnt(7)
    v_mfma_f32_32x32x16_bf16 v[16:31], v[176:179], v[208:211], v[16:31]
    v_mfma_f32_32x32x16_bf16 v[32:47], v[180:183], v[208:211], v[32:47]
    s_add_u32 s75, s82, 27
    s_sub_u32 s4, s75, 28
    s_cmp_ge_u32 s75, 28
    s_cselect_b32 s75, s4, s75
    s_lshl_b32 s75, s75, 12
    s_add_u32 s75, s75, s74
    buffer_load_dwordx4 v[208:211], v247, s[64:67], s75 offen offset:0 sc1
    v_add_u32 v241, 0x10000, v241
    v_add_u32 v242, 0x10000, v242
    ds_read_b64_tr_b16 v[48:49], v241 offset:40960
    ds_read_b64_tr_b16 v[50:51], v241 offset:43008
    ds_read_b64_tr_b16 v[52:53], v242 offset:40960
    ds_read_b64_tr_b16 v[54:55], v242 offset:43008
    s_waitcnt vmcnt(7)
    v_mfma_f32_32x32x16_bf16 v[16:31], v[184:187], v[212:215], v[16:31]
    v_mfma_f32_32x32x16_bf16 v[32:47], v[188:191], v[212:215], v[32:47]
    buffer_load_dwordx4 v[212:215], v247, s[64:67], s75 offen offset:1024 sc1
    ds_read_b64_tr_b16 v[56:57], v241 offset:41984
    ds_read_b64_tr_b16 v[58:59], v241 offset:44032
    ds_read_b64_tr_b16 v[60:61], v242 offset:41984
    ds_read_b64_tr_b16 v[62:63], v242 offset:44032
    s_waitcnt vmcnt(7)
    v_mfma_f32_32x32x16_bf16 v[16:31], v[192:195], v[216:219], v[16:31]
    v_mfma_f32_32x32x16_bf16 v[32:47], v[196:199], v[216:219], v[32:47]
    s_add_u32 s75, s82, 10
    s_sub_u32 s4, s75, 28
    s_cmp_ge_u32 s75, 28
    s_cselect_b32 s75, s4, s75
    s_lshl_b32 s75, s75, 12
    s_add_u32 s75, s75, s74
    buffer_load_dwordx4 v[216:219], v247, s[64:67], s75 offen offset:0 sc1
    ds_read_b64_tr_b16 v[64:65], v241 offset:49152
    ds_read_b64_tr_b16 v[66:67], v241 offset:51200
    ds_read_b64_tr_b16 v[68:69], v242 offset:49152
    ds_read_b64_tr_b16 v[70:71], v242 offset:51200
    s_waitcnt vmcnt(7)
    v_mfma_f32_32x32x16_bf16 v[16:31], v[200:203], v[220:223], v[16:31]
    v_mfma_f32_32x32x16_bf16 v[32:47], v[204:207], v[220:223], v[32:47]
    buffer_load_dwordx4 v[220:223], v247, s[64:67], s75 offen offset:1024 sc1
    s_barrier
    ds_read_b64_tr_b16 v[72:73], v241 offset:50176
    ds_read_b64_tr_b16 v[74:75], v241 offset:52224
    ds_read_b64_tr_b16 v[76:77], v242 offset:50176
    ds_read_b64_tr_b16 v[78:79], v242 offset:52224
    s_waitcnt lgkmcnt(12)
    s_waitcnt vmcnt(7)
    v_mfma_f32_32x32x16_bf16 v[16:31], v[48:51], v[224:227], v[16:31]
    v_mfma_f32_32x32x16_bf16 v[32:47], v[52:55], v[224:227], v[32:47]
    s_add_u32 s75, s82, 11
    s_sub_u32 s4, s75, 28
    s_cmp_ge_u32 s75, 28
    s_cselect_b32 s75, s4, s75
    s_lshl_b32 s75, s75, 12
    s_add_u32 s75, s75, s74
    buffer_load_dwordx4 v[224:227], v247, s[64:67], s75 offen offset:0 sc1
    ds_read_b64_tr_b16 v[80:81], v241 offset:57344
    ds_read_b64_tr_b16 v[82:83], v241 offset:59392
    ds_read_b64_tr_b16 v[84:85], v242 offset:57344
    ds_read_b64_tr_b16 v[86:87], v242 offset:59392
    s_waitcnt lgkmcnt(12)
    s_waitcnt vmcnt(7)
    v_mfma_f32_32x32x16_bf16 v[16:31], v[56:59], v[228:231], v[16:31]
    v_mfma_f32_32x32x16_bf16 v[32:47], v[60:63], v[228:231], v[32:47]
    buffer_load_dwordx4 v[228:231], v247, s[64:67], s75 offen offset:1024 sc1
    buffer_load_dword v10, v5, s[56:59], s54 offen sc1
    ds_read_b64_tr_b16 v[88:89], v241 offset:58368
    ds_read_b64_tr_b16 v[90:91], v241 offset:60416
    ds_read_b64_tr_b16 v[92:93], v242 offset:58368
    ds_read_b64_tr_b16 v[94:95], v242 offset:60416
    s_waitcnt lgkmcnt(12)
    s_waitcnt vmcnt(8)
    v_mfma_f32_32x32x16_bf16 v[16:31], v[64:67], v[232:235], v[16:31]
    v_mfma_f32_32x32x16_bf16 v[32:47], v[68:71], v[232:235], v[32:47]
    v_add_u32 v241, 0x10000, v241
    v_add_u32 v242, 0x10000, v242
    ds_read_b64_tr_b16 v[48:49], v241 offset:0
    ds_read_b64_tr_b16 v[50:51], v241 offset:2048
    ds_read_b64_tr_b16 v[52:53], v242 offset:0
    ds_read_b64_tr_b16 v[54:55], v242 offset:2048
    s_waitcnt lgkmcnt(12)
    s_waitcnt vmcnt(7)
    v_mfma_f32_32x32x16_bf16 v[16:31], v[72:75], v[236:239], v[16:31]
    v_mfma_f32_32x32x16_bf16 v[32:47], v[76:79], v[236:239], v[32:47]
    ds_read_b64_tr_b16 v[56:57], v241 offset:1024
    ds_read_b64_tr_b16 v[58:59], v241 offset:3072
    ds_read_b64_tr_b16 v[60:61], v242 offset:1024
    ds_read_b64_tr_b16 v[62:63], v242 offset:3072
    s_waitcnt lgkmcnt(12)
    s_waitcnt vmcnt(6)
    v_mfma_f32_32x32x16_bf16 v[16:31], v[80:83], v[208:211], v[16:31]
    v_mfma_f32_32x32x16_bf16 v[32:47], v[84:87], v[208:211], v[32:47]
    ds_read_b64_tr_b16 v[64:65], v241 offset:8192
    ds_read_b64_tr_b16 v[66:67], v241 offset:10240
    ds_read_b64_tr_b16 v[68:69], v242 offset:8192
    ds_read_b64_tr_b16 v[70:71], v242 offset:10240
    s_waitcnt lgkmcnt(12)
    s_waitcnt vmcnt(5)
    v_mfma_f32_32x32x16_bf16 v[16:31], v[88:91], v[212:215], v[16:31]
    v_mfma_f32_32x32x16_bf16 v[32:47], v[92:95], v[212:215], v[32:47]
    ds_read_b64_tr_b16 v[72:73], v241 offset:9216
    ds_read_b64_tr_b16 v[74:75], v241 offset:11264
    ds_read_b64_tr_b16 v[76:77], v242 offset:9216
    ds_read_b64_tr_b16 v[78:79], v242 offset:11264
    s_waitcnt lgkmcnt(12)
    s_waitcnt vmcnt(4)
    v_mfma_f32_32x32x16_bf16 v[16:31], v[48:51], v[216:219], v[16:31]
    v_mfma_f32_32x32x16_bf16 v[32:47], v[52:55], v[216:219], v[32:47]
    s_waitcnt lgkmcnt(8)
    s_waitcnt vmcnt(3)
    v_mfma_f32_32x32x16_bf16 v[16:31], v[56:59], v[220:223], v[16:31]
    v_mfma_f32_32x32x16_bf16 v[32:47], v[60:63], v[220:223], v[32:47]
    s_waitcnt lgkmcnt(4)
    s_waitcnt vmcnt(2)
    v_mfma_f32_32x32x16_bf16 v[16:31], v[64:67], v[224:227], v[16:31]
    v_mfma_f32_32x32x16_bf16 v[32:47], v[68:71], v[224:227], v[32:47]
    s_waitcnt lgkmcnt(0)
    s_waitcnt vmcnt(1)
    v_mfma_f32_32x32x16_bf16 v[16:31], v[72:75], v[228:231], v[16:31]
    v_mfma_f32_32x32x16_bf16 v[32:47], v[76:79], v[228:231], v[32:47]
    s_add_u32 s60, s48, 8388608
    s_addc_u32 s61, s49, 0
    s_and_b32 s61, s61, 0xffff
    s_mov_b32 s62, 4194304
    s_mov_b32 s63, 0x00020000
    s_waitcnt vmcnt(0)
    s_mov_b32 s5, 0
    v_cmp_ne_u32 vcc, s15, v10
    s_cbranch_vccz L_apoll_done
L_apoll:
    buffer_load_dword v10, v5, s[56:59], s54 offen sc1
    s_add_u32 s5, s5, 1
    s_cmp_gt_u32 s5, 400000
    s_cbranch_scc1 L_apoll_done
    s_waitcnt vmcnt(0)
    v_cmp_ne_u32 vcc, s15, v10
    s_cbranch_vccnz L_apoll
L_apoll_done:
    s_add_u32 s76, s55, 0
    buffer_load_dwordx4 v[96:99], v253, s[60:63], s76 offen sc1
    s_add_u32 s76, s55, 32768
    buffer_load_dwordx4 v[100:103], v253, s[60:63], s76 offen sc1
    s_add_u32 s76, s55, 2097152
    buffer_load_dwordx4 v[104:107], v253, s[60:63], s76 offen sc1
    s_add_u32 s76, s55, 2129920
    buffer_load_dwordx4 v[108:111], v253, s[60:63], s76 offen sc1
    s_lshl_b32 s4, s3, 11
    s_add_u32 s4, s4, 0
    v_add_u32 v9, s4, v247
    s_mov_b32 s78, 1
    s_branch L_g2end
L_g2:
    s_mov_b32 s64, s48
    s_and_b32 s65, s49, 0xffff
    s_mov_b32 s66, 7340032
    s_mov_b32 s67, 0x00020000
    s_lshl_b32 s4, s80, 1
    s_add_u32 s4, s4, s84
    s_mul_i32 s4, s4, 112
    s_lshl_b32 s5, s83, 1
    s_add_u32 s4, s4, s5
    s_lshl_b32 s74, s4, 10
    s_add_u32 s60, s48, 14680064
    s_addc_u32 s61, s49, 0
    s_and_b32 s61, s61, 0xffff
    s_mov_b32 s62, 8192
    s_mov_b32 s63, 0x00020000
    s_mov_b32 s68, s40
    s_and_b32 s69, s41, 0xffff
    s_mov_b32 s70, 1835008
    s_mov_b32 s71, 0x00020000
    s_lshl_b32 s72, s81, 7
    s_lshl_b32 s4, s83, 15
    s_add_u32 s72, s72, s4
    s_lshl_b32 s73, s83, 12
    v_lshlrev_b32 v4, 2, v246
    s_waitcnt vmcnt(4)
    s_barrier
    buffer_load_dword v251, v4, s[60:63], 0 offen sc1
    s_add_u32 s75, s82, 12
    s_sub_u32 s4, s75, 28
    s_cmp_ge_u32 s75, 28
    s_cselect_b32 s75, s4, s75
    s_lshl_b32 s75, s75, 12
    s_add_u32 s75, s75, s74
    buffer_load_dwordx4 v[144:147], v247, s[64:67], s75 offen offset:0 sc1
    buffer_load_dwordx4 v[148:151], v247, s[64:67], s75 offen offset:1024 sc1
    s_waitcnt vmcnt(3)
    buffer_store_dword v250, v249, s[56:59], s79 offen sc1
    s_add_u32 s75, s82, 13
    s_sub_u32 s4, s75, 28
    s_cmp_ge_u32 s75, 28
    s_cselect_b32 s75, s4, s75
    s_lshl_b32 s75, s75, 12
    s_add_u32 s75, s75, s74
    buffer_load_dwordx4 v[152:155], v247, s[64:67], s75 offen offset:0 sc1
    buffer_load_dwordx4 v[156:159], v247, s[64:67], s75 offen offset:1024 sc1
    s_add_u32 s75, s82, 14
    s_sub_u32 s4, s75, 28
    s_cmp_ge_u32 s75, 28
    s_cselect_b32 s75, s4, s75
    s_lshl_b32 s75, s75, 12
    s_add_u32 s75, s75, s74
    buffer_load_dwordx4 v[160:163], v247, s[64:67], s75 offen offset:0 sc1
    buffer_load_dwordx4 v[164:167], v247, s[64:67], s75 offen offset:1024 sc1
    ds_read_b64_tr_b16 v[48:49], v241 offset:49152
    ds_read_b64_tr_b16 v[50:51], v241 offset:51200
    ds_read_b64_tr_b16 v[52:53], v242 offset:49152
    ds_read_b64_tr_b16 v[54:55], v242 offset:51200
    ds_read_b64_tr_b16 v[56:57], v241 offset:50176
    ds_read_b64_tr_b16 v[58:59], v241 offset:52224
    ds_read_b64_tr_b16 v[60:61], v242 offset:50176
    ds_read_b64_tr_b16 v[62:63], v242 offset:52224
    ds_read_b64_tr_b16 v[64:65], v241 offset:57344
    ds_read_b64_tr_b16 v[66:67], v241 offset:59392
    ds_read_b64_tr_b16 v[68:69], v242 offset:57344
    ds_read_b64_tr_b16 v[70:71], v242 offset:59392
    ds_read_b64_tr_b16 v[72:73], v241 offset:58368
    ds_read_b64_tr_b16 v[74:75], v241 offset:60416
    ds_read_b64_tr_b16 v[76:77], v242 offset:58368
    ds_read_b64_tr_b16 v[78:79], v242 offset:60416
    s_waitcnt lgkmcnt(12)
    s_waitcnt vmcnt(6)
    v_mfma_f32_32x32x16_bf16 v[16:31], v[48:51], v[144:147], 0
    v_mfma_f32_32x32x16_bf16 v[32:47], v[52:55], v[144:147], 0
    s_add_u32 s75, s82, 15
    s_sub_u32 s4, s75, 28
    s_cmp_ge_u32 s75, 28
    s_cselect_b32 s75, s4, s75
    s_lshl_b32 s75, s75, 12
    s_add_u32 s75, s75, s74
    buffer_load_dwordx4 v[168:171], v247, s[64:67], s75 offen offset:0 sc1
    buffer_load_dwordx4 v[172:175], v247, s[64:67], s75 offen offset:1024 sc1
    v_add_u32 v241, 0x10000, v241
    v_add_u32 v242, 0x10000, v242
    ds_read_b64_tr_b16 v[80:81], v241 offset:0
    ds_read_b64_tr_b16 v[82:83], v241 offset:2048
    ds_read_b64_tr_b16 v[84:85], v242 offset:0
    ds_read_b64_tr_b16 v[86:87], v242 offset:2048
    s_waitcnt lgkmcnt(12)
    s_waitcnt vmcnt(7)
    v_mfma_f32_32x32x16_bf16 v[16:31], v[56:59], v[148:151], v[16:31]
    v_mfma_f32_32x32x16_bf16 v[32:47], v[60:63], v[148:151], v[32:47]
    s_add_u32 s75, s82, 16
    s_sub_u32 s4, s75, 28
    s_cmp_ge_u32 s75, 28
    s_cselect_b32 s75, s4, s75
    s_lshl_b32 s75, s75, 12
    s_add_u32 s75, s75, s74
    buffer_load_dwordx4 v[144:147], v247, s[64:67], s75 offen offset:0 sc1
    buffer_load_dwordx4 v[148:151], v247, s[64:67], s75 offen offset:1024 sc1
    ds_read_b64_tr_b16 v[88:89], v241 offset:1024
    ds_read_b64_tr_b16 v[90:91], v241 offset:3072
    ds_read_b64_tr_b16 v[92:93], v242 offset:1024
    ds_read_b64_tr_b16 v[94:95], v242 offset:3072
    s_waitcnt lgkmcnt(12)
    s_waitcnt vmcnt(7)
    v_mfma_f32_32x32x16_bf16 v[16:31], v[64:67], v[152:155], v[16:31]
    v_mfma_f32_32x32x16_bf16 v[32:47], v[68:71], v[152:155], v[32:47]
    s_add_u32 s75, s82, 17
    s_sub_u32 s4, s75, 28
    s_cmp_ge_u32 s75, 28
    s_cselect_b32 s75, s4, s75
    s_lshl_b32 s75, s75, 12
    s_add_u32 s75, s75, s74
    buffer_load_dwordx4 v[152:155], v247, s[64:67], s75 offen offset:0 sc1
    ds_read_b64_tr_b16 v[48:49], v241 offset:8192
    ds_read_b64_tr_b16 v[50:51], v241 offset:10240
    ds_read_b64_tr_b16 v[52:53], v242 offset:8192
    ds_read_b64_tr_b16 v[54:55], v242 offset:10240
    s_waitcnt lgkmcnt(12)
    s_waitcnt vmcnt(7)
    v_mfma_f32_32x32x16_bf16 v[16:31], v[72:75], v[156:159], v[16:31]
    v_mfma_f32_32x32x16_bf16 v[32:47], v[76:79], v[156:159], v[32:47]
    buffer_load_dwordx4 v[156:159], v247, s[64:67], s75 offen offset:1024 sc1
    ds_read_b64_tr_b16 v[56:57], v241 offset:9216
    ds_read_b64_tr_b16 v[58:59], v241 offset:11264
    ds_read_b64_tr_b16 v[60:61], v242 offset:9216
    ds_read_b64_tr_b16 v[62:63], v242 offset:11264
    s_waitcnt lgkmcnt(12)
    s_waitcnt vmcnt(7)
    v_mfma_f32_32x32x16_bf16 v[16:31], v[80:83], v[160:163], v[16:31]
    v_mfma_f32_32x32x16_bf16 v[32:47], v[84:87], v[160:163], v[32:47]
    s_add_u32 s75, s82, 18
    s_sub_u32 s4, s75, 28
    s_cmp_ge_u32 s75, 28
    s_cselect_b32 s75, s4, s75
    s_lshl_b32 s75, s75, 12
    s_add_u32 s75, s75, s74
    buffer_load_dwordx4 v[160:163], v247, s[64:67], s75 offen offset:0 sc1
    ds_read_b64_tr_b16 v[64:65], v241 offset:16384
    ds_read_b64_tr_b16 v[66:67], v241 offset:18432
    ds_read_b64_tr_b16 v[68:69], v242 offset:16384
    ds_read_b64_tr_b16 v[70:71], v242 offset:18432
    s_waitcnt lgkmcnt(12)
    s_waitcnt vmcnt(7)
    v_mfma_f32_32x32x16_bf16 v[16:31], v[88:91], v[164:167], v[16:31]
    v_mfma_f32_32x32x16_bf16 v[32:47], v[92:95], v[164:167], v[32:47]
    buffer_load_dwordx4 v[164:167], v247, s[64:67], s75 offen offset:1024 sc1
    ds_read_b64_tr_b16 v[72:73], v241 offset:17408
    ds_read_b64_tr_b16 v[74:75], v241 offset:19456
    ds_read_b64_tr_b16 v[76:77], v242 offset:17408
    ds_read_b64_tr_b16 v[78:79], v242 offset:19456
    s_waitcnt lgkmcnt(12)
    s_waitcnt vmcnt(7)
    v_mfma_f32_32x32x16_bf16 v[16:31], v[48:51], v[168:171], v[16:31]
    v_mfma_f32_32x32x16_bf16 v[32:47], v[52:55], v[168:171], v[32:47]
    s_add_u32 s75, s82, 19
    s_sub_u32 s4, s75, 28
    s_cmp_ge_u32 s75, 28
    s_cselect_b32 s75, s4, s75
    s_lshl_b32 s75, s75, 12
    s_add_u32 s75, s75, s74
    buffer_load_dwordx4 v[168:171], v247, s[64:67], s75 offen offset:0 sc1
    ds_read_b64_tr_b16 v[80:81], v241 offset:24576
    ds_read_b64_tr_b16 v[82:83], v241 offset:26624
    ds_read_b64_tr_b16 v[84:85], v242 offset:24576
    ds_read_b64_tr_b16 v[86:87], v242 offset:26624
    s_waitcnt lgkmcnt(12)
    s_waitcnt vmcnt(7)
    v_mfma_f32_32x32x16_bf16 v[16:31], v[56:59], v[172:175], v[16:31]
    v_mfma_f32_32x32x16_bf16 v[32:47], v[60:63], v[172:175], v[32:47]
    buffer_load_dwordx4 v[172:175], v247, s[64:67], s75 offen offset:1024 sc1
    ds_read_b64_tr_b16 v[88:89], v241 offset:25600
    ds_read_b64_tr_b16 v[90:91], v241 offset:27648
    ds_read_b64_tr_b16 v[92:93], v242 offset:25600
    ds_read_b64_tr_b16 v[94:95], v242 offset:27648
    s_waitcnt lgkmcnt(12)
    s_waitcnt vmcnt(7)
    v_mfma_f32_32x32x16_bf16 v[16:31], v[64:67], v[144:147], v[16:31]
    v_mfma_f32_32x32x16_bf16 v[32:47], v[68:71], v[144:147], v[32:47]
    s_add_u32 s75, s82, 20
    s_sub_u32 s4, s75, 28
    s_cmp_ge_u32 s75, 28
    s_cselect_b32 s75, s4, s75
    s_lshl_b32 s75, s75, 12
    s_add_u32 s75, s75, s74
    buffer_load_dwordx4 v[144:147], v247, s[64:67], s75 offen offset:0 sc1
    v_add_u32 v241, 0xffff0000, v241
    v_add_u32 v242, 0xffff0000, v242
    ds_read_b64_tr_b16 v[48:49], v241 offset:0
    ds_read_b64_tr_b16 v[50:51], v241 offset:2048
    ds_read_b64_tr_b16 v[52:53], v242 offset:0
    ds_read_b64_tr_b16 v[54:55], v242 offset:2048
    s_waitcnt lgkmcnt(12)
    s_waitcnt vmcnt(7)
    v_mfma_f32_32x32x16_bf16 v[16:31], v[72:75], v[148:151], v[16:31]
    v_mfma_f32_32x32x16_bf16 v[32:47], v[76:79], v[148:151], v[32:47]
    buffer_load_dwordx4 v[148:151], v247, s[64:67], s75 offen offset:1024 sc1
    ds_read_b64_tr_b16 v[56:57], v241 offset:1024
    ds_read_b64_tr_b16 v[58:59], v241 offset:3072
    ds_read_b64_tr_b16 v[60:61], v242 offset:1024
    ds_read_b64_tr_b16 v[62:63], v242 offset:3072
    s_waitcnt lgkmcnt(12)
    s_waitcnt vmcnt(7)
    v_mfma_f32_32x32x16_bf16 v[16:31], v[80:83], v[152:155], v[16:31]
    v_mfma_f32_32x32x16_bf16 v[32:47], v[84:87], v[152:155], v[32:47]
    s_add_u32 s75, s82, 21
    s_sub_u32 s4, s75, 28
    s_cmp_ge_u32 s75, 28
    s_cselect_b32 s75, s4, s75
    s_lshl_b32 s75, s75, 12
    s_add_u32 s75, s75, s74
    buffer_load_dwordx4 v[152:155], v247, s[64:67], s75 offen offset:0 sc1
    ds_read_b64_tr_b16 v[64:65], v241 offset:8192
    ds_read_b64_tr_b16 v[66:67], v241 offset:10240
    ds_read_b64_tr_b16 v[68:69], v242 offset:8192
    ds_read_b64_tr_b16 v[70:71], v242 offset:10240
    s_waitcnt lgkmcnt(12)
    s_waitcnt vmcnt(7)
    v_mfma_f32_32x32x16_bf16 v[16:31], v[88:91], v[156:159], v[16:31]
    v_mfma_f32_32x32x16_bf16 v[32:47], v[92:95], v[156:159], v[32:47]
    buffer_load_dwordx4 v[156:159], v247, s[64:67], s75 offen offset:1024 sc1
    ds_read_b64_tr_b16 v[72:73], v241 offset:9216
    ds_read_b64_tr_b16 v[74:75], v241 offset:11264
    ds_read_b64_tr_b16 v[76:77], v242 offset:9216
    ds_read_b64_tr_b16 v[78:79], v242 offset:11264
    s_waitcnt lgkmcnt(12)
    s_waitcnt vmcnt(7)
    v_mfma_f32_32x32x16_bf16 v[16:31], v[48:51], v[160:163], v[16:31]
    v_mfma_f32_32x32x16_bf16 v[32:47], v[52:55], v[160:163], v[32:47]
    s_add_u32 s75, s82, 22
    s_sub_u32 s4, s75, 28
    s_cmp_ge_u32 s75, 28
    s_cselect_b32 s75, s4, s75
    s_lshl_b32 s75, s75, 12
    s_add_u32 s75, s75, s74
    buffer_load_dwordx4 v[160:163], v247, s[64:67], s75 offen offset:0 sc1
    ds_read_b64_tr_b16 v[80:81], v241 offset:16384
    ds_read_b64_tr_b16 v[82:83], v241 offset:18432
    ds_read_b64_tr_b16 v[84:85], v242 offset:16384
    ds_read_b64_tr_b16 v[86:87], v242 offset:18432
    s_waitcnt lgkmcnt(12)
    s_waitcnt vmcnt(7)
    v_mfma_f32_32x32x16_bf16 v[16:31], v[56:59], v[164:167], v[16:31]
    v_mfma_f32_32x32x16_bf16 v[32:47], v[60:63], v[164:167], v[32:47]
    buffer_load_dwordx4 v[164:167], v247, s[64:67], s75 offen offset:1024 sc1
    ds_read_b64_tr_b16 v[88:89], v241 offset:17408
    ds_read_b64_tr_b16 v[90:91], v241 offset:19456
    ds_read_b64_tr_b16 v[92:93], v242 offset:17408
    ds_read_b64_tr_b16 v[94:95], v242 offset:19456
    s_waitcnt lgkmcnt(12)
    s_waitcnt vmcnt(7)
    v_mfma_f32_32x32x16_bf16 v[16:31], v[64:67], v[168:171], v[16:31]
    v_mfma_f32_32x32x16_bf16 v[32:47], v[68:71], v[168:171], v[32:47]
    s_add_u32 s75, s82, 23
    s_sub_u32 s4, s75, 28
    s_cmp_ge_u32 s75, 28
    s_cselect_b32 s75, s4, s75
    s_lshl_b32 s75, s75, 12
    s_add_u32 s75, s75, s74
    buffer_load_dwordx4 v[168:171], v247, s[64:67], s75 offen offset:0 sc1
    ds_read_b64_tr_b16 v[48:49], v241 offset:24576
    ds_read_b64_tr_b16 v[50:51], v241 offset:26624
    ds_read_b64_tr_b16 v[52:53], v242 offset:24576
    ds_read_b64_tr_b16 v[54:55], v242 offset:26624
    s_waitcnt lgkmcnt(12)
    s_waitcnt vmcnt(7)
    v_mfma_f32_32x32x16_bf16 v[16:31], v[72:75], v[172:175], v[16:31]
    v_mfma_f32_32x32x16_bf16 v[32:47], v[76:79], v[172:175], v[32:47]
    buffer_load_dwordx4 v[172:175], v247, s[64:67], s75 offen offset:1024 sc1
    s_barrier
    ds_read_b64_tr_b16 v[56:57], v241 offset:25600
    ds_read_b64_tr_b16 v[58:59], v241 offset:27648
    ds_read_b64_tr_b16 v[60:61], v242 offset:25600
    ds_read_b64_tr_b16 v[62:63], v242 offset:27648
    s_waitcnt lgkmcnt(12)
    s_waitcnt vmcnt(7)
    v_mfma_f32_32x32x16_bf16 v[16:31], v[80:83], v[144:147], v[16:31]
    v_mfma_f32_32x32x16_bf16 v[32:47], v[84:87], v[144:147], v[32:47]
    s_add_u32 s75, s82, 24
    s_sub_u32 s4, s75, 28
    s_cmp_ge_u32 s75, 28
    s_cselect_b32 s75, s4, s75
    s_lshl_b32 s75, s75, 12
    s_add_u32 s75, s75, s74
    buffer_load_dwordx4 v[144:147], v247, s[64:67], s75 offen offset:0 sc1
    ds_read_b64_tr_b16 v[64:65], v241 offset:32768
    ds_read_b64_tr_b16 v[66:67], v241 offset:34816
    ds_read_b64_tr_b16 v[68:69], v242 offset:32768
    ds_read_b64_tr_b16 v[70:71], v242 offset:34816
    s_waitcnt lgkmcnt(12)
    s_waitcnt vmcnt(7)
    v_mfma_f32_32x32x16_bf16 v[16:31], v[88:91], v[148:151], v[16:31]
    v_mfma_f32_32x32x16_bf16 v[32:47], v[92:95], v[148:151], v[32:47]
    buffer_load_dwordx4 v[148:151], v247, s[64:67], s75 offen offset:1024 sc1
    ds_read_b64_tr_b16 v[72:73], v241 offset:33792
    ds_read_b64_tr_b16 v[74:75], v241 offset:35840
    ds_read_b64_tr_b16 v[76:77], v242 offset:33792
    ds_read_b64_tr_b16 v[78:79], v242 offset:35840
    s_waitcnt lgkmcnt(12)
    s_waitcnt vmcnt(7)
    v_mfma_f32_32x32x16_bf16 v[16:31], v[48:51], v[152:155], v[16:31]
    v_mfma_f32_32x32x16_bf16 v[32:47], v[52:55], v[152:155], v[32:47]
    ds_read_b64_tr_b16 v[80:81], v241 offset:40960
    ds_read_b64_tr_b16 v[82:83], v241 offset:43008
    ds_read_b64_tr_b16 v[84:85], v242 offset:40960
    ds_read_b64_tr_b16 v[86:87], v242 offset:43008
    s_waitcnt lgkmcnt(12)
    s_waitcnt vmcnt(6)
    v_mfma_f32_32x32x16_bf16 v[16:31], v[56:59], v[156:159], v[16:31]
    v_mfma_f32_32x32x16_bf16 v[32:47], v[60:63], v[156:159], v[32:47]
    ds_read_b64_tr_b16 v[88:89], v241 offset:41984
    ds_read_b64_tr_b16 v[90:91], v241 offset:44032
    ds_read_b64_tr_b16 v[92:93], v242 offset:41984
    ds_read_b64_tr_b16 v[94:95], v242 offset:44032
    s_waitcnt lgkmcnt(12)
    s_waitcnt vmcnt(5)
    v_mfma_f32_32x32x16_bf16 v[16:31], v[64:67], v[160:163], v[16:31]
    v_mfma_f32_32x32x16_bf16 v[32:47], v[68:71], v[160:163], v[32:47]
    v_add_u32 v241, 0x10000, v241
    v_add_u32 v242, 0x10000, v242
    ds_read_b64_tr_b16 v[48:49], v241 offset:32768
    ds_read_b64_tr_b16 v[50:51], v241 offset:34816
    ds_read_b64_tr_b16 v[52:53], v242 offset:32768
    ds_read_b64_tr_b16 v[54:55], v242 offset:34816
    s_waitcnt lgkmcnt(12)
    s_waitcnt vmcnt(4)
    v_mfma_f32_32x32x16_bf16 v[16:31], v[72:75], v[164:167], v[16:31]
    v_mfma_f32_32x32x16_bf16 v[32:47], v[76:79], v[164:167], v[32:47]
    ds_read_b64_tr_b16 v[56:57], v241 offset:33792
    ds_read_b64_tr_b16 v[58:59], v241 offset:35840
    ds_read_b64_tr_b16 v[60:61], v242 offset:33792
    ds_read_b64_tr_b16 v[62:63], v242 offset:35840
    s_waitcnt lgkmcnt(12)
    s_waitcnt vmcnt(3)
    v_mfma_f32_32x32x16_bf16 v[16:31], v[80:83], v[168:171], v[16:31]
    v_mfma_f32_32x32x16_bf16 v[32:47], v[84:87], v[168:171], v[32:47]
    s_waitcnt lgkmcnt(8)
    s_waitcnt vmcnt(2)
    v_mfma_f32_32x32x16_bf16 v[16:31], v[88:91], v[172:175], v[16:31]
    v_mfma_f32_32x32x16_bf16 v[32:47], v[92:95], v[172:175], v[32:47]
    s_waitcnt lgkmcnt(4)
    s_waitcnt vmcnt(1)
    v_mfma_f32_32x32x16_bf16 v[16:31], v[48:51], v[144:147], v[16:31]
    v_mfma_f32_32x32x16_bf16 v[32:47], v[52:55], v[144:147], v[32:47]
    s_waitcnt lgkmcnt(0)
    s_waitcnt vmcnt(0)
    v_mfma_f32_32x32x16_bf16 v[16:31], v[56:59], v[148:151], v[16:31]
    v_mfma_f32_32x32x16_bf16 v[32:47], v[60:63], v[148:151], v[32:47]
    s_mov_b32 s78, 0
    v_mov_b32 v9, 0
L_g2end:
    s_lshl_b32 s4, s84, 2
    s_xor_b32 s5, s85, 0
    s_add_u32 s5, s5, s4
    s_mul_i32 s5, s5, 6144
    s_add_u32 s5, s5, 49152
    v_add_u32 v6, s5, v247
    s_xor_b32 s5, s85, 1
    s_add_u32 s5, s5, s4
    s_mul_i32 s5, s5, 6144
    s_add_u32 s5, s5, 49152
    v_add_u32 v5, s5, v247
    s_xor_b32 s5, s85, 2
    s_add_u32 s5, s5, s4
    s_mul_i32 s5, s5, 6144
    s_add_u32 s5, s5, 49152
    v_add_u32 v8, s5, v247
    s_xor_b32 s5, s85, 3
    s_add_u32 s5, s5, s4
    s_mul_i32 s5, s5, 6144
    s_add_u32 s5, s5, 49152
    v_add_u32 v11, s5, v247
    s_mov_b32 s64, s44
    s_and_b32 s65, s45, 0xffff
    s_mov_b32 s66, 2097152
    s_mov_b32 s67, 0x00020000
    v_lshrrev_b32 v3, 5, v0
    v_lshlrev_b32 v2, 10, v246
    v_lshl_add_u32 v7, v3, 4, v2
    s_lshl_b32 s72, s81, 7
    s_lshl_b32 s4, s85, 5
    s_add_u32 s72, s72, s4
    v_sub_f32 v10, 1.0, v251
    v_cvt_pk_bf16_f32 v10, v10, v10
    v_lshlrev_b32 v10, 16, v10
    ds_write_b128 v5, v[24:27] offset:0
    ds_write_b128 v5, v[28:31] offset:1024
    ds_write_b128 v8, v[32:35] offset:2048
    ds_write_b128 v8, v[36:39] offset:3072
    ds_write_b128 v11, v[40:43] offset:4096
    ds_write_b128 v11, v[44:47] offset:5120
    s_cmp_eq_u32 s78, 0
    s_cbranch_scc1 L_noatw
    s_waitcnt vmcnt(0)
    ds_write_b128 v9, v[96:99] offset:0
    ds_write_b128 v9, v[100:103] offset:1024
    ds_write_b128 v9, v[104:107] offset:8192
    ds_write_b128 v9, v[108:111] offset:9216
L_noatw:
    s_waitcnt lgkmcnt(0)
    s_barrier
    ds_read_b128 v[56:59], v6 offset:0
    ds_read_b128 v[60:63], v6 offset:1024
    ds_read_b128 v[64:67], v6 offset:2048
    ds_read_b128 v[68:71], v6 offset:3072
    ds_read_b128 v[72:75], v6 offset:4096
    ds_read_b128 v[76:79], v6 offset:5120
    ds_read_b64_tr_b16 v[80:81], v243 offset:0
    ds_read_b64_tr_b16 v[96:97], v243 offset:8192
    ds_read_b64_tr_b16 v[82:83], v243 offset:1024
    ds_read_b64_tr_b16 v[98:99], v243 offset:9216
    s_waitcnt lgkmcnt(0)
    v_pk_add_f32 v[48:49], v[16:17], v[56:57]
    v_pk_add_f32 v[64:65], v[64:65], v[72:73]
    v_pk_add_f32 v[50:51], v[18:19], v[58:59]
    v_pk_add_f32 v[66:67], v[66:67], v[74:75]
    v_pk_add_f32 v[52:53], v[20:21], v[60:61]
    v_pk_add_f32 v[68:69], v[68:69], v[76:77]
    v_pk_add_f32 v[54:55], v[22:23], v[62:63]
    v_pk_add_f32 v[70:71], v[70:71], v[78:79]
    v_lshlrev_b32 v84, 16, v80
    v_and_b32 v85, 0xffff0000, v80
    v_lshlrev_b32 v100, 16, v96
    v_and_b32 v101, 0xffff0000, v96
    v_lshlrev_b32 v86, 16, v81
    v_and_b32 v87, 0xffff0000, v81
    v_lshlrev_b32 v102, 16, v97
    v_and_b32 v103, 0xffff0000, v97
    v_lshlrev_b32 v88, 16, v82
    v_and_b32 v89, 0xffff0000, v82
    v_lshlrev_b32 v104, 16, v98
    v_and_b32 v105, 0xffff0000, v98
    v_lshlrev_b32 v90, 16, v83
    v_and_b32 v91, 0xffff0000, v83
    v_lshlrev_b32 v106, 16, v99
    v_and_b32 v107, 0xffff0000, v99
    v_pk_add_f32 v[84:85], v[84:85], v[100:101]
    v_pk_add_f32 v[86:87], v[86:87], v[102:103]
    v_pk_add_f32 v[88:89], v[88:89], v[104:105]
    v_pk_add_f32 v[90:91], v[90:91], v[106:107]
    v_pk_add_f32 v[48:49], v[48:49], v[64:65]
    v_pk_add_f32 v[50:51], v[50:51], v[66:67]
    v_pk_add_f32 v[52:53], v[52:53], v[68:69]
    v_pk_add_f32 v[54:55], v[54:55], v[70:71]
    v_mul_f32 v84, v251, v84
    v_mul_f32 v85, v251, v85
    v_mul_f32 v86, v251, v86
    v_mul_f32 v87, v251, v87
    v_mul_f32 v88, v251, v88
    v_mul_f32 v89, v251, v89
    v_mul_f32 v90, v251, v90
    v_mul_f32 v91, v251, v91
    v_fma_f32 v84, v10, v48, v84
    v_fma_f32 v85, v10, v49, v85
    v_fma_f32 v86, v10, v50, v86
    v_fma_f32 v87, v10, v51, v87
    v_fma_f32 v88, v10, v52, v88
    v_fma_f32 v89, v10, v53, v89
    v_fma_f32 v90, v10, v54, v90
    v_fma_f32 v91, v10, v55, v91
    v_cvt_pk_bf16_f32 v92, v84, v85
    v_cvt_pk_bf16_f32 v93, v86, v87
    v_cvt_pk_bf16_f32 v94, v88, v89
    v_cvt_pk_bf16_f32 v95, v90, v91
    s_nop 1
    v_permlane32_swap_b32 v92, v94
    v_permlane32_swap_b32 v93, v95
    buffer_store_dwordx4 v[92:95], v7, s[64:67], s72 offen
L_end:
    s_endpgm
.section .rodata,"a"
.p2align 6
.amdhsa_kernel gated_mix__ssm_conv_s4__swiglu_ffn__prompt_kernel
  .amdhsa_next_free_vgpr 256
  .amdhsa_next_free_sgpr 102
  .amdhsa_accum_offset 256
  .amdhsa_group_segment_fixed_size 0
  .amdhsa_kernarg_size 136
  .amdhsa_user_sgpr_count 2
  .amdhsa_user_sgpr_kernarg_segment_ptr 1
  .amdhsa_system_sgpr_workgroup_id_x 1
.end_amdhsa_kernel
```
